```python
import torch

def _softmax(x, axis=-1):
    return torch.softmax(x, dim=axis)
def _gelu(x):
    return torch.nn.functional.gelu(x, approximate="tanh")
def _silu(x):
    return torch.nn.functional.silu(x)
def _sigmoid(x):
    return torch.sigmoid(x)
def _layernorm(x, axis=-1, eps=1e-5):
    m = x.mean(dim=axis, keepdim=True)
    v = x.var(dim=axis, keepdim=True, unbiased=False)
    return (x - m) / torch.sqrt(v + eps)
def _scatter_add(tgt, idx, src, axis=0):
    return tgt.clone().index_add_(axis, idx, src)
def _segment_sum(src, seg, n):
    out = torch.zeros((n,) + src.shape[1:], dtype=src.dtype)
    return out.index_add_(0, seg, src)
def _pad(x, pw):
    flat = tuple(v for pair in reversed(pw) for v in pair)
    return torch.nn.functional.pad(x, flat)

kernel_name = 'standalone__gqa_softmax__near_ridge'

def setup_inputs():

    _w = (lambda a: (lambda t: t.to(torch.bfloat16) if t.is_floating_point() else t)(torch.as_tensor(a)))
    B, Hq, Hkv, Sq, Sk, D = 8, 32, 32, 336, 2048, 128
    return {
        "q": _w((lambda *s: torch.randn(*s, dtype=torch.bfloat16) * 0.8)(B, Hq, Sq, D)),
        "k": _w((lambda *s: torch.randn(*s, dtype=torch.bfloat16) * 0.8)(B, Hkv, Sk, D)),
        "v": _w((lambda *s: torch.randn(*s, dtype=torch.bfloat16) * 0.05)(B, Hkv, Sk, D)),
    }

def reference(q, k, v):
    B, Hq, Sq, D = q.shape
    Hkv = k.shape[1]
    rep = Hq // Hkv
    k = (lambda x, n, axis: torch.repeat_interleave(x, n, dim=axis))(k, rep, axis=1)
    v = (lambda x, n, axis: torch.repeat_interleave(x, n, dim=axis))(v, rep, axis=1)
    scale = D ** -0.5
    scores = torch.einsum("bhqd,bhkd->bhqk", q, k) * scale
    p = _softmax(scores, axis=-1)
    return torch.einsum("bhqk,bhkd->bhqd", p, v)
```

```asm
; @launch grid=(256,1,1) block=(256,1,1) lds=163840
.amdgcn_target "amdgcn-amd-amdhsa--gfx950"
.text
.globl standalone__gqa_softmax__near_ridge_kernel
.p2align 8
.type standalone__gqa_softmax__near_ridge_kernel,@function
standalone__gqa_softmax__near_ridge_kernel:
    s_cmp_ge_u32 s2, 256
    s_cbranch_scc1 L_end
    s_load_dwordx8 s[36:43], s[0:1], 0
    v_mov_b32 v216, 0
    v_mov_b32 v217, 0
    v_mov_b32 v218, 0
    v_mov_b32 v219, 0
    v_and_b32 v250, 63, v0
    v_lshrrev_b32 v242, 6, v0
    v_lshrrev_b32 v243, 5, v250
    v_mfma_f32_32x32x16_bf16 v[160:175], v[216:219], v[216:219], 0
    v_readfirstlane_b32 s28, v242
    v_lshlrev_b32 v242, 6, v243
    v_bfe_u32 v243, v250, 2, 3
    v_mfma_f32_32x32x16_bf16 v[176:191], v[216:219], v[216:219], 0
    v_and_b32 v244, 3, v250
    v_lshl_add_u32 v242, v243, 8, v242
    v_lshrrev_b32 v245, 2, v243
    v_mfma_f32_32x32x16_bf16 a[224:239], v[216:219], v[216:219], 0
    v_add_u32 v246, 0, v245
    v_sub_u32 v246, 0, v246
    v_and_b32 v246, 3, v246
    v_xor_b32 v246, v246, v244
    v_lshl_add_u32 v246, v246, 4, v242
    v_add_u32 v248, 0, v246
    v_add_u32 v246, 2, v245
    v_sub_u32 v246, 0, v246
    v_and_b32 v246, 3, v246
    v_xor_b32 v246, v246, v244
    v_lshl_add_u32 v246, v246, 4, v242
    v_add_u32 v249, 2048, v246
    s_and_b32 s58, s28, 1
    s_lshr_b32 s32, s28, 1
    s_cmp_eq_u32 s58, 0
    s_cselect_b64 s[46:47], -1, 0
    v_cndmask_b32 v245, v249, v248, s[46:47]
    s_lshl_b32 s33, s32, 7
    v_add_u32 v234, s33, v245
    s_lshl_b32 s31, s28, 10
    s_mul_i32 s33, s2, 86016
    s_lshl_b32 s34, s2, 19
    s_waitcnt lgkmcnt(0)
    s_add_u32 s12, s38, s34
    s_addc_u32 s13, s39, 0
    s_and_b32 s13, s13, 0xffff
    s_mov_b32 s14, 524288
    s_mov_b32 s15, 0x20000
    s_add_u32 m0, s31, 49152
    s_mov_b32 s48, 0
    buffer_load_dwordx4 v234, s[12:15], s48 offen nt lds
    s_add_u32 m0, s31, 53248
    s_mov_b32 s48, 4096
    buffer_load_dwordx4 v234, s[12:15], s48 offen nt lds
    s_add_u32 m0, s31, 57344
    s_mov_b32 s48, 8192
    buffer_load_dwordx4 v234, s[12:15], s48 offen nt lds
    s_add_u32 m0, s31, 61440
    s_mov_b32 s48, 12288
    buffer_load_dwordx4 v234, s[12:15], s48 offen nt lds
    s_add_u32 s8, s36, s33
    s_addc_u32 s9, s37, 0
    s_and_b32 s9, s9, 0xffff
    s_mov_b32 s10, 86016
    s_mov_b32 s11, 0x20000
    s_lshl_b32 s32, s28, 13
    s_lshl_b32 s35, s28, 12
    s_mul_i32 s65, s28, 20480
    s_add_u32 m0, s32, 131072
    s_add_u32 s48, s65, 0
    buffer_load_dwordx4 v248, s[8:11], s48 offen nt lds
    s_add_u32 m0, s32, 132096
    s_add_u32 s48, s65, 0
    buffer_load_dwordx4 v249, s[8:11], s48 offen nt lds
    s_add_u32 m0, s32, 133120
    s_add_u32 s48, s65, 128
    buffer_load_dwordx4 v248, s[8:11], s48 offen nt lds
    s_add_u32 m0, s32, 134144
    s_add_u32 s48, s65, 128
    buffer_load_dwordx4 v249, s[8:11], s48 offen nt lds
    s_add_u32 m0, s31, 98304
    s_lshr_b32 s48, s28, 1
    s_lshl_b32 s48, s48, 7
    s_add_u32 s48, s48, 81920
    buffer_load_dwordx4 v245, s[8:11], s48 offen nt lds
    s_add_u32 s16, s40, s34
    s_addc_u32 s17, s41, 0
    s_and_b32 s17, s17, 0xffff
    s_mov_b32 s18, 524288
    s_mov_b32 s19, 0x20000
    v_bfe_u32 v242, v250, 4, 1
    v_bfe_u32 v243, v250, 2, 2
    v_lshl_add_u32 v243, v242, 2, v243
    v_bfe_u32 v244, v250, 1, 1
    v_xor_b32 v244, v244, v242
    v_and_b32 v245, 1, v250
    v_lshl_add_u32 v244, v244, 1, v245
    v_lshrrev_b32 v245, 5, v250
    v_lshl_add_u32 v244, v245, 2, v244
    v_lshlrev_b32 v244, 4, v244
    v_lshl_add_u32 v235, v243, 8, v244
    s_lshr_b32 s46, s28, 1
    s_lshl_b32 s46, s46, 11
    s_lshl_b32 s47, s58, 7
    s_add_u32 s46, s46, s47
    v_add_u32 v235, s46, v235
    s_add_u32 m0, s31, 114688
    s_mov_b32 s48, 0
    buffer_load_dwordx4 v235, s[16:19], s48 offen nt lds
    s_add_u32 m0, s31, 118784
    s_mov_b32 s48, 4096
    buffer_load_dwordx4 v235, s[16:19], s48 offen nt lds
    s_add_u32 m0, s31, 122880
    s_mov_b32 s48, 8192
    buffer_load_dwordx4 v235, s[16:19], s48 offen nt lds
    s_add_u32 m0, s31, 126976
    s_mov_b32 s48, 12288
    buffer_load_dwordx4 v235, s[16:19], s48 offen nt lds
    s_add_u32 s20, s42, s33
    s_addc_u32 s21, s43, 0
    s_and_b32 s21, s21, 0xffff
    s_mov_b32 s22, 86016
    s_mov_b32 s23, 0x20000
    v_and_b32 v242, 15, v250
    v_lshrrev_b32 v243, 4, v250
    v_lshrrev_b32 v244, 2, v242
    v_sub_u32 v244, 0, v244
    v_and_b32 v244, 3, v244
    v_xor_b32 v244, v244, v243
    v_lshlrev_b32 v244, 4, v244
    v_and_b32 v245, 7, v242
    v_lshl_add_u32 v244, v245, 6, v244
    v_lshrrev_b32 v245, 3, v242
    v_lshl_add_u32 v220, v245, 10, v244
    s_lshl_b32 s46, s58, 13
    s_xor_b32 s47, s46, 8192
    v_add_u32 v228, s46, v220
    v_add_u32 v229, s47, v220
    v_add_u32 v247, 98304, v220
    v_add_u32 v246, s32, v220
    v_add_u32 v246, 131072, v246
    v_add_u32 v251, s35, v220
    v_add_u32 v251, 32768, v251
    v_lshrrev_b32 v244, 1, v243
    v_lshlrev_b32 v244, 11, v244
    v_and_b32 v245, 1, v243
    v_lshl_add_u32 v244, v245, 8, v244
    v_lshrrev_b32 v220, 2, v242
    v_lshl_add_u32 v244, v220, 6, v244
    v_and_b32 v220, 3, v242
    v_lshl_add_u32 v244, v220, 3, v244
    v_add_u32 v244, 65536, v244
    v_xor_b32 v220, 0, v245
    v_lshl_add_u32 v220, v220, 5, v244
    v_add_u32 v230, s46, v220
    v_add_u32 v232, s47, v220
    v_xor_b32 v220, 1, v245
    v_lshl_add_u32 v220, v220, 5, v244
    v_add_u32 v231, s46, v220
    v_add_u32 v233, s47, v220
    v_lshlrev_b32 v250, 4, v250
    v_add_u32 v250, s31, v250
    v_add_u32 v250, 98304, v250
    s_mov_b32 s60, 0x3e0293ee
    s_mov_b32 s61, 0x3e0293ee
    s_mov_b32 s64, 0xffff0000
    s_mov_b32 s62, 0x26800000
    s_mov_b32 s63, 0x3f000000
    v_mov_b32 v252, 0x3f803f80
    v_accvgpr_write_b32 a236, v252
    v_accvgpr_write_b32 a237, v252
    v_accvgpr_write_b32 a238, v252
    v_accvgpr_write_b32 a239, v252
    v_mbcnt_lo_u32_b32 v192, -1, 0
    v_mbcnt_hi_u32_b32 v192, -1, v192
    v_bfe_u32 v193, v192, 1, 1
    v_lshrrev_b32 v194, 5, v192
    v_cmp_eq_u32 vcc, v193, v194
    v_and_b32 v194, 1, v192
    v_mul_u32_u24 v243, 0xaaaa, v194
    v_cndmask_b32 v193, 0, v252, vcc
    v_add_u32 v243, 0x4444, v243
    v_accvgpr_write_b32 a252, v193
    v_accvgpr_write_b32 a253, v193
    v_accvgpr_write_b32 a254, v193
    v_accvgpr_write_b32 a255, v193
    v_mov_b32 v236, 0
    v_mov_b32 v237, 0
    v_mov_b32 v238, 0
    v_mov_b32 v239, 0
    v_mov_b32 v240, 0
    v_mov_b32 v241, 0
    v_mov_b32 v252, 0xc2200000
    v_mov_b32 v253, 0xc2200000
    v_mov_b32 v254, 0xc2200000
    v_mov_b32 v255, 0xc2200000
    v_accvgpr_write_b32 a240, v228
    v_accvgpr_write_b32 a241, v229
    v_accvgpr_write_b32 a242, v230
    v_accvgpr_write_b32 a243, v231
    v_accvgpr_write_b32 a244, v232
    v_accvgpr_write_b32 a245, v233
    v_accvgpr_write_b32 a246, v234
    v_accvgpr_write_b32 a247, v235
    v_mbcnt_lo_u32_b32 v192, -1, 0
    s_mul_i32 s36, s28, 20480
    v_mbcnt_hi_u32_b32 v192, -1, v192
    s_add_u32 s37, s36, 4096
    s_add_u32 s38, s36, 8192
    s_add_u32 s39, s36, 12288
    s_add_u32 s40, s36, 16384
    s_mul_i32 s34, s28, 4608
    s_add_u32 s34, s34, 65536
    v_and_b32 v193, 15, v192
    v_lshrrev_b32 v194, 4, v192
    v_mul_u32_u24 v195, 272, v193
    v_lshl_add_u32 v195, v194, 3, v195
    v_add_u32 v195, s34, v195
    v_accvgpr_write_b32 a248, v195
    v_lshrrev_b32 v193, 3, v192
    v_and_b32 v194, 7, v192
    v_lshlrev_b32 v194, 4, v194
    v_mul_u32_u24 v195, 272, v193
    v_add3_u32 v195, v195, v194, s34
    v_accvgpr_write_b32 a249, v195
    v_lshl_add_u32 v195, v193, 8, v194
    v_accvgpr_write_b32 a250, v195
    v_lshlrev_b32 v192, 4, v192
    v_accvgpr_write_b32 a251, v192
    s_waitcnt vmcnt(9)
    s_barrier
    s_add_u32 m0, s32, 135168
    s_add_u32 s48, s65, 4096
    buffer_load_dwordx4 v248, s[8:11], s48 offen nt lds
    s_add_u32 m0, s32, 136192
    s_add_u32 s48, s65, 4096
    buffer_load_dwordx4 v249, s[8:11], s48 offen nt lds
    s_add_u32 m0, s32, 137216
    s_add_u32 s48, s65, 4224
    buffer_load_dwordx4 v248, s[8:11], s48 offen nt lds
    s_add_u32 m0, s32, 138240
    s_add_u32 s48, s65, 4224
    buffer_load_dwordx4 v249, s[8:11], s48 offen nt lds
    ds_read_b128 a[0:3], v228 offset:49152
    ds_read_b128 a[4:7], v228 offset:49664
    ds_read_b128 a[8:11], v228 offset:51200
    ds_read_b128 a[12:15], v228 offset:51712
    ds_read_b128 a[16:19], v228 offset:53248
    ds_read_b128 a[20:23], v228 offset:53760
    ds_read_b128 a[24:27], v228 offset:55296
    ds_read_b128 a[28:31], v228 offset:55808
    ds_read_b128 a[32:35], v229 offset:49152
    ds_read_b128 a[36:39], v229 offset:49664
    ds_read_b128 a[40:43], v229 offset:51200
    ds_read_b128 a[44:47], v229 offset:51712
    ds_read_b128 a[48:51], v229 offset:53248
    ds_read_b128 a[52:55], v229 offset:53760
    ds_read_b128 a[56:59], v229 offset:55296
    ds_read_b128 a[60:63], v229 offset:55808
    s_waitcnt vmcnt(9)
    ds_read_b128 v[0:3], v246 offset:0
    ds_read_b128 v[4:7], v246 offset:512
    ds_read_b128 v[8:11], v246 offset:2048
    ds_read_b128 v[12:15], v246 offset:2560
    s_waitcnt lgkmcnt(0)
    s_add_u32 m0, s35, 32768
    s_add_u32 s48, s65, 8192
    buffer_load_dwordx4 v248, s[8:11], s48 offen nt lds
    s_add_u32 m0, s35, 33792
    s_add_u32 s48, s65, 8192
    buffer_load_dwordx4 v249, s[8:11], s48 offen nt lds
    s_add_u32 m0, s35, 34816
    s_add_u32 s48, s65, 8320
    buffer_load_dwordx4 v248, s[8:11], s48 offen nt lds
    s_add_u32 m0, s35, 35840
    s_add_u32 s48, s65, 8320
    buffer_load_dwordx4 v249, s[8:11], s48 offen nt lds
    v_lshlrev_b32 v192, 16, v0
    v_and_b32 v193, s64, v0
    v_lshlrev_b32 v194, 16, v1
    v_and_b32 v195, s64, v1
    v_lshlrev_b32 v196, 16, v2
    v_and_b32 v197, s64, v2
    v_lshlrev_b32 v198, 16, v3
    v_and_b32 v199, s64, v3
    v_pk_mul_f32 v[192:193], v[192:193], s[60:61]
    v_pk_mul_f32 v[194:195], v[194:195], s[60:61]
    v_pk_mul_f32 v[196:197], v[196:197], s[60:61]
    v_pk_mul_f32 v[198:199], v[198:199], s[60:61]
    v_cvt_pk_bf16_f32 v0, v192, v193
    v_cvt_pk_bf16_f32 v1, v194, v195
    v_cvt_pk_bf16_f32 v2, v196, v197
    v_cvt_pk_bf16_f32 v3, v198, v199
    v_accvgpr_write_b32 a128, v0
    v_accvgpr_write_b32 a129, v1
    v_accvgpr_write_b32 a130, v2
    v_accvgpr_write_b32 a131, v3
    v_lshlrev_b32 v192, 16, v4
    v_and_b32 v193, s64, v4
    v_lshlrev_b32 v194, 16, v5
    v_and_b32 v195, s64, v5
    v_lshlrev_b32 v196, 16, v6
    v_and_b32 v197, s64, v6
    v_lshlrev_b32 v198, 16, v7
    v_and_b32 v199, s64, v7
    v_pk_mul_f32 v[192:193], v[192:193], s[60:61]
    v_pk_mul_f32 v[194:195], v[194:195], s[60:61]
    v_pk_mul_f32 v[196:197], v[196:197], s[60:61]
    v_pk_mul_f32 v[198:199], v[198:199], s[60:61]
    v_cvt_pk_bf16_f32 v4, v192, v193
    v_cvt_pk_bf16_f32 v5, v194, v195
    v_cvt_pk_bf16_f32 v6, v196, v197
    v_cvt_pk_bf16_f32 v7, v198, v199
    v_accvgpr_write_b32 a132, v4
    v_accvgpr_write_b32 a133, v5
    v_accvgpr_write_b32 a134, v6
    v_accvgpr_write_b32 a135, v7
    v_lshlrev_b32 v192, 16, v8
    v_and_b32 v193, s64, v8
    v_lshlrev_b32 v194, 16, v9
    v_and_b32 v195, s64, v9
    v_lshlrev_b32 v196, 16, v10
    v_and_b32 v197, s64, v10
    v_lshlrev_b32 v198, 16, v11
    v_and_b32 v199, s64, v11
    v_pk_mul_f32 v[192:193], v[192:193], s[60:61]
    v_pk_mul_f32 v[194:195], v[194:195], s[60:61]
    v_pk_mul_f32 v[196:197], v[196:197], s[60:61]
    v_pk_mul_f32 v[198:199], v[198:199], s[60:61]
    v_cvt_pk_bf16_f32 v8, v192, v193
    v_cvt_pk_bf16_f32 v9, v194, v195
    v_cvt_pk_bf16_f32 v10, v196, v197
    v_cvt_pk_bf16_f32 v11, v198, v199
    v_accvgpr_write_b32 a136, v8
    v_accvgpr_write_b32 a137, v9
    v_accvgpr_write_b32 a138, v10
    v_accvgpr_write_b32 a139, v11
    v_lshlrev_b32 v192, 16, v12
    v_and_b32 v193, s64, v12
    v_lshlrev_b32 v194, 16, v13
    v_and_b32 v195, s64, v13
    v_lshlrev_b32 v196, 16, v14
    v_and_b32 v197, s64, v14
    v_lshlrev_b32 v198, 16, v15
    v_and_b32 v199, s64, v15
    v_pk_mul_f32 v[192:193], v[192:193], s[60:61]
    v_pk_mul_f32 v[194:195], v[194:195], s[60:61]
    v_pk_mul_f32 v[196:197], v[196:197], s[60:61]
    v_pk_mul_f32 v[198:199], v[198:199], s[60:61]
    v_cvt_pk_bf16_f32 v12, v192, v193
    v_cvt_pk_bf16_f32 v13, v194, v195
    v_cvt_pk_bf16_f32 v14, v196, v197
    v_cvt_pk_bf16_f32 v15, v198, v199
    v_accvgpr_write_b32 a140, v12
    v_accvgpr_write_b32 a141, v13
    v_accvgpr_write_b32 a142, v14
    v_accvgpr_write_b32 a143, v15
    s_nop 1
    v_mfma_f32_16x16x32_bf16 v[200:203], a[0:3], a[128:131], v[252:255]
    v_mfma_f32_16x16x32_bf16 v[200:203], a[4:7], a[132:135], v[200:203]
    v_mfma_f32_16x16x32_bf16 v[200:203], a[8:11], a[136:139], v[200:203]
    v_mfma_f32_16x16x32_bf16 v[200:203], a[12:15], a[140:143], v[200:203]
    v_mfma_f32_16x16x32_bf16 v[204:207], a[16:19], a[128:131], v[252:255]
    v_mfma_f32_16x16x32_bf16 v[204:207], a[20:23], a[132:135], v[204:207]
    v_mfma_f32_16x16x32_bf16 v[204:207], a[24:27], a[136:139], v[204:207]
    v_mfma_f32_16x16x32_bf16 v[204:207], a[28:31], a[140:143], v[204:207]
    s_nop 2
    v_mfma_f32_16x16x32_bf16 v[208:211], a[32:35], a[128:131], v[252:255]
    v_exp_f32 v200, v200
    v_mfma_f32_16x16x32_bf16 v[208:211], a[36:39], a[132:135], v[208:211]
    v_exp_f32 v201, v201
    v_mfma_f32_16x16x32_bf16 v[208:211], a[40:43], a[136:139], v[208:211]
    v_cvt_pk_bf16_f32 v220, v200, v201
    v_exp_f32 v202, v202
    v_mfma_f32_16x16x32_bf16 v[208:211], a[44:47], a[140:143], v[208:211]
    v_exp_f32 v203, v203
    v_mfma_f32_16x16x32_bf16 v[212:215], a[48:51], a[128:131], v[252:255]
    v_cvt_pk_bf16_f32 v221, v202, v203
    v_exp_f32 v204, v204
    v_mfma_f32_16x16x32_bf16 v[212:215], a[52:55], a[132:135], v[212:215]
    v_exp_f32 v205, v205
    v_mfma_f32_16x16x32_bf16 v[212:215], a[56:59], a[136:139], v[212:215]
    v_cvt_pk_bf16_f32 v222, v204, v205
    v_exp_f32 v206, v206
    v_mfma_f32_16x16x32_bf16 v[212:215], a[60:63], a[140:143], v[212:215]
    v_exp_f32 v207, v207
    s_nop 0
    v_cvt_pk_bf16_f32 v223, v206, v207
    v_exp_f32 v208, v208
    v_exp_f32 v209, v209
    v_exp_f32 v210, v210
    v_cvt_pk_bf16_f32 v224, v208, v209
    v_exp_f32 v211, v211
    v_exp_f32 v212, v212
    v_cvt_pk_bf16_f32 v225, v210, v211
    v_exp_f32 v213, v213
    v_exp_f32 v214, v214
    v_cvt_pk_bf16_f32 v226, v212, v213
    v_exp_f32 v215, v215
    s_nop 0
    v_cvt_pk_bf16_f32 v227, v214, v215
    s_waitcnt vmcnt(12)
    ds_read_b128 v[216:219], v250
    s_waitcnt lgkmcnt(0)
    v_lshlrev_b32 v192, 16, v216
    v_and_b32 v193, s64, v216
    v_lshlrev_b32 v194, 16, v217
    v_and_b32 v195, s64, v217
    v_lshlrev_b32 v196, 16, v218
    v_and_b32 v197, s64, v218
    v_lshlrev_b32 v198, 16, v219
    v_and_b32 v199, s64, v219
    v_pk_mul_f32 v[192:193], v[192:193], s[60:61]
    v_pk_mul_f32 v[194:195], v[194:195], s[60:61]
    v_pk_mul_f32 v[196:197], v[196:197], s[60:61]
    v_pk_mul_f32 v[198:199], v[198:199], s[60:61]
    v_cvt_pk_bf16_f32 v216, v192, v193
    v_cvt_pk_bf16_f32 v217, v194, v195
    v_cvt_pk_bf16_f32 v218, v196, v197
    v_cvt_pk_bf16_f32 v219, v198, v199
    ds_write_b128 v250, v[216:219]
    s_waitcnt vmcnt(8) lgkmcnt(0)
    s_barrier
    s_add_u32 m0, s32, 131072
    s_add_u32 s48, s65, 12288
    buffer_load_dwordx4 v248, s[8:11], s48 offen nt lds
    s_add_u32 m0, s32, 132096
    s_add_u32 s48, s65, 12288
    buffer_load_dwordx4 v249, s[8:11], s48 offen nt lds
    s_add_u32 m0, s32, 133120
    s_add_u32 s48, s65, 12416
    buffer_load_dwordx4 v248, s[8:11], s48 offen nt lds
    s_add_u32 m0, s32, 134144
    s_add_u32 s48, s65, 12416
    buffer_load_dwordx4 v249, s[8:11], s48 offen nt lds
    ds_read_b64_tr_b16 a[64:65], v230 offset:49152
    ds_read_b64_tr_b16 a[66:67], v230 offset:53248
    ds_read_b64_tr_b16 a[68:69], v231 offset:49152
    ds_read_b64_tr_b16 a[70:71], v231 offset:53248
    ds_read_b64_tr_b16 a[72:73], v230 offset:49664
    ds_read_b64_tr_b16 a[74:75], v230 offset:53760
    ds_read_b64_tr_b16 a[76:77], v231 offset:49664
    ds_read_b64_tr_b16 a[78:79], v231 offset:53760
    ds_read_b64_tr_b16 a[80:81], v230 offset:50176
    ds_read_b64_tr_b16 a[82:83], v230 offset:54272
    ds_read_b64_tr_b16 a[84:85], v231 offset:50176
    ds_read_b64_tr_b16 a[86:87], v231 offset:54272
    ds_read_b64_tr_b16 a[88:89], v230 offset:50688
    ds_read_b64_tr_b16 a[90:91], v230 offset:54784
    ds_read_b64_tr_b16 a[92:93], v231 offset:50688
    ds_read_b64_tr_b16 a[94:95], v231 offset:54784
    ds_read_b128 a[208:211], v247 offset:0
    ds_read_b128 a[212:215], v247 offset:512
    ds_read_b128 a[216:219], v247 offset:2048
    ds_read_b128 a[220:223], v247 offset:2560
    ds_read_b64_tr_b16 a[96:97], v232 offset:49152
    ds_read_b64_tr_b16 a[98:99], v232 offset:53248
    ds_read_b64_tr_b16 a[100:101], v233 offset:49152
    ds_read_b64_tr_b16 a[102:103], v233 offset:53248
    ds_read_b64_tr_b16 a[104:105], v232 offset:49664
    ds_read_b64_tr_b16 a[106:107], v232 offset:53760
    ds_read_b64_tr_b16 a[108:109], v233 offset:49664
    ds_read_b64_tr_b16 a[110:111], v233 offset:53760
    ds_read_b64_tr_b16 a[112:113], v232 offset:50176
    ds_read_b64_tr_b16 a[114:115], v232 offset:54272
    ds_read_b64_tr_b16 a[116:117], v233 offset:50176
    ds_read_b64_tr_b16 a[118:119], v233 offset:54272
    ds_read_b64_tr_b16 a[120:121], v232 offset:50688
    ds_read_b64_tr_b16 a[122:123], v232 offset:54784
    ds_read_b64_tr_b16 a[124:125], v233 offset:50688
    ds_read_b64_tr_b16 a[126:127], v233 offset:54784
    s_waitcnt lgkmcnt(15)
    v_mfma_f32_16x16x32_bf16 v[0:3], v[220:223], a[64:67], 0
    v_mfma_f32_16x16x32_bf16 v[4:7], v[220:223], a[68:71], 0
    v_mfma_f32_16x16x32_bf16 v[8:11], v[220:223], a[72:75], 0
    v_mfma_f32_16x16x32_bf16 v[12:15], v[220:223], a[76:79], 0
    v_mfma_f32_16x16x32_bf16 v[16:19], v[220:223], a[80:83], 0
    v_mfma_f32_16x16x32_bf16 v[20:23], v[220:223], a[84:87], 0
    v_mfma_f32_16x16x32_bf16 v[24:27], v[220:223], a[88:91], 0
    v_mfma_f32_16x16x32_bf16 v[28:31], v[220:223], a[92:95], 0
    v_mfma_f32_16x16x32_bf16 a[224:227], a[236:239], v[220:223], a[224:227]
    s_waitcnt lgkmcnt(0)
    v_mfma_f32_16x16x32_bf16 v[0:3], v[224:227], a[96:99], v[0:3]
    v_mfma_f32_16x16x32_bf16 v[4:7], v[224:227], a[100:103], v[4:7]
    v_mfma_f32_16x16x32_bf16 v[8:11], v[224:227], a[104:107], v[8:11]
    v_mfma_f32_16x16x32_bf16 v[12:15], v[224:227], a[108:111], v[12:15]
    v_mfma_f32_16x16x32_bf16 v[16:19], v[224:227], a[112:115], v[16:19]
    v_mfma_f32_16x16x32_bf16 v[20:23], v[224:227], a[116:119], v[20:23]
    v_mfma_f32_16x16x32_bf16 v[24:27], v[224:227], a[120:123], v[24:27]
    v_mfma_f32_16x16x32_bf16 v[28:31], v[224:227], a[124:127], v[28:31]
    v_mfma_f32_16x16x32_bf16 a[224:227], a[236:239], v[224:227], a[224:227]
    s_cmp_ge_u32 s28, 2
    s_cbranch_scc1 L_noshared0
    v_mfma_f32_16x16x32_bf16 v[200:203], a[0:3], a[208:211], v[252:255]
    v_mfma_f32_16x16x32_bf16 v[200:203], a[4:7], a[212:215], v[200:203]
    v_mfma_f32_16x16x32_bf16 v[200:203], a[8:11], a[216:219], v[200:203]
    v_mfma_f32_16x16x32_bf16 v[200:203], a[12:15], a[220:223], v[200:203]
    v_mfma_f32_16x16x32_bf16 v[204:207], a[16:19], a[208:211], v[252:255]
    v_mfma_f32_16x16x32_bf16 v[204:207], a[20:23], a[212:215], v[204:207]
    v_mfma_f32_16x16x32_bf16 v[204:207], a[24:27], a[216:219], v[204:207]
    v_mfma_f32_16x16x32_bf16 v[204:207], a[28:31], a[220:223], v[204:207]
    s_nop 7
    v_exp_f32 v200, v200
    v_exp_f32 v201, v201
    v_exp_f32 v202, v202
    v_cvt_pk_bf16_f32 v220, v200, v201
    v_exp_f32 v203, v203
    v_exp_f32 v204, v204
    v_cvt_pk_bf16_f32 v221, v202, v203
    v_exp_f32 v205, v205
    v_exp_f32 v206, v206
    v_cvt_pk_bf16_f32 v222, v204, v205
    v_exp_f32 v207, v207
    s_nop 0
    v_cvt_pk_bf16_f32 v223, v206, v207
    s_nop 1
    v_mfma_f32_16x16x32_bf16 v[160:163], v[220:223], a[64:67], v[160:163]
    v_mfma_f32_16x16x32_bf16 v[164:167], v[220:223], a[68:71], v[164:167]
    v_mfma_f32_16x16x32_bf16 v[168:171], v[220:223], a[72:75], v[168:171]
    v_mfma_f32_16x16x32_bf16 v[172:175], v[220:223], a[76:79], v[172:175]
    v_mfma_f32_16x16x32_bf16 v[176:179], v[220:223], a[80:83], v[176:179]
    v_mfma_f32_16x16x32_bf16 v[180:183], v[220:223], a[84:87], v[180:183]
    v_mfma_f32_16x16x32_bf16 v[184:187], v[220:223], a[88:91], v[184:187]
    v_mfma_f32_16x16x32_bf16 v[188:191], v[220:223], a[92:95], v[188:191]
    v_mfma_f32_16x16x32_bf16 a[232:235], a[236:239], v[220:223], a[232:235]
L_noshared0:
    s_waitcnt vmcnt(8)
    ds_read_b128 v[32:35], v246 offset:4096
    ds_read_b128 v[36:39], v246 offset:4608
    ds_read_b128 v[40:43], v246 offset:6144
    ds_read_b128 v[44:47], v246 offset:6656
    s_waitcnt lgkmcnt(0)
    s_add_u32 m0, s32, 135168
    s_add_u32 s48, s65, 16384
    buffer_load_dwordx4 v248, s[8:11], s48 offen nt lds
    s_add_u32 m0, s32, 136192
    s_add_u32 s48, s65, 16384
    buffer_load_dwordx4 v249, s[8:11], s48 offen nt lds
    s_add_u32 m0, s32, 137216
    s_add_u32 s48, s65, 16512
    buffer_load_dwordx4 v248, s[8:11], s48 offen nt lds
    s_add_u32 m0, s32, 138240
    s_add_u32 s48, s65, 16512
    buffer_load_dwordx4 v249, s[8:11], s48 offen nt lds
    v_lshlrev_b32 v192, 16, v32
    v_and_b32 v193, s64, v32
    v_lshlrev_b32 v194, 16, v33
    v_and_b32 v195, s64, v33
    v_lshlrev_b32 v196, 16, v34
    v_and_b32 v197, s64, v34
    v_lshlrev_b32 v198, 16, v35
    v_and_b32 v199, s64, v35
    v_pk_mul_f32 v[192:193], v[192:193], s[60:61]
    v_pk_mul_f32 v[194:195], v[194:195], s[60:61]
    v_pk_mul_f32 v[196:197], v[196:197], s[60:61]
    v_pk_mul_f32 v[198:199], v[198:199], s[60:61]
    v_cvt_pk_bf16_f32 v32, v192, v193
    v_cvt_pk_bf16_f32 v33, v194, v195
    v_cvt_pk_bf16_f32 v34, v196, v197
    v_cvt_pk_bf16_f32 v35, v198, v199
    v_accvgpr_write_b32 a144, v32
    v_accvgpr_write_b32 a145, v33
    v_accvgpr_write_b32 a146, v34
    v_accvgpr_write_b32 a147, v35
    v_lshlrev_b32 v192, 16, v36
    v_and_b32 v193, s64, v36
    v_lshlrev_b32 v194, 16, v37
    v_and_b32 v195, s64, v37
    v_lshlrev_b32 v196, 16, v38
    v_and_b32 v197, s64, v38
    v_lshlrev_b32 v198, 16, v39
    v_and_b32 v199, s64, v39
    v_pk_mul_f32 v[192:193], v[192:193], s[60:61]
    v_pk_mul_f32 v[194:195], v[194:195], s[60:61]
    v_pk_mul_f32 v[196:197], v[196:197], s[60:61]
    v_pk_mul_f32 v[198:199], v[198:199], s[60:61]
    v_cvt_pk_bf16_f32 v36, v192, v193
    v_cvt_pk_bf16_f32 v37, v194, v195
    v_cvt_pk_bf16_f32 v38, v196, v197
    v_cvt_pk_bf16_f32 v39, v198, v199
    v_accvgpr_write_b32 a148, v36
    v_accvgpr_write_b32 a149, v37
    v_accvgpr_write_b32 a150, v38
    v_accvgpr_write_b32 a151, v39
    v_lshlrev_b32 v192, 16, v40
    v_and_b32 v193, s64, v40
    v_lshlrev_b32 v194, 16, v41
    v_and_b32 v195, s64, v41
    v_lshlrev_b32 v196, 16, v42
    v_and_b32 v197, s64, v42
    v_lshlrev_b32 v198, 16, v43
    v_and_b32 v199, s64, v43
    v_pk_mul_f32 v[192:193], v[192:193], s[60:61]
    v_pk_mul_f32 v[194:195], v[194:195], s[60:61]
    v_pk_mul_f32 v[196:197], v[196:197], s[60:61]
    v_pk_mul_f32 v[198:199], v[198:199], s[60:61]
    v_cvt_pk_bf16_f32 v40, v192, v193
    v_cvt_pk_bf16_f32 v41, v194, v195
    v_cvt_pk_bf16_f32 v42, v196, v197
    v_cvt_pk_bf16_f32 v43, v198, v199
    v_accvgpr_write_b32 a152, v40
    v_accvgpr_write_b32 a153, v41
    v_accvgpr_write_b32 a154, v42
    v_accvgpr_write_b32 a155, v43
    v_lshlrev_b32 v192, 16, v44
    v_and_b32 v193, s64, v44
    v_lshlrev_b32 v194, 16, v45
    v_and_b32 v195, s64, v45
    v_lshlrev_b32 v196, 16, v46
    v_and_b32 v197, s64, v46
    v_lshlrev_b32 v198, 16, v47
    v_and_b32 v199, s64, v47
    v_pk_mul_f32 v[192:193], v[192:193], s[60:61]
    v_pk_mul_f32 v[194:195], v[194:195], s[60:61]
    v_pk_mul_f32 v[196:197], v[196:197], s[60:61]
    v_pk_mul_f32 v[198:199], v[198:199], s[60:61]
    v_cvt_pk_bf16_f32 v44, v192, v193
    v_cvt_pk_bf16_f32 v45, v194, v195
    v_cvt_pk_bf16_f32 v46, v196, v197
    v_cvt_pk_bf16_f32 v47, v198, v199
    v_accvgpr_write_b32 a156, v44
    v_accvgpr_write_b32 a157, v45
    v_accvgpr_write_b32 a158, v46
    v_accvgpr_write_b32 a159, v47
    s_nop 1
    v_mfma_f32_16x16x32_bf16 v[200:203], a[0:3], a[144:147], v[252:255]
    v_mfma_f32_16x16x32_bf16 v[200:203], a[4:7], a[148:151], v[200:203]
    v_mfma_f32_16x16x32_bf16 v[200:203], a[8:11], a[152:155], v[200:203]
    v_mfma_f32_16x16x32_bf16 v[200:203], a[12:15], a[156:159], v[200:203]
    v_mfma_f32_16x16x32_bf16 v[204:207], a[16:19], a[144:147], v[252:255]
    v_mfma_f32_16x16x32_bf16 v[204:207], a[20:23], a[148:151], v[204:207]
    v_mfma_f32_16x16x32_bf16 v[204:207], a[24:27], a[152:155], v[204:207]
    v_mfma_f32_16x16x32_bf16 v[204:207], a[28:31], a[156:159], v[204:207]
    s_nop 2
    v_mfma_f32_16x16x32_bf16 v[208:211], a[32:35], a[144:147], v[252:255]
    v_exp_f32 v200, v200
    v_mfma_f32_16x16x32_bf16 v[208:211], a[36:39], a[148:151], v[208:211]
    v_exp_f32 v201, v201
    v_mfma_f32_16x16x32_bf16 v[208:211], a[40:43], a[152:155], v[208:211]
    v_cvt_pk_bf16_f32 v220, v200, v201
    v_exp_f32 v202, v202
    v_mfma_f32_16x16x32_bf16 v[208:211], a[44:47], a[156:159], v[208:211]
    v_exp_f32 v203, v203
    v_mfma_f32_16x16x32_bf16 v[212:215], a[48:51], a[144:147], v[252:255]
    v_cvt_pk_bf16_f32 v221, v202, v203
    v_exp_f32 v204, v204
    v_mfma_f32_16x16x32_bf16 v[212:215], a[52:55], a[148:151], v[212:215]
    v_exp_f32 v205, v205
    v_mfma_f32_16x16x32_bf16 v[212:215], a[56:59], a[152:155], v[212:215]
    v_cvt_pk_bf16_f32 v222, v204, v205
    v_exp_f32 v206, v206
    v_mfma_f32_16x16x32_bf16 v[212:215], a[60:63], a[156:159], v[212:215]
    v_exp_f32 v207, v207
    s_nop 0
    v_cvt_pk_bf16_f32 v223, v206, v207
    s_nop 1
    v_mfma_f32_16x16x32_bf16 v[32:35], v[220:223], a[64:67], 0
    v_exp_f32 v208, v208
    v_mfma_f32_16x16x32_bf16 v[36:39], v[220:223], a[68:71], 0
    v_exp_f32 v209, v209
    v_mfma_f32_16x16x32_bf16 v[40:43], v[220:223], a[72:75], 0
    v_cvt_pk_bf16_f32 v224, v208, v209
    v_exp_f32 v210, v210
    v_mfma_f32_16x16x32_bf16 v[44:47], v[220:223], a[76:79], 0
    v_exp_f32 v211, v211
    v_mfma_f32_16x16x32_bf16 v[48:51], v[220:223], a[80:83], 0
    v_cvt_pk_bf16_f32 v225, v210, v211
    v_exp_f32 v212, v212
    v_mfma_f32_16x16x32_bf16 v[52:55], v[220:223], a[84:87], 0
    v_exp_f32 v213, v213
    v_mfma_f32_16x16x32_bf16 v[56:59], v[220:223], a[88:91], 0
    v_cvt_pk_bf16_f32 v226, v212, v213
    v_exp_f32 v214, v214
    v_mfma_f32_16x16x32_bf16 v[60:63], v[220:223], a[92:95], 0
    v_exp_f32 v215, v215
    v_mfma_f32_16x16x32_bf16 a[228:231], a[236:239], v[220:223], a[228:231]
    v_cvt_pk_bf16_f32 v227, v214, v215
    s_nop 1
    v_mfma_f32_16x16x32_bf16 v[32:35], v[224:227], a[96:99], v[32:35]
    v_mfma_f32_16x16x32_bf16 v[36:39], v[224:227], a[100:103], v[36:39]
    v_mfma_f32_16x16x32_bf16 v[40:43], v[224:227], a[104:107], v[40:43]
    v_mfma_f32_16x16x32_bf16 v[44:47], v[224:227], a[108:111], v[44:47]
    v_mfma_f32_16x16x32_bf16 v[48:51], v[224:227], a[112:115], v[48:51]
    v_mfma_f32_16x16x32_bf16 v[52:55], v[224:227], a[116:119], v[52:55]
    v_mfma_f32_16x16x32_bf16 v[56:59], v[224:227], a[120:123], v[56:59]
    v_mfma_f32_16x16x32_bf16 v[60:63], v[224:227], a[124:127], v[60:63]
    v_mfma_f32_16x16x32_bf16 a[228:231], a[236:239], v[224:227], a[228:231]
    s_waitcnt vmcnt(8)
    ds_read_b128 v[64:67], v251 offset:0
    ds_read_b128 v[68:71], v251 offset:512
    ds_read_b128 v[72:75], v251 offset:2048
    ds_read_b128 v[76:79], v251 offset:2560
    s_waitcnt lgkmcnt(0)
    s_add_u32 m0, s31, 0
    s_mov_b32 s48, 16384
    buffer_load_dwordx4 v234, s[12:15], s48 offen nt lds
    s_add_u32 m0, s31, 4096
    s_mov_b32 s48, 20480
    buffer_load_dwordx4 v234, s[12:15], s48 offen nt lds
    s_add_u32 m0, s31, 8192
    s_mov_b32 s48, 24576
    buffer_load_dwordx4 v234, s[12:15], s48 offen nt lds
    s_add_u32 m0, s31, 12288
    s_mov_b32 s48, 28672
    buffer_load_dwordx4 v234, s[12:15], s48 offen nt lds
    v_lshlrev_b32 v192, 16, v64
    v_and_b32 v193, s64, v64
    v_lshlrev_b32 v194, 16, v65
    v_and_b32 v195, s64, v65
    v_lshlrev_b32 v196, 16, v66
    v_and_b32 v197, s64, v66
    v_lshlrev_b32 v198, 16, v67
    v_and_b32 v199, s64, v67
    v_pk_mul_f32 v[192:193], v[192:193], s[60:61]
    v_pk_mul_f32 v[194:195], v[194:195], s[60:61]
    v_pk_mul_f32 v[196:197], v[196:197], s[60:61]
    v_pk_mul_f32 v[198:199], v[198:199], s[60:61]
    v_cvt_pk_bf16_f32 v64, v192, v193
    v_cvt_pk_bf16_f32 v65, v194, v195
    v_cvt_pk_bf16_f32 v66, v196, v197
    v_cvt_pk_bf16_f32 v67, v198, v199
    v_accvgpr_write_b32 a160, v64
    v_accvgpr_write_b32 a161, v65
    v_accvgpr_write_b32 a162, v66
    v_accvgpr_write_b32 a163, v67
    v_lshlrev_b32 v192, 16, v68
    v_and_b32 v193, s64, v68
    v_lshlrev_b32 v194, 16, v69
    v_and_b32 v195, s64, v69
    v_lshlrev_b32 v196, 16, v70
    v_and_b32 v197, s64, v70
    v_lshlrev_b32 v198, 16, v71
    v_and_b32 v199, s64, v71
    v_pk_mul_f32 v[192:193], v[192:193], s[60:61]
    v_pk_mul_f32 v[194:195], v[194:195], s[60:61]
    v_pk_mul_f32 v[196:197], v[196:197], s[60:61]
    v_pk_mul_f32 v[198:199], v[198:199], s[60:61]
    v_cvt_pk_bf16_f32 v68, v192, v193
    v_cvt_pk_bf16_f32 v69, v194, v195
    v_cvt_pk_bf16_f32 v70, v196, v197
    v_cvt_pk_bf16_f32 v71, v198, v199
    v_accvgpr_write_b32 a164, v68
    v_accvgpr_write_b32 a165, v69
    v_accvgpr_write_b32 a166, v70
    v_accvgpr_write_b32 a167, v71
    v_lshlrev_b32 v192, 16, v72
    v_and_b32 v193, s64, v72
    v_lshlrev_b32 v194, 16, v73
    v_and_b32 v195, s64, v73
    v_lshlrev_b32 v196, 16, v74
    v_and_b32 v197, s64, v74
    v_lshlrev_b32 v198, 16, v75
    v_and_b32 v199, s64, v75
    v_pk_mul_f32 v[192:193], v[192:193], s[60:61]
    v_pk_mul_f32 v[194:195], v[194:195], s[60:61]
    v_pk_mul_f32 v[196:197], v[196:197], s[60:61]
    v_pk_mul_f32 v[198:199], v[198:199], s[60:61]
    v_cvt_pk_bf16_f32 v72, v192, v193
    v_cvt_pk_bf16_f32 v73, v194, v195
    v_cvt_pk_bf16_f32 v74, v196, v197
    v_cvt_pk_bf16_f32 v75, v198, v199
    v_accvgpr_write_b32 a168, v72
    v_accvgpr_write_b32 a169, v73
    v_accvgpr_write_b32 a170, v74
    v_accvgpr_write_b32 a171, v75
    v_lshlrev_b32 v192, 16, v76
    v_and_b32 v193, s64, v76
    v_lshlrev_b32 v194, 16, v77
    v_and_b32 v195, s64, v77
    v_lshlrev_b32 v196, 16, v78
    v_and_b32 v197, s64, v78
    v_lshlrev_b32 v198, 16, v79
    v_and_b32 v199, s64, v79
    v_pk_mul_f32 v[192:193], v[192:193], s[60:61]
    v_pk_mul_f32 v[194:195], v[194:195], s[60:61]
    v_pk_mul_f32 v[196:197], v[196:197], s[60:61]
    v_pk_mul_f32 v[198:199], v[198:199], s[60:61]
    v_cvt_pk_bf16_f32 v76, v192, v193
    v_cvt_pk_bf16_f32 v77, v194, v195
    v_cvt_pk_bf16_f32 v78, v196, v197
    v_cvt_pk_bf16_f32 v79, v198, v199
    v_accvgpr_write_b32 a172, v76
    v_accvgpr_write_b32 a173, v77
    v_accvgpr_write_b32 a174, v78
    v_accvgpr_write_b32 a175, v79
    s_nop 1
    v_mfma_f32_16x16x32_bf16 v[200:203], a[0:3], a[160:163], v[252:255]
    v_mfma_f32_16x16x32_bf16 v[200:203], a[4:7], a[164:167], v[200:203]
    v_mfma_f32_16x16x32_bf16 v[200:203], a[8:11], a[168:171], v[200:203]
    v_mfma_f32_16x16x32_bf16 v[200:203], a[12:15], a[172:175], v[200:203]
    v_mfma_f32_16x16x32_bf16 v[204:207], a[16:19], a[160:163], v[252:255]
    v_mfma_f32_16x16x32_bf16 v[204:207], a[20:23], a[164:167], v[204:207]
    v_mfma_f32_16x16x32_bf16 v[204:207], a[24:27], a[168:171], v[204:207]
    v_mfma_f32_16x16x32_bf16 v[204:207], a[28:31], a[172:175], v[204:207]
    s_nop 2
    v_mfma_f32_16x16x32_bf16 v[208:211], a[32:35], a[160:163], v[252:255]
    v_exp_f32 v200, v200
    v_mfma_f32_16x16x32_bf16 v[208:211], a[36:39], a[164:167], v[208:211]
    v_add_f32 v238, v238, v200
    v_exp_f32 v201, v201
    v_mfma_f32_16x16x32_bf16 v[208:211], a[40:43], a[168:171], v[208:211]
    v_cvt_pk_bf16_f32 v220, v200, v201
    v_add_f32 v238, v238, v201
    v_exp_f32 v202, v202
    v_mfma_f32_16x16x32_bf16 v[208:211], a[44:47], a[172:175], v[208:211]
    v_add_f32 v238, v238, v202
    v_exp_f32 v203, v203
    v_mfma_f32_16x16x32_bf16 v[212:215], a[48:51], a[160:163], v[252:255]
    v_cvt_pk_bf16_f32 v221, v202, v203
    v_add_f32 v238, v238, v203
    v_exp_f32 v204, v204
    v_mfma_f32_16x16x32_bf16 v[212:215], a[52:55], a[164:167], v[212:215]
    v_add_f32 v238, v238, v204
    v_exp_f32 v205, v205
    v_mfma_f32_16x16x32_bf16 v[212:215], a[56:59], a[168:171], v[212:215]
    v_cvt_pk_bf16_f32 v222, v204, v205
    v_add_f32 v238, v238, v205
    v_exp_f32 v206, v206
    v_mfma_f32_16x16x32_bf16 v[212:215], a[60:63], a[172:175], v[212:215]
    v_add_f32 v238, v238, v206
    v_exp_f32 v207, v207
    s_nop 0
    v_cvt_pk_bf16_f32 v223, v206, v207
    v_add_f32 v238, v238, v207
    s_nop 1
    v_mfma_f32_16x16x32_bf16 v[64:67], v[220:223], a[64:67], 0
    v_exp_f32 v208, v208
    v_mfma_f32_16x16x32_bf16 v[68:71], v[220:223], a[68:71], 0
    v_add_f32 v238, v238, v208
    v_exp_f32 v209, v209
    v_mfma_f32_16x16x32_bf16 v[72:75], v[220:223], a[72:75], 0
    v_cvt_pk_bf16_f32 v224, v208, v209
    v_add_f32 v238, v238, v209
    v_exp_f32 v210, v210
    v_mfma_f32_16x16x32_bf16 v[76:79], v[220:223], a[76:79], 0
    v_add_f32 v238, v238, v210
    v_exp_f32 v211, v211
    v_mfma_f32_16x16x32_bf16 v[80:83], v[220:223], a[80:83], 0
    v_cvt_pk_bf16_f32 v225, v210, v211
    v_add_f32 v238, v238, v211
    v_exp_f32 v212, v212
    v_mfma_f32_16x16x32_bf16 v[84:87], v[220:223], a[84:87], 0
    v_add_f32 v238, v238, v212
    v_exp_f32 v213, v213
    v_mfma_f32_16x16x32_bf16 v[88:91], v[220:223], a[88:91], 0
    v_cvt_pk_bf16_f32 v226, v212, v213
    v_add_f32 v238, v238, v213
    v_exp_f32 v214, v214
    v_mfma_f32_16x16x32_bf16 v[92:95], v[220:223], a[92:95], 0
    v_add_f32 v238, v238, v214
    v_exp_f32 v215, v215
    s_nop 0
    v_cvt_pk_bf16_f32 v227, v214, v215
    v_add_f32 v238, v238, v215
    s_nop 1
    v_mfma_f32_16x16x32_bf16 v[64:67], v[224:227], a[96:99], v[64:67]
    v_mfma_f32_16x16x32_bf16 v[68:71], v[224:227], a[100:103], v[68:71]
    v_mfma_f32_16x16x32_bf16 v[72:75], v[224:227], a[104:107], v[72:75]
    v_mfma_f32_16x16x32_bf16 v[76:79], v[224:227], a[108:111], v[76:79]
    v_mfma_f32_16x16x32_bf16 v[80:83], v[224:227], a[112:115], v[80:83]
    v_mfma_f32_16x16x32_bf16 v[84:87], v[224:227], a[116:119], v[84:87]
    v_mfma_f32_16x16x32_bf16 v[88:91], v[224:227], a[120:123], v[88:91]
    v_mfma_f32_16x16x32_bf16 v[92:95], v[224:227], a[124:127], v[92:95]
    s_waitcnt vmcnt(8)
    ds_read_b128 v[96:99], v246 offset:0
    ds_read_b128 v[100:103], v246 offset:512
    ds_read_b128 v[104:107], v246 offset:2048
    ds_read_b128 v[108:111], v246 offset:2560
    s_waitcnt lgkmcnt(0)
    s_add_u32 m0, s31, 65536
    s_mov_b32 s48, 16384
    buffer_load_dwordx4 v235, s[16:19], s48 offen nt lds
    s_add_u32 m0, s31, 69632
    s_mov_b32 s48, 20480
    buffer_load_dwordx4 v235, s[16:19], s48 offen nt lds
    s_add_u32 m0, s31, 73728
    s_mov_b32 s48, 24576
    buffer_load_dwordx4 v235, s[16:19], s48 offen nt lds
    s_add_u32 m0, s31, 77824
    s_mov_b32 s48, 28672
    buffer_load_dwordx4 v235, s[16:19], s48 offen nt lds
    v_lshlrev_b32 v192, 16, v96
    v_and_b32 v193, s64, v96
    v_lshlrev_b32 v194, 16, v97
    v_and_b32 v195, s64, v97
    v_lshlrev_b32 v196, 16, v98
    v_and_b32 v197, s64, v98
    v_lshlrev_b32 v198, 16, v99
    v_and_b32 v199, s64, v99
    v_pk_mul_f32 v[192:193], v[192:193], s[60:61]
    v_pk_mul_f32 v[194:195], v[194:195], s[60:61]
    v_pk_mul_f32 v[196:197], v[196:197], s[60:61]
    v_pk_mul_f32 v[198:199], v[198:199], s[60:61]
    v_cvt_pk_bf16_f32 v96, v192, v193
    v_cvt_pk_bf16_f32 v97, v194, v195
    v_cvt_pk_bf16_f32 v98, v196, v197
    v_cvt_pk_bf16_f32 v99, v198, v199
    v_accvgpr_write_b32 a176, v96
    v_accvgpr_write_b32 a177, v97
    v_accvgpr_write_b32 a178, v98
    v_accvgpr_write_b32 a179, v99
    v_lshlrev_b32 v192, 16, v100
    v_and_b32 v193, s64, v100
    v_lshlrev_b32 v194, 16, v101
    v_and_b32 v195, s64, v101
    v_lshlrev_b32 v196, 16, v102
    v_and_b32 v197, s64, v102
    v_lshlrev_b32 v198, 16, v103
    v_and_b32 v199, s64, v103
    v_pk_mul_f32 v[192:193], v[192:193], s[60:61]
    v_pk_mul_f32 v[194:195], v[194:195], s[60:61]
    v_pk_mul_f32 v[196:197], v[196:197], s[60:61]
    v_pk_mul_f32 v[198:199], v[198:199], s[60:61]
    v_cvt_pk_bf16_f32 v100, v192, v193
    v_cvt_pk_bf16_f32 v101, v194, v195
    v_cvt_pk_bf16_f32 v102, v196, v197
    v_cvt_pk_bf16_f32 v103, v198, v199
    v_accvgpr_write_b32 a180, v100
    v_accvgpr_write_b32 a181, v101
    v_accvgpr_write_b32 a182, v102
    v_accvgpr_write_b32 a183, v103
    v_lshlrev_b32 v192, 16, v104
    v_and_b32 v193, s64, v104
    v_lshlrev_b32 v194, 16, v105
    v_and_b32 v195, s64, v105
    v_lshlrev_b32 v196, 16, v106
    v_and_b32 v197, s64, v106
    v_lshlrev_b32 v198, 16, v107
    v_and_b32 v199, s64, v107
    v_pk_mul_f32 v[192:193], v[192:193], s[60:61]
    v_pk_mul_f32 v[194:195], v[194:195], s[60:61]
    v_pk_mul_f32 v[196:197], v[196:197], s[60:61]
    v_pk_mul_f32 v[198:199], v[198:199], s[60:61]
    v_cvt_pk_bf16_f32 v104, v192, v193
    v_cvt_pk_bf16_f32 v105, v194, v195
    v_cvt_pk_bf16_f32 v106, v196, v197
    v_cvt_pk_bf16_f32 v107, v198, v199
    v_accvgpr_write_b32 a184, v104
    v_accvgpr_write_b32 a185, v105
    v_accvgpr_write_b32 a186, v106
    v_accvgpr_write_b32 a187, v107
    v_lshlrev_b32 v192, 16, v108
    v_and_b32 v193, s64, v108
    v_lshlrev_b32 v194, 16, v109
    v_and_b32 v195, s64, v109
    v_lshlrev_b32 v196, 16, v110
    v_and_b32 v197, s64, v110
    v_lshlrev_b32 v198, 16, v111
    v_and_b32 v199, s64, v111
    v_pk_mul_f32 v[192:193], v[192:193], s[60:61]
    v_pk_mul_f32 v[194:195], v[194:195], s[60:61]
    v_pk_mul_f32 v[196:197], v[196:197], s[60:61]
    v_pk_mul_f32 v[198:199], v[198:199], s[60:61]
    v_cvt_pk_bf16_f32 v108, v192, v193
    v_cvt_pk_bf16_f32 v109, v194, v195
    v_cvt_pk_bf16_f32 v110, v196, v197
    v_cvt_pk_bf16_f32 v111, v198, v199
    v_accvgpr_write_b32 a188, v108
    v_accvgpr_write_b32 a189, v109
    v_accvgpr_write_b32 a190, v110
    v_accvgpr_write_b32 a191, v111
    s_nop 1
    v_mfma_f32_16x16x32_bf16 v[200:203], a[0:3], a[176:179], v[252:255]
    v_mfma_f32_16x16x32_bf16 v[200:203], a[4:7], a[180:183], v[200:203]
    v_mfma_f32_16x16x32_bf16 v[200:203], a[8:11], a[184:187], v[200:203]
    v_mfma_f32_16x16x32_bf16 v[200:203], a[12:15], a[188:191], v[200:203]
    v_mfma_f32_16x16x32_bf16 v[204:207], a[16:19], a[176:179], v[252:255]
    v_mfma_f32_16x16x32_bf16 v[204:207], a[20:23], a[180:183], v[204:207]
    v_mfma_f32_16x16x32_bf16 v[204:207], a[24:27], a[184:187], v[204:207]
    v_mfma_f32_16x16x32_bf16 v[204:207], a[28:31], a[188:191], v[204:207]
    s_nop 2
    v_mfma_f32_16x16x32_bf16 v[208:211], a[32:35], a[176:179], v[252:255]
    v_exp_f32 v200, v200
    v_mfma_f32_16x16x32_bf16 v[208:211], a[36:39], a[180:183], v[208:211]
    v_add_f32 v239, v239, v200
    v_exp_f32 v201, v201
    v_mfma_f32_16x16x32_bf16 v[208:211], a[40:43], a[184:187], v[208:211]
    v_cvt_pk_bf16_f32 v220, v200, v201
    v_add_f32 v239, v239, v201
    v_exp_f32 v202, v202
    v_mfma_f32_16x16x32_bf16 v[208:211], a[44:47], a[188:191], v[208:211]
    v_add_f32 v239, v239, v202
    v_exp_f32 v203, v203
    v_mfma_f32_16x16x32_bf16 v[212:215], a[48:51], a[176:179], v[252:255]
    v_cvt_pk_bf16_f32 v221, v202, v203
    v_add_f32 v239, v239, v203
    v_exp_f32 v204, v204
    v_mfma_f32_16x16x32_bf16 v[212:215], a[52:55], a[180:183], v[212:215]
    v_add_f32 v239, v239, v204
    v_exp_f32 v205, v205
    v_mfma_f32_16x16x32_bf16 v[212:215], a[56:59], a[184:187], v[212:215]
    v_cvt_pk_bf16_f32 v222, v204, v205
    v_add_f32 v239, v239, v205
    v_exp_f32 v206, v206
    v_mfma_f32_16x16x32_bf16 v[212:215], a[60:63], a[188:191], v[212:215]
    v_add_f32 v239, v239, v206
    v_exp_f32 v207, v207
    s_nop 0
    v_cvt_pk_bf16_f32 v223, v206, v207
    v_add_f32 v239, v239, v207
    s_nop 1
    v_mfma_f32_16x16x32_bf16 v[96:99], v[220:223], a[64:67], 0
    v_exp_f32 v208, v208
    v_mfma_f32_16x16x32_bf16 v[100:103], v[220:223], a[68:71], 0
    v_add_f32 v239, v239, v208
    v_exp_f32 v209, v209
    v_mfma_f32_16x16x32_bf16 v[104:107], v[220:223], a[72:75], 0
    v_cvt_pk_bf16_f32 v224, v208, v209
    v_add_f32 v239, v239, v209
    v_exp_f32 v210, v210
    v_mfma_f32_16x16x32_bf16 v[108:111], v[220:223], a[76:79], 0
    v_add_f32 v239, v239, v210
    v_exp_f32 v211, v211
    v_mfma_f32_16x16x32_bf16 v[112:115], v[220:223], a[80:83], 0
    v_cvt_pk_bf16_f32 v225, v210, v211
    v_add_f32 v239, v239, v211
    v_exp_f32 v212, v212
    v_mfma_f32_16x16x32_bf16 v[116:119], v[220:223], a[84:87], 0
    v_add_f32 v239, v239, v212
    v_exp_f32 v213, v213
    v_mfma_f32_16x16x32_bf16 v[120:123], v[220:223], a[88:91], 0
    v_cvt_pk_bf16_f32 v226, v212, v213
    v_add_f32 v239, v239, v213
    v_exp_f32 v214, v214
    v_mfma_f32_16x16x32_bf16 v[124:127], v[220:223], a[92:95], 0
    v_add_f32 v239, v239, v214
    v_exp_f32 v215, v215
    s_nop 0
    v_cvt_pk_bf16_f32 v227, v214, v215
    v_add_f32 v239, v239, v215
    s_nop 1
    v_mfma_f32_16x16x32_bf16 v[96:99], v[224:227], a[96:99], v[96:99]
    v_mfma_f32_16x16x32_bf16 v[100:103], v[224:227], a[100:103], v[100:103]
    v_mfma_f32_16x16x32_bf16 v[104:107], v[224:227], a[104:107], v[104:107]
    v_mfma_f32_16x16x32_bf16 v[108:111], v[224:227], a[108:111], v[108:111]
    v_mfma_f32_16x16x32_bf16 v[112:115], v[224:227], a[112:115], v[112:115]
    v_mfma_f32_16x16x32_bf16 v[116:119], v[224:227], a[116:119], v[116:119]
    v_mfma_f32_16x16x32_bf16 v[120:123], v[224:227], a[120:123], v[120:123]
    v_mfma_f32_16x16x32_bf16 v[124:127], v[224:227], a[124:127], v[124:127]
    s_waitcnt vmcnt(8)
    ds_read_b128 v[128:131], v246 offset:4096
    ds_read_b128 v[132:135], v246 offset:4608
    ds_read_b128 v[136:139], v246 offset:6144
    ds_read_b128 v[140:143], v246 offset:6656
    s_waitcnt lgkmcnt(0)
    s_add_u32 m0, s31, 16384
    s_mov_b32 s48, 32768
    buffer_load_dwordx4 v234, s[12:15], s48 offen nt lds
    s_add_u32 m0, s31, 20480
    s_mov_b32 s48, 36864
    buffer_load_dwordx4 v234, s[12:15], s48 offen nt lds
    s_add_u32 m0, s31, 24576
    s_mov_b32 s48, 40960
    buffer_load_dwordx4 v234, s[12:15], s48 offen nt lds
    s_add_u32 m0, s31, 28672
    s_mov_b32 s48, 45056
    buffer_load_dwordx4 v234, s[12:15], s48 offen nt lds
    v_lshlrev_b32 v192, 16, v128
    v_and_b32 v193, s64, v128
    v_lshlrev_b32 v194, 16, v129
    v_and_b32 v195, s64, v129
    v_lshlrev_b32 v196, 16, v130
    v_and_b32 v197, s64, v130
    v_lshlrev_b32 v198, 16, v131
    v_and_b32 v199, s64, v131
    v_pk_mul_f32 v[192:193], v[192:193], s[60:61]
    v_pk_mul_f32 v[194:195], v[194:195], s[60:61]
    v_pk_mul_f32 v[196:197], v[196:197], s[60:61]
    v_pk_mul_f32 v[198:199], v[198:199], s[60:61]
    v_cvt_pk_bf16_f32 v128, v192, v193
    v_cvt_pk_bf16_f32 v129, v194, v195
    v_cvt_pk_bf16_f32 v130, v196, v197
    v_cvt_pk_bf16_f32 v131, v198, v199
    v_accvgpr_write_b32 a192, v128
    v_accvgpr_write_b32 a193, v129
    v_accvgpr_write_b32 a194, v130
    v_accvgpr_write_b32 a195, v131
    v_lshlrev_b32 v192, 16, v132
    v_and_b32 v193, s64, v132
    v_lshlrev_b32 v194, 16, v133
    v_and_b32 v195, s64, v133
    v_lshlrev_b32 v196, 16, v134
    v_and_b32 v197, s64, v134
    v_lshlrev_b32 v198, 16, v135
    v_and_b32 v199, s64, v135
    v_pk_mul_f32 v[192:193], v[192:193], s[60:61]
    v_pk_mul_f32 v[194:195], v[194:195], s[60:61]
    v_pk_mul_f32 v[196:197], v[196:197], s[60:61]
    v_pk_mul_f32 v[198:199], v[198:199], s[60:61]
    v_cvt_pk_bf16_f32 v132, v192, v193
    v_cvt_pk_bf16_f32 v133, v194, v195
    v_cvt_pk_bf16_f32 v134, v196, v197
    v_cvt_pk_bf16_f32 v135, v198, v199
    v_accvgpr_write_b32 a196, v132
    v_accvgpr_write_b32 a197, v133
    v_accvgpr_write_b32 a198, v134
    v_accvgpr_write_b32 a199, v135
    v_lshlrev_b32 v192, 16, v136
    v_and_b32 v193, s64, v136
    v_lshlrev_b32 v194, 16, v137
    v_and_b32 v195, s64, v137
    v_lshlrev_b32 v196, 16, v138
    v_and_b32 v197, s64, v138
    v_lshlrev_b32 v198, 16, v139
    v_and_b32 v199, s64, v139
    v_pk_mul_f32 v[192:193], v[192:193], s[60:61]
    v_pk_mul_f32 v[194:195], v[194:195], s[60:61]
    v_pk_mul_f32 v[196:197], v[196:197], s[60:61]
    v_pk_mul_f32 v[198:199], v[198:199], s[60:61]
    v_cvt_pk_bf16_f32 v136, v192, v193
    v_cvt_pk_bf16_f32 v137, v194, v195
    v_cvt_pk_bf16_f32 v138, v196, v197
    v_cvt_pk_bf16_f32 v139, v198, v199
    v_accvgpr_write_b32 a200, v136
    v_accvgpr_write_b32 a201, v137
    v_accvgpr_write_b32 a202, v138
    v_accvgpr_write_b32 a203, v139
    v_lshlrev_b32 v192, 16, v140
    v_and_b32 v193, s64, v140
    v_lshlrev_b32 v194, 16, v141
    v_and_b32 v195, s64, v141
    v_lshlrev_b32 v196, 16, v142
    v_and_b32 v197, s64, v142
    v_lshlrev_b32 v198, 16, v143
    v_and_b32 v199, s64, v143
    v_pk_mul_f32 v[192:193], v[192:193], s[60:61]
    v_pk_mul_f32 v[194:195], v[194:195], s[60:61]
    v_pk_mul_f32 v[196:197], v[196:197], s[60:61]
    v_pk_mul_f32 v[198:199], v[198:199], s[60:61]
    v_cvt_pk_bf16_f32 v140, v192, v193
    v_cvt_pk_bf16_f32 v141, v194, v195
    v_cvt_pk_bf16_f32 v142, v196, v197
    v_cvt_pk_bf16_f32 v143, v198, v199
    v_accvgpr_write_b32 a204, v140
    v_accvgpr_write_b32 a205, v141
    v_accvgpr_write_b32 a206, v142
    v_accvgpr_write_b32 a207, v143
    s_nop 1
    v_mfma_f32_16x16x32_bf16 v[200:203], a[0:3], a[192:195], v[252:255]
    v_mfma_f32_16x16x32_bf16 v[200:203], a[4:7], a[196:199], v[200:203]
    v_mfma_f32_16x16x32_bf16 v[200:203], a[8:11], a[200:203], v[200:203]
    v_mfma_f32_16x16x32_bf16 v[200:203], a[12:15], a[204:207], v[200:203]
    v_mfma_f32_16x16x32_bf16 v[204:207], a[16:19], a[192:195], v[252:255]
    v_mfma_f32_16x16x32_bf16 v[204:207], a[20:23], a[196:199], v[204:207]
    v_mfma_f32_16x16x32_bf16 v[204:207], a[24:27], a[200:203], v[204:207]
    v_mfma_f32_16x16x32_bf16 v[204:207], a[28:31], a[204:207], v[204:207]
    s_nop 2
    v_mfma_f32_16x16x32_bf16 v[208:211], a[32:35], a[192:195], v[252:255]
    v_exp_f32 v200, v200
    v_mfma_f32_16x16x32_bf16 v[208:211], a[36:39], a[196:199], v[208:211]
    v_add_f32 v240, v240, v200
    v_exp_f32 v201, v201
    v_mfma_f32_16x16x32_bf16 v[208:211], a[40:43], a[200:203], v[208:211]
    v_cvt_pk_bf16_f32 v220, v200, v201
    v_add_f32 v240, v240, v201
    v_exp_f32 v202, v202
    v_mfma_f32_16x16x32_bf16 v[208:211], a[44:47], a[204:207], v[208:211]
    v_add_f32 v240, v240, v202
    v_exp_f32 v203, v203
    v_mfma_f32_16x16x32_bf16 v[212:215], a[48:51], a[192:195], v[252:255]
    v_cvt_pk_bf16_f32 v221, v202, v203
    v_add_f32 v240, v240, v203
    v_exp_f32 v204, v204
    v_mfma_f32_16x16x32_bf16 v[212:215], a[52:55], a[196:199], v[212:215]
    v_add_f32 v240, v240, v204
    v_exp_f32 v205, v205
    v_mfma_f32_16x16x32_bf16 v[212:215], a[56:59], a[200:203], v[212:215]
    v_cvt_pk_bf16_f32 v222, v204, v205
    v_add_f32 v240, v240, v205
    v_exp_f32 v206, v206
    v_mfma_f32_16x16x32_bf16 v[212:215], a[60:63], a[204:207], v[212:215]
    v_add_f32 v240, v240, v206
    v_exp_f32 v207, v207
    s_nop 0
    v_cvt_pk_bf16_f32 v223, v206, v207
    v_add_f32 v240, v240, v207
    s_nop 1
    v_mfma_f32_16x16x32_bf16 v[128:131], v[220:223], a[64:67], 0
    v_exp_f32 v208, v208
    v_mfma_f32_16x16x32_bf16 v[132:135], v[220:223], a[68:71], 0
    v_add_f32 v240, v240, v208
    v_exp_f32 v209, v209
    v_mfma_f32_16x16x32_bf16 v[136:139], v[220:223], a[72:75], 0
    v_cvt_pk_bf16_f32 v216, v208, v209
    v_add_f32 v240, v240, v209
    v_exp_f32 v210, v210
    v_mfma_f32_16x16x32_bf16 v[140:143], v[220:223], a[76:79], 0
    v_add_f32 v240, v240, v210
    v_exp_f32 v211, v211
    v_mfma_f32_16x16x32_bf16 v[144:147], v[220:223], a[80:83], 0
    v_cvt_pk_bf16_f32 v217, v210, v211
    v_add_f32 v240, v240, v211
    v_exp_f32 v212, v212
    v_mfma_f32_16x16x32_bf16 v[148:151], v[220:223], a[84:87], 0
    v_add_f32 v240, v240, v212
    v_exp_f32 v213, v213
    v_mfma_f32_16x16x32_bf16 v[152:155], v[220:223], a[88:91], 0
    v_cvt_pk_bf16_f32 v218, v212, v213
    v_add_f32 v240, v240, v213
    v_exp_f32 v214, v214
    v_mfma_f32_16x16x32_bf16 v[156:159], v[220:223], a[92:95], 0
    v_add_f32 v240, v240, v214
    v_exp_f32 v215, v215
    s_nop 0
    v_cvt_pk_bf16_f32 v219, v214, v215
    v_add_f32 v240, v240, v215
    s_add_u32 m0, s31, 81920
    s_mov_b32 s48, 32768
    buffer_load_dwordx4 v235, s[16:19], s48 offen nt lds
    s_add_u32 m0, s31, 86016
    s_mov_b32 s48, 36864
    buffer_load_dwordx4 v235, s[16:19], s48 offen nt lds
    s_add_u32 m0, s31, 90112
    s_mov_b32 s48, 40960
    buffer_load_dwordx4 v235, s[16:19], s48 offen nt lds
    s_add_u32 m0, s31, 94208
    s_mov_b32 s48, 45056
    buffer_load_dwordx4 v235, s[16:19], s48 offen nt lds
    v_mov_b32 v244, 0
    v_mov_b32 v248, 0
    v_mov_b32 v245, 0
    v_mov_b32 v249, 0
    v_mov_b32 v246, 0
    v_mov_b32 v250, 0
    v_mov_b32 v247, 0
    v_mov_b32 v251, 0
    s_waitcnt vmcnt(8) lgkmcnt(0)
    s_barrier
    ds_read_b128 a[0:3], v228 offset:0
    ds_read_b128 a[4:7], v228 offset:512
    ds_read_b128 a[8:11], v228 offset:2048
    ds_read_b128 a[12:15], v228 offset:2560
    ds_read_b128 a[16:19], v228 offset:4096
    ds_read_b128 a[20:23], v228 offset:4608
    ds_read_b128 a[24:27], v228 offset:6144
    ds_read_b128 a[28:31], v228 offset:6656
    ds_read_b64_tr_b16 a[64:65], v230 offset:0
    ds_read_b64_tr_b16 a[66:67], v230 offset:4096
    ds_read_b64_tr_b16 a[68:69], v231 offset:0
    ds_read_b64_tr_b16 a[70:71], v231 offset:4096
    ds_read_b64_tr_b16 a[72:73], v230 offset:512
    ds_read_b64_tr_b16 a[74:75], v230 offset:4608
    ds_read_b64_tr_b16 a[76:77], v231 offset:512
    ds_read_b64_tr_b16 a[78:79], v231 offset:4608
    ds_read_b64_tr_b16 a[80:81], v230 offset:1024
    ds_read_b64_tr_b16 a[82:83], v230 offset:5120
    ds_read_b64_tr_b16 a[84:85], v231 offset:1024
    ds_read_b64_tr_b16 a[86:87], v231 offset:5120
    ds_read_b64_tr_b16 a[88:89], v230 offset:1536
    ds_read_b64_tr_b16 a[90:91], v230 offset:5632
    ds_read_b64_tr_b16 a[92:93], v231 offset:1536
    ds_read_b64_tr_b16 a[94:95], v231 offset:5632
    s_add_u32 m0, s31, 32768
    s_mov_b32 s48, 49152
    buffer_load_dwordx4 v234, s[12:15], s48 offen nt lds
    s_add_u32 m0, s31, 36864
    s_mov_b32 s48, 53248
    buffer_load_dwordx4 v234, s[12:15], s48 offen nt lds
    s_add_u32 m0, s31, 40960
    s_mov_b32 s48, 57344
    buffer_load_dwordx4 v234, s[12:15], s48 offen nt lds
    s_add_u32 m0, s31, 45056
    s_mov_b32 s48, 61440
    buffer_load_dwordx4 v234, s[12:15], s48 offen nt lds
    s_mov_b32 s30, 49152
    s_add_u32 s31, s31, 32768
    s_waitcnt lgkmcnt(15)
    s_cmp_ge_u32 s28, 2
    s_cbranch_scc1 L_cls1
    v_mfma_f32_16x16x32_bf16 v[192:195], a[0:3], a[144:147], v[252:255]
    v_mfma_f32_16x16x32_bf16 v[192:195], a[4:7], a[148:151], v[192:195]
    v_mfma_f32_16x16x32_bf16 v[192:195], a[8:11], a[152:155], v[192:195]
    v_mfma_f32_16x16x32_bf16 v[192:195], a[12:15], a[156:159], v[192:195]
    v_mfma_f32_16x16x32_bf16 v[196:199], a[16:19], a[144:147], v[252:255]
    v_mfma_f32_16x16x32_bf16 v[196:199], a[20:23], a[148:151], v[196:199]
    v_mfma_f32_16x16x32_bf16 v[196:199], a[24:27], a[152:155], v[196:199]
    v_mfma_f32_16x16x32_bf16 v[196:199], a[28:31], a[156:159], v[196:199]
    s_nop 7
    s_mov_b32 s29, 15
    s_branch L_mid0
    .p2align 6
L_loop0:
    s_add_u32 s48, s30, 8192
    v_mfma_f32_16x16x32_bf16 v[208:211], a[32:35], a[192:195], v[252:255]
    s_add_u32 m0, s31, 8192
    v_exp_f32 v200, v200
    v_mfma_f32_16x16x32_bf16 v[208:211], a[36:39], a[196:199], v[208:211]
    buffer_load_dwordx4 v234, s[12:15], s48 offen nt lds
    v_mfma_f32_16x16x32_bf16 v[208:211], a[40:43], a[200:203], v[208:211]
    v_exp_f32 v201, v201
    v_mfma_f32_16x16x32_bf16 v[208:211], a[44:47], a[204:207], v[208:211]
    s_add_u32 s48, s30, 12288
    ds_read_b64_tr_b16 a[82:83], v230 offset:5120
    v_cvt_pk_bf16_f32 v220, v200, v201
    v_mfma_f32_16x16x32_bf16 v[212:215], a[48:51], a[192:195], v[252:255]
    s_add_u32 m0, s31, 12288
    v_exp_f32 v202, v202
    v_mfma_f32_16x16x32_bf16 v[212:215], a[52:55], a[196:199], v[212:215]
    buffer_load_dwordx4 v234, s[12:15], s48 offen nt lds
    v_mfma_f32_16x16x32_bf16 v[212:215], a[56:59], a[200:203], v[212:215]
    v_exp_f32 v203, v203
    v_mfma_f32_16x16x32_bf16 v[212:215], a[60:63], a[204:207], v[212:215]
    ds_read_b128 a[24:27], v228 offset:6144
    v_cvt_pk_bf16_f32 v221, v202, v203
    v_mfma_f32_16x16x32_bf16 v[64:67], v[224:227], a[96:99], v[64:67]
    v_exp_f32 v204, v204
    v_mfma_f32_16x16x32_bf16 v[68:71], v[224:227], a[100:103], v[68:71]
    ds_read_b128 a[28:31], v228 offset:6656
    ds_read_b64_tr_b16 a[84:85], v231 offset:1024
    v_mfma_f32_16x16x32_bf16 v[72:75], v[224:227], a[104:107], v[72:75]
    v_exp_f32 v205, v205
    v_mfma_f32_16x16x32_bf16 v[76:79], v[224:227], a[108:111], v[76:79]
    v_cvt_pk_bf16_f32 v222, v204, v205
    v_xor_b32 v233, 0x8000, v233
    v_mfma_f32_16x16x32_bf16 v[80:83], v[224:227], a[112:115], v[80:83]
    v_exp_f32 v206, v206
    v_mfma_f32_16x16x32_bf16 v[84:87], v[224:227], a[116:119], v[84:87]
    ds_read_b64_tr_b16 a[86:87], v231 offset:5120
    v_mfma_f32_16x16x32_bf16 v[88:91], v[224:227], a[120:123], v[88:91]
    v_exp_f32 v207, v207
    v_mfma_f32_16x16x32_bf16 v[92:95], v[224:227], a[124:127], v[92:95]
    s_waitcnt lgkmcnt(2)
    ds_read_b64_tr_b16 a[88:89], v230 offset:1536
    v_cvt_pk_bf16_f32 v223, v206, v207
    v_mfma_f32_16x16x32_bf16 v[192:195], a[0:3], a[144:147], v[252:255]
    v_exp_f32 v208, v208
    v_mfma_f32_16x16x32_bf16 v[192:195], a[4:7], a[148:151], v[192:195]
    v_add_f32 v240, v240, v208
    v_mfma_f32_16x16x32_bf16 v[192:195], a[8:11], a[152:155], v[192:195]
    v_exp_f32 v209, v209
    v_mfma_f32_16x16x32_bf16 v[192:195], a[12:15], a[156:159], v[192:195]
    v_cvt_pk_bf16_f32 v216, v208, v209
    v_add_f32 v240, v240, v209
    v_mfma_f32_16x16x32_bf16 v[196:199], a[16:19], a[144:147], v[252:255]
    v_exp_f32 v210, v210
    v_mfma_f32_16x16x32_bf16 v[196:199], a[20:23], a[148:151], v[196:199]
    ds_read_b64_tr_b16 a[90:91], v230 offset:5632
    v_add_f32 v240, v240, v210
    v_mfma_f32_16x16x32_bf16 v[196:199], a[24:27], a[152:155], v[196:199]
    v_exp_f32 v211, v211
    v_mfma_f32_16x16x32_bf16 v[196:199], a[28:31], a[156:159], v[196:199]
    v_cvt_pk_bf16_f32 v217, v210, v211
    v_add_f32 v240, v240, v211
    v_mfma_f32_16x16x32_bf16 v[96:99], v[220:223], a[96:99], v[96:99]
    v_exp_f32 v212, v212
    v_mfma_f32_16x16x32_bf16 v[100:103], v[220:223], a[100:103], v[100:103]
    ds_read_b64_tr_b16 a[92:93], v231 offset:1536
    v_add_f32 v240, v240, v212
    v_mfma_f32_16x16x32_bf16 v[104:107], v[220:223], a[104:107], v[104:107]
    v_exp_f32 v213, v213
    v_mfma_f32_16x16x32_bf16 v[108:111], v[220:223], a[108:111], v[108:111]
    v_cvt_pk_bf16_f32 v218, v212, v213
    v_add_f32 v240, v240, v213
    v_mfma_f32_16x16x32_bf16 v[112:115], v[220:223], a[112:115], v[112:115]
    v_exp_f32 v214, v214
    v_mfma_f32_16x16x32_bf16 v[116:119], v[220:223], a[116:119], v[116:119]
    v_add_f32 v240, v240, v214
    v_mfma_f32_16x16x32_bf16 v[120:123], v[220:223], a[120:123], v[120:123]
    v_exp_f32 v215, v215
    v_mfma_f32_16x16x32_bf16 v[124:127], v[220:223], a[124:127], v[124:127]
    v_cvt_pk_bf16_f32 v219, v214, v215
    v_add_f32 v240, v240, v215
    v_smfmac_f32_16x16x64_bf16 v[248:251], a[252:255], v[220:227], v243
    ds_read_b64_tr_b16 a[94:95], v231 offset:5632
L_mid0:
    v_mfma_f32_16x16x32_bf16 v[200:203], a[0:3], a[128:131], v[252:255]
    v_exp_f32 v192, v192
    v_mfma_f32_16x16x32_bf16 v[200:203], a[4:7], a[132:135], v[200:203]
    v_mfma_f32_16x16x32_bf16 v[200:203], a[8:11], a[136:139], v[200:203]
    v_exp_f32 v193, v193
    v_mfma_f32_16x16x32_bf16 v[200:203], a[12:15], a[140:143], v[200:203]
    ds_read_b128 a[32:35], v229 offset:0
    v_cvt_pk_bf16_f32 v220, v192, v193
    v_mfma_f32_16x16x32_bf16 v[204:207], a[16:19], a[128:131], v[252:255]
    v_exp_f32 v194, v194
    v_mfma_f32_16x16x32_bf16 v[204:207], a[20:23], a[132:135], v[204:207]
    v_mfma_f32_16x16x32_bf16 v[204:207], a[24:27], a[136:139], v[204:207]
    v_exp_f32 v195, v195
    v_mfma_f32_16x16x32_bf16 v[204:207], a[28:31], a[140:143], v[204:207]
    ds_read_b128 a[36:39], v229 offset:512
    v_cvt_pk_bf16_f32 v221, v194, v195
    v_mfma_f32_16x16x32_bf16 v[128:131], v[216:219], a[96:99], v[128:131]
    v_exp_f32 v196, v196
    v_mfma_f32_16x16x32_bf16 v[132:135], v[216:219], a[100:103], v[132:135]
    v_mfma_f32_16x16x32_bf16 v[136:139], v[216:219], a[104:107], v[136:139]
    v_exp_f32 v197, v197
    v_mfma_f32_16x16x32_bf16 v[140:143], v[216:219], a[108:111], v[140:143]
    v_cvt_pk_bf16_f32 v222, v196, v197
    v_mfma_f32_16x16x32_bf16 v[144:147], v[216:219], a[112:115], v[144:147]
    v_exp_f32 v198, v198
    v_mfma_f32_16x16x32_bf16 v[148:151], v[216:219], a[116:119], v[148:151]
    v_mfma_f32_16x16x32_bf16 v[152:155], v[216:219], a[120:123], v[152:155]
    v_exp_f32 v199, v199
    v_mfma_f32_16x16x32_bf16 v[156:159], v[216:219], a[124:127], v[156:159]
    s_add_u32 s48, s30, 0
    v_cvt_pk_bf16_f32 v223, v198, v199
    v_mfma_f32_16x16x32_bf16 v[208:211], a[0:3], a[160:163], v[252:255]
    s_add_u32 m0, s31, 65536
    v_exp_f32 v200, v200
    v_mfma_f32_16x16x32_bf16 v[208:211], a[4:7], a[164:167], v[208:211]
    buffer_load_dwordx4 v235, s[16:19], s48 offen nt lds
    v_mfma_f32_16x16x32_bf16 v[208:211], a[8:11], a[168:171], v[208:211]
    v_exp_f32 v201, v201
    v_mfma_f32_16x16x32_bf16 v[208:211], a[12:15], a[172:175], v[208:211]
    ds_read_b64_tr_b16 a[96:97], v232 offset:0
    v_cvt_pk_bf16_f32 v216, v200, v201
    v_mfma_f32_16x16x32_bf16 v[212:215], a[16:19], a[160:163], v[252:255]
    v_exp_f32 v202, v202
    v_mfma_f32_16x16x32_bf16 v[212:215], a[20:23], a[164:167], v[212:215]
    ds_read_b128 a[40:43], v229 offset:2048
    ds_read_b64_tr_b16 a[98:99], v232 offset:4096
    v_mfma_f32_16x16x32_bf16 v[212:215], a[24:27], a[168:171], v[212:215]
    v_exp_f32 v203, v203
    v_mfma_f32_16x16x32_bf16 v[212:215], a[28:31], a[172:175], v[212:215]
    s_waitcnt lgkmcnt(5)
    s_add_u32 s48, s30, 4096
    v_cvt_pk_bf16_f32 v217, v202, v203
    v_mfma_f32_16x16x32_bf16 v[32:35], v[220:223], a[64:67], v[32:35]
    s_add_u32 m0, s31, 69632
    v_exp_f32 v204, v204
    v_mfma_f32_16x16x32_bf16 v[36:39], v[220:223], a[68:71], v[36:39]
    buffer_load_dwordx4 v235, s[16:19], s48 offen nt lds
    v_mfma_f32_16x16x32_bf16 v[40:43], v[220:223], a[72:75], v[40:43]
    v_exp_f32 v205, v205
    v_mfma_f32_16x16x32_bf16 v[44:47], v[220:223], a[76:79], v[44:47]
    ds_read_b64_tr_b16 a[100:101], v233 offset:0
    v_cvt_pk_bf16_f32 v218, v204, v205
    v_mfma_f32_16x16x32_bf16 v[48:51], v[220:223], a[80:83], v[48:51]
    v_exp_f32 v206, v206
    v_mfma_f32_16x16x32_bf16 v[52:55], v[220:223], a[84:87], v[52:55]
    ds_read_b128 a[44:47], v229 offset:2560
    v_mfma_f32_16x16x32_bf16 v[56:59], v[220:223], a[88:91], v[56:59]
    v_exp_f32 v207, v207
    v_mfma_f32_16x16x32_bf16 v[60:63], v[220:223], a[92:95], v[60:63]
    ds_read_b64_tr_b16 a[102:103], v233 offset:4096
    v_cvt_pk_bf16_f32 v219, v206, v207
    v_mfma_f32_16x16x32_bf16 v[192:195], a[0:3], a[176:179], v[252:255]
    v_exp_f32 v208, v208
    v_mfma_f32_16x16x32_bf16 v[192:195], a[4:7], a[180:183], v[192:195]
    ds_read_b128 a[48:51], v229 offset:4096
    v_mfma_f32_16x16x32_bf16 v[192:195], a[8:11], a[184:187], v[192:195]
    v_exp_f32 v209, v209
    v_mfma_f32_16x16x32_bf16 v[192:195], a[12:15], a[188:191], v[192:195]
    s_add_u32 s48, s30, 8192
    ds_read_b64_tr_b16 a[104:105], v232 offset:512
    v_cvt_pk_bf16_f32 v224, v208, v209
    v_mfma_f32_16x16x32_bf16 v[196:199], a[16:19], a[176:179], v[252:255]
    s_add_u32 m0, s31, 73728
    v_exp_f32 v210, v210
    v_mfma_f32_16x16x32_bf16 v[196:199], a[20:23], a[180:183], v[196:199]
    buffer_load_dwordx4 v235, s[16:19], s48 offen nt lds
    v_mfma_f32_16x16x32_bf16 v[196:199], a[24:27], a[184:187], v[196:199]
    v_exp_f32 v211, v211
    v_mfma_f32_16x16x32_bf16 v[196:199], a[28:31], a[188:191], v[196:199]
    v_cvt_pk_bf16_f32 v225, v210, v211
    v_mfma_f32_16x16x32_bf16 v[0:3], v[216:219], a[64:67], v[0:3]
    v_exp_f32 v212, v212
    v_mfma_f32_16x16x32_bf16 v[4:7], v[216:219], a[68:71], v[4:7]
    ds_read_b128 a[52:55], v229 offset:4608
    v_mfma_f32_16x16x32_bf16 v[8:11], v[216:219], a[72:75], v[8:11]
    v_exp_f32 v213, v213
    v_mfma_f32_16x16x32_bf16 v[12:15], v[216:219], a[76:79], v[12:15]
    ds_read_b64_tr_b16 a[106:107], v232 offset:4608
    v_cvt_pk_bf16_f32 v226, v212, v213
    v_mfma_f32_16x16x32_bf16 v[16:19], v[216:219], a[80:83], v[16:19]
    v_exp_f32 v214, v214
    v_mfma_f32_16x16x32_bf16 v[20:23], v[216:219], a[84:87], v[20:23]
    ds_read_b64_tr_b16 a[108:109], v233 offset:512
    v_mfma_f32_16x16x32_bf16 v[24:27], v[216:219], a[88:91], v[24:27]
    v_exp_f32 v215, v215
    v_mfma_f32_16x16x32_bf16 v[28:31], v[216:219], a[92:95], v[28:31]
    ds_read_b64_tr_b16 a[110:111], v233 offset:4608
    v_cvt_pk_bf16_f32 v227, v214, v215
    v_smfmac_f32_16x16x64_bf16 v[244:247], a[252:255], v[216:223], v243
    ds_read_b128 a[56:59], v229 offset:6144
    v_mfma_f32_16x16x32_bf16 v[200:203], a[0:3], a[192:195], v[252:255]
    v_exp_f32 v192, v192
    v_mfma_f32_16x16x32_bf16 v[200:203], a[4:7], a[196:199], v[200:203]
    ds_read_b64_tr_b16 a[112:113], v232 offset:1024
    v_mfma_f32_16x16x32_bf16 v[200:203], a[8:11], a[200:203], v[200:203]
    v_exp_f32 v193, v193
    v_mfma_f32_16x16x32_bf16 v[200:203], a[12:15], a[204:207], v[200:203]
    ds_read_b128 a[60:63], v229 offset:6656
    v_cvt_pk_bf16_f32 v220, v192, v193
    v_mfma_f32_16x16x32_bf16 v[204:207], a[16:19], a[192:195], v[252:255]
    v_exp_f32 v194, v194
    v_mfma_f32_16x16x32_bf16 v[204:207], a[20:23], a[196:199], v[204:207]
    ds_read_b64_tr_b16 a[114:115], v232 offset:5120
    ds_read_b64_tr_b16 a[116:117], v233 offset:1024
    v_mfma_f32_16x16x32_bf16 v[204:207], a[24:27], a[200:203], v[204:207]
    v_exp_f32 v195, v195
    v_mfma_f32_16x16x32_bf16 v[204:207], a[28:31], a[204:207], v[204:207]
    s_add_u32 s48, s30, 12288
    v_cvt_pk_bf16_f32 v221, v194, v195
    v_mfma_f32_16x16x32_bf16 v[64:67], v[224:227], a[64:67], v[64:67]
    s_add_u32 m0, s31, 77824
    v_exp_f32 v196, v196
    v_mfma_f32_16x16x32_bf16 v[68:71], v[224:227], a[68:71], v[68:71]
    buffer_load_dwordx4 v235, s[16:19], s48 offen nt lds
    v_mfma_f32_16x16x32_bf16 v[72:75], v[224:227], a[72:75], v[72:75]
    s_add_u32 s30, s30, 16384
    v_exp_f32 v197, v197
    v_mfma_f32_16x16x32_bf16 v[76:79], v[224:227], a[76:79], v[76:79]
    s_add_u32 s31, s31, 16384
    ds_read_b64_tr_b16 a[118:119], v233 offset:5120
    v_cvt_pk_bf16_f32 v222, v196, v197
    v_mfma_f32_16x16x32_bf16 v[80:83], v[224:227], a[80:83], v[80:83]
    s_and_b32 s31, s31, 0xffff
    v_exp_f32 v198, v198
    v_mfma_f32_16x16x32_bf16 v[84:87], v[224:227], a[84:87], v[84:87]
    ds_read_b64_tr_b16 a[120:121], v232 offset:1536
    v_mfma_f32_16x16x32_bf16 v[88:91], v[224:227], a[88:91], v[88:91]
    v_exp_f32 v199, v199
    v_mfma_f32_16x16x32_bf16 v[92:95], v[224:227], a[92:95], v[92:95]
    s_waitcnt lgkmcnt(4)
    v_cvt_pk_bf16_f32 v223, v198, v199
    v_mfma_f32_16x16x32_bf16 v[208:211], a[32:35], a[144:147], v[252:255]
    v_exp_f32 v200, v200
    v_mfma_f32_16x16x32_bf16 v[208:211], a[36:39], a[148:151], v[208:211]
    v_add_f32 v240, v240, v200
    v_mfma_f32_16x16x32_bf16 v[208:211], a[40:43], a[152:155], v[208:211]
    v_exp_f32 v201, v201
    v_mfma_f32_16x16x32_bf16 v[208:211], a[44:47], a[156:159], v[208:211]
    v_cvt_pk_bf16_f32 v216, v200, v201
    v_add_f32 v240, v240, v201
    v_mfma_f32_16x16x32_bf16 v[212:215], a[48:51], a[144:147], v[252:255]
    v_exp_f32 v202, v202
    v_mfma_f32_16x16x32_bf16 v[212:215], a[52:55], a[148:151], v[212:215]
    ds_read_b64_tr_b16 a[122:123], v232 offset:5632
    v_add_f32 v240, v240, v202
    v_mfma_f32_16x16x32_bf16 v[212:215], a[56:59], a[152:155], v[212:215]
    v_exp_f32 v203, v203
    v_mfma_f32_16x16x32_bf16 v[212:215], a[60:63], a[156:159], v[212:215]
    v_cvt_pk_bf16_f32 v217, v202, v203
    v_add_f32 v240, v240, v203
    v_mfma_f32_16x16x32_bf16 v[96:99], v[220:223], a[64:67], v[96:99]
    v_exp_f32 v204, v204
    v_mfma_f32_16x16x32_bf16 v[100:103], v[220:223], a[68:71], v[100:103]
    v_add_f32 v240, v240, v204
    v_mfma_f32_16x16x32_bf16 v[104:107], v[220:223], a[72:75], v[104:107]
    v_exp_f32 v205, v205
    v_mfma_f32_16x16x32_bf16 v[108:111], v[220:223], a[76:79], v[108:111]
    v_cvt_pk_bf16_f32 v218, v204, v205
    v_add_f32 v240, v240, v205
    v_mfma_f32_16x16x32_bf16 v[112:115], v[220:223], a[80:83], v[112:115]
    v_exp_f32 v206, v206
    v_mfma_f32_16x16x32_bf16 v[116:119], v[220:223], a[84:87], v[116:119]
    ds_read_b64_tr_b16 a[124:125], v233 offset:1536
    v_add_f32 v240, v240, v206
    v_mfma_f32_16x16x32_bf16 v[120:123], v[220:223], a[88:91], v[120:123]
    v_exp_f32 v207, v207
    v_mfma_f32_16x16x32_bf16 v[124:127], v[220:223], a[92:95], v[124:127]
    v_cvt_pk_bf16_f32 v219, v206, v207
    v_add_f32 v240, v240, v207
    v_smfmac_f32_16x16x64_bf16 v[248:251], a[252:255], v[220:227], v243
    ds_read_b64_tr_b16 a[126:127], v233 offset:5632
    v_mfma_f32_16x16x32_bf16 v[192:195], a[32:35], a[128:131], v[252:255]
    v_exp_f32 v208, v208
    v_mfma_f32_16x16x32_bf16 v[192:195], a[36:39], a[132:135], v[192:195]
    v_mfma_f32_16x16x32_bf16 v[192:195], a[40:43], a[136:139], v[192:195]
    v_exp_f32 v209, v209
    v_mfma_f32_16x16x32_bf16 v[192:195], a[44:47], a[140:143], v[192:195]
    v_cvt_pk_bf16_f32 v220, v208, v209
    v_mfma_f32_16x16x32_bf16 v[196:199], a[48:51], a[128:131], v[252:255]
    s_waitcnt vmcnt(8)
    v_exp_f32 v210, v210
    v_mfma_f32_16x16x32_bf16 v[196:199], a[52:55], a[132:135], v[196:199]
    s_barrier
    v_mfma_f32_16x16x32_bf16 v[196:199], a[56:59], a[136:139], v[196:199]
    v_exp_f32 v211, v211
    v_mfma_f32_16x16x32_bf16 v[196:199], a[60:63], a[140:143], v[196:199]
    v_cvt_pk_bf16_f32 v221, v210, v211
    v_mfma_f32_16x16x32_bf16 v[128:131], v[216:219], a[64:67], v[128:131]
    v_exp_f32 v212, v212
    v_mfma_f32_16x16x32_bf16 v[132:135], v[216:219], a[68:71], v[132:135]
    ds_read_b128 a[0:3], v228 offset:16384
    v_mfma_f32_16x16x32_bf16 v[136:139], v[216:219], a[72:75], v[136:139]
    v_exp_f32 v213, v213
    v_mfma_f32_16x16x32_bf16 v[140:143], v[216:219], a[76:79], v[140:143]
    v_cvt_pk_bf16_f32 v222, v212, v213
    v_mfma_f32_16x16x32_bf16 v[144:147], v[216:219], a[80:83], v[144:147]
    v_exp_f32 v214, v214
    v_mfma_f32_16x16x32_bf16 v[148:151], v[216:219], a[84:87], v[148:151]
    v_mfma_f32_16x16x32_bf16 v[152:155], v[216:219], a[88:91], v[152:155]
    v_exp_f32 v215, v215
    v_mfma_f32_16x16x32_bf16 v[156:159], v[216:219], a[92:95], v[156:159]
    v_cvt_pk_bf16_f32 v223, v214, v215
    v_mfma_f32_16x16x32_bf16 v[200:203], a[32:35], a[160:163], v[252:255]
    v_exp_f32 v192, v192
    v_mfma_f32_16x16x32_bf16 v[200:203], a[36:39], a[164:167], v[200:203]
    ds_read_b64_tr_b16 a[64:65], v230 offset:16384
    ds_read_b64_tr_b16 a[66:67], v230 offset:20480
    v_mfma_f32_16x16x32_bf16 v[200:203], a[40:43], a[168:171], v[200:203]
    v_exp_f32 v193, v193
    v_mfma_f32_16x16x32_bf16 v[200:203], a[44:47], a[172:175], v[200:203]
    v_cvt_pk_bf16_f32 v216, v192, v193
    v_mfma_f32_16x16x32_bf16 v[204:207], a[48:51], a[160:163], v[252:255]
    v_exp_f32 v194, v194
    v_mfma_f32_16x16x32_bf16 v[204:207], a[52:55], a[164:167], v[204:207]
    v_mfma_f32_16x16x32_bf16 v[204:207], a[56:59], a[168:171], v[204:207]
    v_exp_f32 v195, v195
    v_mfma_f32_16x16x32_bf16 v[204:207], a[60:63], a[172:175], v[204:207]
    s_waitcnt lgkmcnt(3)
    s_add_u32 s48, s30, 0
    v_cvt_pk_bf16_f32 v217, v194, v195
    v_mfma_f32_16x16x32_bf16 v[32:35], v[220:223], a[96:99], v[32:35]
    s_add_u32 m0, s31, 0
    v_exp_f32 v196, v196
    v_mfma_f32_16x16x32_bf16 v[36:39], v[220:223], a[100:103], v[36:39]
    buffer_load_dwordx4 v234, s[12:15], s48 offen nt lds
    v_mfma_f32_16x16x32_bf16 v[40:43], v[220:223], a[104:107], v[40:43]
    v_exp_f32 v197, v197
    v_mfma_f32_16x16x32_bf16 v[44:47], v[220:223], a[108:111], v[44:47]
    ds_read_b128 a[4:7], v228 offset:16896
    v_cvt_pk_bf16_f32 v218, v196, v197
    v_mfma_f32_16x16x32_bf16 v[48:51], v[220:223], a[112:115], v[48:51]
    v_exp_f32 v198, v198
    v_mfma_f32_16x16x32_bf16 v[52:55], v[220:223], a[116:119], v[52:55]
    ds_read_b64_tr_b16 a[68:69], v231 offset:16384
    ds_read_b64_tr_b16 a[70:71], v231 offset:20480
    v_mfma_f32_16x16x32_bf16 v[56:59], v[220:223], a[120:123], v[56:59]
    v_exp_f32 v199, v199
    v_mfma_f32_16x16x32_bf16 v[60:63], v[220:223], a[124:127], v[60:63]
    ds_read_b64_tr_b16 a[72:73], v230 offset:16896
    v_cvt_pk_bf16_f32 v219, v198, v199
    v_mfma_f32_16x16x32_bf16 v[208:211], a[32:35], a[176:179], v[252:255]
    v_exp_f32 v200, v200
    v_mfma_f32_16x16x32_bf16 v[208:211], a[36:39], a[180:183], v[208:211]
    v_mfma_f32_16x16x32_bf16 v[208:211], a[40:43], a[184:187], v[208:211]
    v_exp_f32 v201, v201
    v_mfma_f32_16x16x32_bf16 v[208:211], a[44:47], a[188:191], v[208:211]
    s_add_u32 s48, s30, 4096
    v_cvt_pk_bf16_f32 v224, v200, v201
    v_mfma_f32_16x16x32_bf16 v[212:215], a[48:51], a[176:179], v[252:255]
    s_add_u32 m0, s31, 4096
    v_exp_f32 v202, v202
    v_mfma_f32_16x16x32_bf16 v[212:215], a[52:55], a[180:183], v[212:215]
    buffer_load_dwordx4 v234, s[12:15], s48 offen nt lds
    v_mfma_f32_16x16x32_bf16 v[212:215], a[56:59], a[184:187], v[212:215]
    v_exp_f32 v203, v203
    v_mfma_f32_16x16x32_bf16 v[212:215], a[60:63], a[188:191], v[212:215]
    s_add_u32 s48, s30, 8192
    ds_read_b64_tr_b16 a[74:75], v230 offset:20992
    v_cvt_pk_bf16_f32 v225, v202, v203
    v_mfma_f32_16x16x32_bf16 v[0:3], v[216:219], a[96:99], v[0:3]
    s_add_u32 m0, s31, 8192
    v_exp_f32 v204, v204
    v_mfma_f32_16x16x32_bf16 v[4:7], v[216:219], a[100:103], v[4:7]
    buffer_load_dwordx4 v234, s[12:15], s48 offen nt lds
    v_mfma_f32_16x16x32_bf16 v[8:11], v[216:219], a[104:107], v[8:11]
    v_exp_f32 v205, v205
    v_mfma_f32_16x16x32_bf16 v[12:15], v[216:219], a[108:111], v[12:15]
    ds_read_b64_tr_b16 a[76:77], v231 offset:16896
    v_cvt_pk_bf16_f32 v226, v204, v205
    v_mfma_f32_16x16x32_bf16 v[16:19], v[216:219], a[112:115], v[16:19]
    v_exp_f32 v206, v206
    v_mfma_f32_16x16x32_bf16 v[20:23], v[216:219], a[116:119], v[20:23]
    ds_read_b128 a[8:11], v228 offset:18432
    ds_read_b128 a[12:15], v228 offset:18944
    v_mfma_f32_16x16x32_bf16 v[24:27], v[216:219], a[120:123], v[24:27]
    v_exp_f32 v207, v207
    v_mfma_f32_16x16x32_bf16 v[28:31], v[216:219], a[124:127], v[28:31]
    ds_read_b64_tr_b16 a[78:79], v231 offset:20992
    v_cvt_pk_bf16_f32 v227, v206, v207
    v_smfmac_f32_16x16x64_bf16 v[244:247], a[252:255], v[216:223], v243
    ds_read_b128 a[16:19], v228 offset:20480
    ds_read_b128 a[20:23], v228 offset:20992
    v_mfma_f32_16x16x32_bf16 v[192:195], a[32:35], a[192:195], v[252:255]
    v_exp_f32 v208, v208
    v_mfma_f32_16x16x32_bf16 v[192:195], a[36:39], a[196:199], v[192:195]
    ds_read_b128 a[24:27], v228 offset:22528
    ds_read_b64_tr_b16 a[80:81], v230 offset:17408
    v_mfma_f32_16x16x32_bf16 v[192:195], a[40:43], a[200:203], v[192:195]
    v_exp_f32 v209, v209
    v_mfma_f32_16x16x32_bf16 v[192:195], a[44:47], a[204:207], v[192:195]
    ds_read_b64_tr_b16 a[82:83], v230 offset:21504
    v_cvt_pk_bf16_f32 v220, v208, v209
    v_mfma_f32_16x16x32_bf16 v[196:199], a[48:51], a[192:195], v[252:255]
    v_exp_f32 v210, v210
    v_mfma_f32_16x16x32_bf16 v[196:199], a[52:55], a[196:199], v[196:199]
    ds_read_b128 a[28:31], v228 offset:23040
    ds_read_b64_tr_b16 a[84:85], v231 offset:17408
    v_mfma_f32_16x16x32_bf16 v[196:199], a[56:59], a[200:203], v[196:199]
    v_exp_f32 v211, v211
    v_mfma_f32_16x16x32_bf16 v[196:199], a[60:63], a[204:207], v[196:199]
    v_cvt_pk_bf16_f32 v221, v210, v211
    v_mfma_f32_16x16x32_bf16 v[64:67], v[224:227], a[96:99], v[64:67]
    v_exp_f32 v212, v212
    v_mfma_f32_16x16x32_bf16 v[68:71], v[224:227], a[100:103], v[68:71]
    ds_read_b64_tr_b16 a[86:87], v231 offset:21504
    ds_read_b64_tr_b16 a[88:89], v230 offset:17920
    v_mfma_f32_16x16x32_bf16 v[72:75], v[224:227], a[104:107], v[72:75]
    v_exp_f32 v213, v213
    v_mfma_f32_16x16x32_bf16 v[76:79], v[224:227], a[108:111], v[76:79]
    v_cvt_pk_bf16_f32 v222, v212, v213
    v_mfma_f32_16x16x32_bf16 v[80:83], v[224:227], a[112:115], v[80:83]
    v_exp_f32 v214, v214
    v_mfma_f32_16x16x32_bf16 v[84:87], v[224:227], a[116:119], v[84:87]
    ds_read_b64_tr_b16 a[90:91], v230 offset:22016
    v_mfma_f32_16x16x32_bf16 v[88:91], v[224:227], a[120:123], v[88:91]
    v_exp_f32 v215, v215
    v_mfma_f32_16x16x32_bf16 v[92:95], v[224:227], a[124:127], v[92:95]
    s_waitcnt lgkmcnt(4)
    ds_read_b64_tr_b16 a[92:93], v231 offset:17920
    v_cvt_pk_bf16_f32 v223, v214, v215
    v_mfma_f32_16x16x32_bf16 v[200:203], a[0:3], a[144:147], v[252:255]
    v_exp_f32 v192, v192
    v_mfma_f32_16x16x32_bf16 v[200:203], a[4:7], a[148:151], v[200:203]
    v_add_f32 v240, v240, v192
    v_mfma_f32_16x16x32_bf16 v[200:203], a[8:11], a[152:155], v[200:203]
    v_exp_f32 v193, v193
    v_mfma_f32_16x16x32_bf16 v[200:203], a[12:15], a[156:159], v[200:203]
    v_cvt_pk_bf16_f32 v216, v192, v193
    v_add_f32 v240, v240, v193
    v_mfma_f32_16x16x32_bf16 v[204:207], a[16:19], a[144:147], v[252:255]
    v_exp_f32 v194, v194
    v_mfma_f32_16x16x32_bf16 v[204:207], a[20:23], a[148:151], v[204:207]
    v_add_f32 v240, v240, v194
    v_mfma_f32_16x16x32_bf16 v[204:207], a[24:27], a[152:155], v[204:207]
    v_exp_f32 v195, v195
    v_mfma_f32_16x16x32_bf16 v[204:207], a[28:31], a[156:159], v[204:207]
    v_cvt_pk_bf16_f32 v217, v194, v195
    v_add_f32 v240, v240, v195
    v_mfma_f32_16x16x32_bf16 v[96:99], v[220:223], a[96:99], v[96:99]
    v_exp_f32 v196, v196
    v_mfma_f32_16x16x32_bf16 v[100:103], v[220:223], a[100:103], v[100:103]
    v_add_f32 v240, v240, v196
    v_mfma_f32_16x16x32_bf16 v[104:107], v[220:223], a[104:107], v[104:107]
    v_exp_f32 v197, v197
    v_mfma_f32_16x16x32_bf16 v[108:111], v[220:223], a[108:111], v[108:111]
    v_cvt_pk_bf16_f32 v218, v196, v197
    v_add_f32 v240, v240, v197
    v_mfma_f32_16x16x32_bf16 v[112:115], v[220:223], a[112:115], v[112:115]
    v_exp_f32 v198, v198
    v_mfma_f32_16x16x32_bf16 v[116:119], v[220:223], a[116:119], v[116:119]
    ds_read_b64_tr_b16 a[94:95], v231 offset:22016
    v_add_f32 v240, v240, v198
    v_mfma_f32_16x16x32_bf16 v[120:123], v[220:223], a[120:123], v[120:123]
    s_add_u32 s48, s30, 12288
    v_exp_f32 v199, v199
    v_mfma_f32_16x16x32_bf16 v[124:127], v[220:223], a[124:127], v[124:127]
    s_add_u32 m0, s31, 12288
    v_cvt_pk_bf16_f32 v219, v198, v199
    v_add_f32 v240, v240, v199
    v_smfmac_f32_16x16x64_bf16 v[248:251], a[252:255], v[220:227], v243
    buffer_load_dwordx4 v234, s[12:15], s48 offen nt lds
    v_mfma_f32_16x16x32_bf16 v[208:211], a[0:3], a[128:131], v[252:255]
    v_exp_f32 v200, v200
    v_mfma_f32_16x16x32_bf16 v[208:211], a[4:7], a[132:135], v[208:211]
    v_xor_b32 v228, 0x8000, v228
    v_mfma_f32_16x16x32_bf16 v[208:211], a[8:11], a[136:139], v[208:211]
    v_exp_f32 v201, v201
    v_mfma_f32_16x16x32_bf16 v[208:211], a[12:15], a[140:143], v[208:211]
    v_cvt_pk_bf16_f32 v220, v200, v201
    v_mfma_f32_16x16x32_bf16 v[212:215], a[16:19], a[128:131], v[252:255]
    v_exp_f32 v202, v202
    v_mfma_f32_16x16x32_bf16 v[212:215], a[20:23], a[132:135], v[212:215]
    ds_read_b128 a[32:35], v229 offset:16384
    v_mfma_f32_16x16x32_bf16 v[212:215], a[24:27], a[136:139], v[212:215]
    v_exp_f32 v203, v203
    v_mfma_f32_16x16x32_bf16 v[212:215], a[28:31], a[140:143], v[212:215]
    v_cvt_pk_bf16_f32 v221, v202, v203
    v_mfma_f32_16x16x32_bf16 v[128:131], v[216:219], a[96:99], v[128:131]
    v_exp_f32 v204, v204
    v_mfma_f32_16x16x32_bf16 v[132:135], v[216:219], a[100:103], v[132:135]
    ds_read_b128 a[36:39], v229 offset:16896
    v_mfma_f32_16x16x32_bf16 v[136:139], v[216:219], a[104:107], v[136:139]
    v_exp_f32 v205, v205
    v_mfma_f32_16x16x32_bf16 v[140:143], v[216:219], a[108:111], v[140:143]
    v_cvt_pk_bf16_f32 v222, v204, v205
    v_xor_b32 v230, 0x8000, v230
    v_mfma_f32_16x16x32_bf16 v[144:147], v[216:219], a[112:115], v[144:147]
    v_exp_f32 v206, v206
    v_mfma_f32_16x16x32_bf16 v[148:151], v[216:219], a[116:119], v[148:151]
    v_mfma_f32_16x16x32_bf16 v[152:155], v[216:219], a[120:123], v[152:155]
    v_exp_f32 v207, v207
    v_mfma_f32_16x16x32_bf16 v[156:159], v[216:219], a[124:127], v[156:159]
    s_add_u32 s48, s30, 0
    ds_read_b128 a[40:43], v229 offset:18432
    v_cvt_pk_bf16_f32 v223, v206, v207
    v_mfma_f32_16x16x32_bf16 v[192:195], a[0:3], a[208:211], v[252:255]
    s_add_u32 m0, s31, 65536
    v_exp_f32 v208, v208
    v_mfma_f32_16x16x32_bf16 v[192:195], a[4:7], a[212:215], v[192:195]
    buffer_load_dwordx4 v235, s[16:19], s48 offen nt lds
    v_mfma_f32_16x16x32_bf16 v[192:195], a[8:11], a[216:219], v[192:195]
    v_exp_f32 v209, v209
    v_mfma_f32_16x16x32_bf16 v[192:195], a[12:15], a[220:223], v[192:195]
    v_cvt_pk_bf16_f32 v216, v208, v209
    v_mfma_f32_16x16x32_bf16 v[196:199], a[16:19], a[208:211], v[252:255]
    v_exp_f32 v210, v210
    v_mfma_f32_16x16x32_bf16 v[196:199], a[20:23], a[212:215], v[196:199]
    ds_read_b64_tr_b16 a[96:97], v232 offset:16384
    v_mfma_f32_16x16x32_bf16 v[196:199], a[24:27], a[216:219], v[196:199]
    v_exp_f32 v211, v211
    v_mfma_f32_16x16x32_bf16 v[196:199], a[28:31], a[220:223], v[196:199]
    s_waitcnt lgkmcnt(4)
    ds_read_b64_tr_b16 a[98:99], v232 offset:20480
    v_cvt_pk_bf16_f32 v217, v210, v211
    v_mfma_f32_16x16x32_bf16 v[32:35], v[220:223], a[64:67], v[32:35]
    v_exp_f32 v212, v212
    v_mfma_f32_16x16x32_bf16 v[36:39], v[220:223], a[68:71], v[36:39]
    v_mfma_f32_16x16x32_bf16 v[40:43], v[220:223], a[72:75], v[40:43]
    v_exp_f32 v213, v213
    v_mfma_f32_16x16x32_bf16 v[44:47], v[220:223], a[76:79], v[44:47]
    ds_read_b128 a[44:47], v229 offset:18944
    v_cvt_pk_bf16_f32 v218, v212, v213
    v_mfma_f32_16x16x32_bf16 v[48:51], v[220:223], a[80:83], v[48:51]
    v_exp_f32 v214, v214
    v_mfma_f32_16x16x32_bf16 v[52:55], v[220:223], a[84:87], v[52:55]
    ds_read_b128 a[48:51], v229 offset:20480
    v_mfma_f32_16x16x32_bf16 v[56:59], v[220:223], a[88:91], v[56:59]
    v_exp_f32 v215, v215
    v_mfma_f32_16x16x32_bf16 v[60:63], v[220:223], a[92:95], v[60:63]
    ds_read_b64_tr_b16 a[100:101], v233 offset:16384
    v_cvt_pk_bf16_f32 v219, v214, v215
    v_mfma_f32_16x16x32_bf16 v[200:203], a[0:3], a[160:163], v[252:255]
    v_exp_f32 v192, v192
    v_mfma_f32_16x16x32_bf16 v[200:203], a[4:7], a[164:167], v[200:203]
    v_mfma_f32_16x16x32_bf16 v[200:203], a[8:11], a[168:171], v[200:203]
    v_exp_f32 v193, v193
    v_mfma_f32_16x16x32_bf16 v[200:203], a[12:15], a[172:175], v[200:203]
    ds_read_b64_tr_b16 a[102:103], v233 offset:20480
    v_cvt_pk_bf16_f32 v224, v192, v193
    v_mfma_f32_16x16x32_bf16 v[204:207], a[16:19], a[160:163], v[252:255]
    v_exp_f32 v194, v194
    v_mfma_f32_16x16x32_bf16 v[204:207], a[20:23], a[164:167], v[204:207]
    v_mfma_f32_16x16x32_bf16 v[204:207], a[24:27], a[168:171], v[204:207]
    v_exp_f32 v195, v195
    v_mfma_f32_16x16x32_bf16 v[204:207], a[28:31], a[172:175], v[204:207]
    s_add_u32 s48, s30, 4096
    ds_read_b64_tr_b16 a[104:105], v232 offset:16896
    v_cvt_pk_bf16_f32 v225, v194, v195
    v_mfma_f32_16x16x32_bf16 v[0:3], v[216:219], a[64:67], v[0:3]
    s_add_u32 m0, s31, 69632
    v_exp_f32 v196, v196
    v_mfma_f32_16x16x32_bf16 v[4:7], v[216:219], a[68:71], v[4:7]
    buffer_load_dwordx4 v235, s[16:19], s48 offen nt lds
    v_mfma_f32_16x16x32_bf16 v[8:11], v[216:219], a[72:75], v[8:11]
    v_exp_f32 v197, v197
    v_mfma_f32_16x16x32_bf16 v[12:15], v[216:219], a[76:79], v[12:15]
    ds_read_b64_tr_b16 a[106:107], v232 offset:20992
    v_cvt_pk_bf16_f32 v226, v196, v197
    v_mfma_f32_16x16x32_bf16 v[16:19], v[216:219], a[80:83], v[16:19]
    v_exp_f32 v198, v198
    v_mfma_f32_16x16x32_bf16 v[20:23], v[216:219], a[84:87], v[20:23]
    v_mfma_f32_16x16x32_bf16 v[24:27], v[216:219], a[88:91], v[24:27]
    v_exp_f32 v199, v199
    v_mfma_f32_16x16x32_bf16 v[28:31], v[216:219], a[92:95], v[28:31]
    ds_read_b64_tr_b16 a[108:109], v233 offset:16896
    v_cvt_pk_bf16_f32 v227, v198, v199
    v_smfmac_f32_16x16x64_bf16 v[244:247], a[252:255], v[216:223], v243
    s_add_u32 s48, s30, 8192
    ds_read_b128 a[52:55], v229 offset:20992
    v_mfma_f32_16x16x32_bf16 v[208:211], a[0:3], a[176:179], v[252:255]
    s_add_u32 m0, s31, 73728
    v_exp_f32 v200, v200
    v_mfma_f32_16x16x32_bf16 v[208:211], a[4:7], a[180:183], v[208:211]
    buffer_load_dwordx4 v235, s[16:19], s48 offen nt lds
    v_mfma_f32_16x16x32_bf16 v[208:211], a[8:11], a[184:187], v[208:211]
    v_exp_f32 v201, v201
    v_mfma_f32_16x16x32_bf16 v[208:211], a[12:15], a[188:191], v[208:211]
    v_cvt_pk_bf16_f32 v220, v200, v201
    v_mfma_f32_16x16x32_bf16 v[212:215], a[16:19], a[176:179], v[252:255]
    v_exp_f32 v202, v202
    v_mfma_f32_16x16x32_bf16 v[212:215], a[20:23], a[180:183], v[212:215]
    ds_read_b64_tr_b16 a[110:111], v233 offset:20992
    v_mfma_f32_16x16x32_bf16 v[212:215], a[24:27], a[184:187], v[212:215]
    v_exp_f32 v203, v203
    v_mfma_f32_16x16x32_bf16 v[212:215], a[28:31], a[188:191], v[212:215]
    ds_read_b128 a[56:59], v229 offset:22528
    v_cvt_pk_bf16_f32 v221, v202, v203
    v_mfma_f32_16x16x32_bf16 v[160:163], v[224:227], a[64:67], v[160:163]
    v_exp_f32 v204, v204
    v_mfma_f32_16x16x32_bf16 v[164:167], v[224:227], a[68:71], v[164:167]
    ds_read_b64_tr_b16 a[112:113], v232 offset:17408
    v_mfma_f32_16x16x32_bf16 v[168:171], v[224:227], a[72:75], v[168:171]
    v_exp_f32 v205, v205
    v_mfma_f32_16x16x32_bf16 v[172:175], v[224:227], a[76:79], v[172:175]
    v_cvt_pk_bf16_f32 v222, v204, v205
    v_mfma_f32_16x16x32_bf16 v[176:179], v[224:227], a[80:83], v[176:179]
    v_exp_f32 v206, v206
    v_mfma_f32_16x16x32_bf16 v[180:183], v[224:227], a[84:87], v[180:183]
    ds_read_b64_tr_b16 a[114:115], v232 offset:21504
    v_xor_b32 v231, 0x8000, v231
    v_mfma_f32_16x16x32_bf16 v[184:187], v[224:227], a[88:91], v[184:187]
    s_add_u32 s48, s30, 12288
    v_exp_f32 v207, v207
    v_mfma_f32_16x16x32_bf16 v[188:191], v[224:227], a[92:95], v[188:191]
    s_add_u32 m0, s31, 77824
    v_cvt_pk_bf16_f32 v223, v206, v207
    v_mfma_f32_16x16x32_bf16 a[232:235], a[236:239], v[224:227], a[232:235]
    buffer_load_dwordx4 v235, s[16:19], s48 offen nt lds
    v_mfma_f32_16x16x32_bf16 v[192:195], a[0:3], a[192:195], v[252:255]
    s_add_u32 s30, s30, 16384
    v_exp_f32 v208, v208
    v_mfma_f32_16x16x32_bf16 v[192:195], a[4:7], a[196:199], v[192:195]
    s_add_u32 s31, s31, 16384
    ds_read_b64_tr_b16 a[116:117], v233 offset:17408
    v_mfma_f32_16x16x32_bf16 v[192:195], a[8:11], a[200:203], v[192:195]
    s_and_b32 s31, s31, 0xffff
    v_exp_f32 v209, v209
    v_mfma_f32_16x16x32_bf16 v[192:195], a[12:15], a[204:207], v[192:195]
    v_cvt_pk_bf16_f32 v216, v208, v209
    v_mfma_f32_16x16x32_bf16 v[196:199], a[16:19], a[192:195], v[252:255]
    v_exp_f32 v210, v210
    v_mfma_f32_16x16x32_bf16 v[196:199], a[20:23], a[196:199], v[196:199]
    ds_read_b128 a[60:63], v229 offset:23040
    v_mfma_f32_16x16x32_bf16 v[196:199], a[24:27], a[200:203], v[196:199]
    v_exp_f32 v211, v211
    v_mfma_f32_16x16x32_bf16 v[196:199], a[28:31], a[204:207], v[196:199]
    ds_read_b64_tr_b16 a[118:119], v233 offset:21504
    v_cvt_pk_bf16_f32 v217, v210, v211
    v_mfma_f32_16x16x32_bf16 v[64:67], v[220:223], a[64:67], v[64:67]
    v_exp_f32 v212, v212
    v_mfma_f32_16x16x32_bf16 v[68:71], v[220:223], a[68:71], v[68:71]
    ds_read_b64_tr_b16 a[120:121], v232 offset:17920
    v_mfma_f32_16x16x32_bf16 v[72:75], v[220:223], a[72:75], v[72:75]
    v_exp_f32 v213, v213
    v_mfma_f32_16x16x32_bf16 v[76:79], v[220:223], a[76:79], v[76:79]
    v_cvt_pk_bf16_f32 v218, v212, v213
    v_mfma_f32_16x16x32_bf16 v[80:83], v[220:223], a[80:83], v[80:83]
    v_exp_f32 v214, v214
    v_mfma_f32_16x16x32_bf16 v[84:87], v[220:223], a[84:87], v[84:87]
    ds_read_b64_tr_b16 a[122:123], v232 offset:22016
    v_mfma_f32_16x16x32_bf16 v[88:91], v[220:223], a[88:91], v[88:91]
    v_exp_f32 v215, v215
    v_mfma_f32_16x16x32_bf16 v[92:95], v[220:223], a[92:95], v[92:95]
    s_waitcnt lgkmcnt(3)
    v_cvt_pk_bf16_f32 v219, v214, v215
    v_mfma_f32_16x16x32_bf16 v[200:203], a[32:35], a[144:147], v[252:255]
    v_exp_f32 v192, v192
    v_mfma_f32_16x16x32_bf16 v[200:203], a[36:39], a[148:151], v[200:203]
    ds_read_b64_tr_b16 a[124:125], v233 offset:17920
    v_add_f32 v240, v240, v192
    v_mfma_f32_16x16x32_bf16 v[200:203], a[40:43], a[152:155], v[200:203]
    v_exp_f32 v193, v193
    v_mfma_f32_16x16x32_bf16 v[200:203], a[44:47], a[156:159], v[200:203]
    v_cvt_pk_bf16_f32 v224, v192, v193
    v_add_f32 v240, v240, v193
    v_mfma_f32_16x16x32_bf16 v[204:207], a[48:51], a[144:147], v[252:255]
    s_waitcnt vmcnt(8)
    v_exp_f32 v194, v194
    v_mfma_f32_16x16x32_bf16 v[204:207], a[52:55], a[148:151], v[204:207]
    s_barrier
    v_add_f32 v240, v240, v194
    v_mfma_f32_16x16x32_bf16 v[204:207], a[56:59], a[152:155], v[204:207]
    v_exp_f32 v195, v195
    v_mfma_f32_16x16x32_bf16 v[204:207], a[60:63], a[156:159], v[204:207]
    v_cvt_pk_bf16_f32 v225, v194, v195
    v_add_f32 v240, v240, v195
    v_mfma_f32_16x16x32_bf16 v[96:99], v[216:219], a[64:67], v[96:99]
    v_exp_f32 v196, v196
    v_mfma_f32_16x16x32_bf16 v[100:103], v[216:219], a[68:71], v[100:103]
    v_add_f32 v240, v240, v196
    v_mfma_f32_16x16x32_bf16 v[104:107], v[216:219], a[72:75], v[104:107]
    v_exp_f32 v197, v197
    v_mfma_f32_16x16x32_bf16 v[108:111], v[216:219], a[76:79], v[108:111]
    v_cvt_pk_bf16_f32 v226, v196, v197
    v_add_f32 v240, v240, v197
    v_mfma_f32_16x16x32_bf16 v[112:115], v[216:219], a[80:83], v[112:115]
    v_exp_f32 v198, v198
    v_mfma_f32_16x16x32_bf16 v[116:119], v[216:219], a[84:87], v[116:119]
    v_add_f32 v240, v240, v198
    v_mfma_f32_16x16x32_bf16 v[120:123], v[216:219], a[88:91], v[120:123]
    v_exp_f32 v199, v199
    v_mfma_f32_16x16x32_bf16 v[124:127], v[216:219], a[92:95], v[124:127]
    v_cvt_pk_bf16_f32 v227, v198, v199
    v_add_f32 v240, v240, v199
    v_smfmac_f32_16x16x64_bf16 v[248:251], a[252:255], v[216:223], v243
    ds_read_b64_tr_b16 a[126:127], v233 offset:22016
    v_mfma_f32_16x16x32_bf16 v[208:211], a[32:35], a[128:131], v[252:255]
    v_exp_f32 v200, v200
    v_mfma_f32_16x16x32_bf16 v[208:211], a[36:39], a[132:135], v[208:211]
    v_mfma_f32_16x16x32_bf16 v[208:211], a[40:43], a[136:139], v[208:211]
    v_exp_f32 v201, v201
    v_mfma_f32_16x16x32_bf16 v[208:211], a[44:47], a[140:143], v[208:211]
    v_cvt_pk_bf16_f32 v220, v200, v201
    v_mfma_f32_16x16x32_bf16 v[212:215], a[48:51], a[128:131], v[252:255]
    v_exp_f32 v202, v202
    v_mfma_f32_16x16x32_bf16 v[212:215], a[52:55], a[132:135], v[212:215]
    ds_read_b128 a[0:3], v228 offset:0
    v_xor_b32 v229, 0x8000, v229
    v_mfma_f32_16x16x32_bf16 v[212:215], a[56:59], a[136:139], v[212:215]
    v_exp_f32 v203, v203
    v_mfma_f32_16x16x32_bf16 v[212:215], a[60:63], a[140:143], v[212:215]
    v_cvt_pk_bf16_f32 v221, v202, v203
    v_mfma_f32_16x16x32_bf16 v[128:131], v[224:227], a[64:67], v[128:131]
    v_exp_f32 v204, v204
    v_mfma_f32_16x16x32_bf16 v[132:135], v[224:227], a[68:71], v[132:135]
    v_mfma_f32_16x16x32_bf16 v[136:139], v[224:227], a[72:75], v[136:139]
    v_exp_f32 v205, v205
    v_mfma_f32_16x16x32_bf16 v[140:143], v[224:227], a[76:79], v[140:143]
    v_cvt_pk_bf16_f32 v222, v204, v205
    v_mfma_f32_16x16x32_bf16 v[144:147], v[224:227], a[80:83], v[144:147]
    v_exp_f32 v206, v206
    v_mfma_f32_16x16x32_bf16 v[148:151], v[224:227], a[84:87], v[148:151]
    v_mfma_f32_16x16x32_bf16 v[152:155], v[224:227], a[88:91], v[152:155]
    v_exp_f32 v207, v207
    v_mfma_f32_16x16x32_bf16 v[156:159], v[224:227], a[92:95], v[156:159]
    s_add_u32 s48, s30, 0
    v_cvt_pk_bf16_f32 v223, v206, v207
    v_xor_b32 v232, 0x8000, v232
    v_mfma_f32_16x16x32_bf16 v[192:195], a[32:35], a[160:163], v[252:255]
    s_add_u32 m0, s31, 0
    v_exp_f32 v208, v208
    v_mfma_f32_16x16x32_bf16 v[192:195], a[36:39], a[164:167], v[192:195]
    buffer_load_dwordx4 v234, s[12:15], s48 offen nt lds
    v_mfma_f32_16x16x32_bf16 v[192:195], a[40:43], a[168:171], v[192:195]
    v_exp_f32 v209, v209
    v_mfma_f32_16x16x32_bf16 v[192:195], a[44:47], a[172:175], v[192:195]
    s_add_u32 s48, s30, 4096
    ds_read_b64_tr_b16 a[64:65], v230 offset:0
    v_cvt_pk_bf16_f32 v216, v208, v209
    v_mfma_f32_16x16x32_bf16 v[196:199], a[48:51], a[160:163], v[252:255]
    s_add_u32 m0, s31, 4096
    v_exp_f32 v210, v210
    v_mfma_f32_16x16x32_bf16 v[196:199], a[52:55], a[164:167], v[196:199]
    buffer_load_dwordx4 v234, s[12:15], s48 offen nt lds
    v_mfma_f32_16x16x32_bf16 v[196:199], a[56:59], a[168:171], v[196:199]
    v_exp_f32 v211, v211
    v_mfma_f32_16x16x32_bf16 v[196:199], a[60:63], a[172:175], v[196:199]
    s_waitcnt lgkmcnt(2)
    ds_read_b128 a[4:7], v228 offset:512
    v_cvt_pk_bf16_f32 v217, v210, v211
    v_mfma_f32_16x16x32_bf16 v[32:35], v[220:223], a[96:99], v[32:35]
    v_exp_f32 v212, v212
    v_mfma_f32_16x16x32_bf16 v[36:39], v[220:223], a[100:103], v[36:39]
    ds_read_b128 a[8:11], v228 offset:2048
    v_mfma_f32_16x16x32_bf16 v[40:43], v[220:223], a[104:107], v[40:43]
    v_exp_f32 v213, v213
    v_mfma_f32_16x16x32_bf16 v[44:47], v[220:223], a[108:111], v[44:47]
    ds_read_b64_tr_b16 a[66:67], v230 offset:4096
    v_cvt_pk_bf16_f32 v218, v212, v213
    v_mfma_f32_16x16x32_bf16 v[48:51], v[220:223], a[112:115], v[48:51]
    v_exp_f32 v214, v214
    v_mfma_f32_16x16x32_bf16 v[52:55], v[220:223], a[116:119], v[52:55]
    ds_read_b128 a[12:15], v228 offset:2560
    v_mfma_f32_16x16x32_bf16 v[56:59], v[220:223], a[120:123], v[56:59]
    v_exp_f32 v215, v215
    v_mfma_f32_16x16x32_bf16 v[60:63], v[220:223], a[124:127], v[60:63]
    ds_read_b64_tr_b16 a[68:69], v231 offset:0
    v_cvt_pk_bf16_f32 v219, v214, v215
    v_mfma_f32_16x16x32_bf16 v[200:203], a[32:35], a[176:179], v[252:255]
    v_exp_f32 v192, v192
    v_mfma_f32_16x16x32_bf16 v[200:203], a[36:39], a[180:183], v[200:203]
    ds_read_b128 a[16:19], v228 offset:4096
    ds_read_b128 a[20:23], v228 offset:4608
    v_mfma_f32_16x16x32_bf16 v[200:203], a[40:43], a[184:187], v[200:203]
    v_exp_f32 v193, v193
    v_mfma_f32_16x16x32_bf16 v[200:203], a[44:47], a[188:191], v[200:203]
    ds_read_b64_tr_b16 a[70:71], v231 offset:4096
    v_cvt_pk_bf16_f32 v224, v192, v193
    v_mfma_f32_16x16x32_bf16 v[204:207], a[48:51], a[176:179], v[252:255]
    v_exp_f32 v194, v194
    v_mfma_f32_16x16x32_bf16 v[204:207], a[52:55], a[180:183], v[204:207]
    ds_read_b64_tr_b16 a[72:73], v230 offset:512
    v_mfma_f32_16x16x32_bf16 v[204:207], a[56:59], a[184:187], v[204:207]
    v_exp_f32 v195, v195
    v_mfma_f32_16x16x32_bf16 v[204:207], a[60:63], a[188:191], v[204:207]
    ds_read_b64_tr_b16 a[74:75], v230 offset:4608
    v_cvt_pk_bf16_f32 v225, v194, v195
    v_mfma_f32_16x16x32_bf16 v[0:3], v[216:219], a[96:99], v[0:3]
    v_exp_f32 v196, v196
    v_mfma_f32_16x16x32_bf16 v[4:7], v[216:219], a[100:103], v[4:7]
    ds_read_b64_tr_b16 a[76:77], v231 offset:512
    v_mfma_f32_16x16x32_bf16 v[8:11], v[216:219], a[104:107], v[8:11]
    v_exp_f32 v197, v197
    v_mfma_f32_16x16x32_bf16 v[12:15], v[216:219], a[108:111], v[12:15]
    v_cvt_pk_bf16_f32 v226, v196, v197
    v_mfma_f32_16x16x32_bf16 v[16:19], v[216:219], a[112:115], v[16:19]
    v_exp_f32 v198, v198
    v_mfma_f32_16x16x32_bf16 v[20:23], v[216:219], a[116:119], v[20:23]
    ds_read_b64_tr_b16 a[78:79], v231 offset:4608
    ds_read_b64_tr_b16 a[80:81], v230 offset:1024
    v_mfma_f32_16x16x32_bf16 v[24:27], v[216:219], a[120:123], v[24:27]
    v_exp_f32 v199, v199
    v_mfma_f32_16x16x32_bf16 v[28:31], v[216:219], a[124:127], v[28:31]
    s_sub_u32 s29, s29, 1
    s_cmp_lg_u32 s29, 0
    v_cvt_pk_bf16_f32 v227, v198, v199
    v_smfmac_f32_16x16x64_bf16 v[244:247], a[252:255], v[216:223], v243
    s_cbranch_scc1 L_loop0
    s_add_u32 s48, s30, 8192
    v_mfma_f32_16x16x32_bf16 v[208:211], a[32:35], a[192:195], v[252:255]
    s_add_u32 m0, s31, 8192
    v_exp_f32 v200, v200
    v_mfma_f32_16x16x32_bf16 v[208:211], a[36:39], a[196:199], v[208:211]
    buffer_load_dwordx4 v234, s[12:15], s48 offen nt lds
    v_mfma_f32_16x16x32_bf16 v[208:211], a[40:43], a[200:203], v[208:211]
    v_exp_f32 v201, v201
    v_mfma_f32_16x16x32_bf16 v[208:211], a[44:47], a[204:207], v[208:211]
    s_add_u32 s48, s30, 12288
    ds_read_b64_tr_b16 a[82:83], v230 offset:5120
    v_cvt_pk_bf16_f32 v220, v200, v201
    v_mfma_f32_16x16x32_bf16 v[212:215], a[48:51], a[192:195], v[252:255]
    s_add_u32 m0, s31, 12288
    v_exp_f32 v202, v202
    v_mfma_f32_16x16x32_bf16 v[212:215], a[52:55], a[196:199], v[212:215]
    buffer_load_dwordx4 v234, s[12:15], s48 offen nt lds
    v_mfma_f32_16x16x32_bf16 v[212:215], a[56:59], a[200:203], v[212:215]
    v_exp_f32 v203, v203
    v_mfma_f32_16x16x32_bf16 v[212:215], a[60:63], a[204:207], v[212:215]
    ds_read_b128 a[24:27], v228 offset:6144
    v_cvt_pk_bf16_f32 v221, v202, v203
    v_mfma_f32_16x16x32_bf16 v[64:67], v[224:227], a[96:99], v[64:67]
    v_exp_f32 v204, v204
    v_mfma_f32_16x16x32_bf16 v[68:71], v[224:227], a[100:103], v[68:71]
    ds_read_b128 a[28:31], v228 offset:6656
    ds_read_b64_tr_b16 a[84:85], v231 offset:1024
    v_mfma_f32_16x16x32_bf16 v[72:75], v[224:227], a[104:107], v[72:75]
    v_exp_f32 v205, v205
    v_mfma_f32_16x16x32_bf16 v[76:79], v[224:227], a[108:111], v[76:79]
    v_cvt_pk_bf16_f32 v222, v204, v205
    v_xor_b32 v233, 0x8000, v233
    v_mfma_f32_16x16x32_bf16 v[80:83], v[224:227], a[112:115], v[80:83]
    v_exp_f32 v206, v206
    v_mfma_f32_16x16x32_bf16 v[84:87], v[224:227], a[116:119], v[84:87]
    ds_read_b64_tr_b16 a[86:87], v231 offset:5120
    v_mfma_f32_16x16x32_bf16 v[88:91], v[224:227], a[120:123], v[88:91]
    v_exp_f32 v207, v207
    v_mfma_f32_16x16x32_bf16 v[92:95], v[224:227], a[124:127], v[92:95]
    s_waitcnt lgkmcnt(2)
    ds_read_b64_tr_b16 a[88:89], v230 offset:1536
    v_cvt_pk_bf16_f32 v223, v206, v207
    v_mfma_f32_16x16x32_bf16 v[192:195], a[0:3], a[144:147], v[252:255]
    v_exp_f32 v208, v208
    v_mfma_f32_16x16x32_bf16 v[192:195], a[4:7], a[148:151], v[192:195]
    v_add_f32 v240, v240, v208
    v_mfma_f32_16x16x32_bf16 v[192:195], a[8:11], a[152:155], v[192:195]
    v_exp_f32 v209, v209
    v_mfma_f32_16x16x32_bf16 v[192:195], a[12:15], a[156:159], v[192:195]
    v_cvt_pk_bf16_f32 v216, v208, v209
    v_add_f32 v240, v240, v209
    v_mfma_f32_16x16x32_bf16 v[196:199], a[16:19], a[144:147], v[252:255]
    v_exp_f32 v210, v210
    v_mfma_f32_16x16x32_bf16 v[196:199], a[20:23], a[148:151], v[196:199]
    ds_read_b64_tr_b16 a[90:91], v230 offset:5632
    v_add_f32 v240, v240, v210
    v_mfma_f32_16x16x32_bf16 v[196:199], a[24:27], a[152:155], v[196:199]
    v_exp_f32 v211, v211
    v_mfma_f32_16x16x32_bf16 v[196:199], a[28:31], a[156:159], v[196:199]
    v_cvt_pk_bf16_f32 v217, v210, v211
    v_add_f32 v240, v240, v211
    v_mfma_f32_16x16x32_bf16 v[96:99], v[220:223], a[96:99], v[96:99]
    v_exp_f32 v212, v212
    v_mfma_f32_16x16x32_bf16 v[100:103], v[220:223], a[100:103], v[100:103]
    ds_read_b64_tr_b16 a[92:93], v231 offset:1536
    v_add_f32 v240, v240, v212
    v_mfma_f32_16x16x32_bf16 v[104:107], v[220:223], a[104:107], v[104:107]
    v_exp_f32 v213, v213
    v_mfma_f32_16x16x32_bf16 v[108:111], v[220:223], a[108:111], v[108:111]
    v_cvt_pk_bf16_f32 v218, v212, v213
    v_add_f32 v240, v240, v213
    v_mfma_f32_16x16x32_bf16 v[112:115], v[220:223], a[112:115], v[112:115]
    v_exp_f32 v214, v214
    v_mfma_f32_16x16x32_bf16 v[116:119], v[220:223], a[116:119], v[116:119]
    v_add_f32 v240, v240, v214
    v_mfma_f32_16x16x32_bf16 v[120:123], v[220:223], a[120:123], v[120:123]
    v_exp_f32 v215, v215
    v_mfma_f32_16x16x32_bf16 v[124:127], v[220:223], a[124:127], v[124:127]
    v_cvt_pk_bf16_f32 v219, v214, v215
    v_add_f32 v240, v240, v215
    v_smfmac_f32_16x16x64_bf16 v[248:251], a[252:255], v[220:227], v243
    ds_read_b64_tr_b16 a[94:95], v231 offset:5632
    ds_read_b128 a[32:35], v229 offset:0
    ds_read_b128 a[36:39], v229 offset:512
    ds_read_b128 a[40:43], v229 offset:2048
    ds_read_b128 a[44:47], v229 offset:2560
    ds_read_b128 a[48:51], v229 offset:4096
    ds_read_b128 a[52:55], v229 offset:4608
    ds_read_b128 a[56:59], v229 offset:6144
    ds_read_b128 a[60:63], v229 offset:6656
L_tail0:
    s_getpc_b64 s[4:5]
    v_mbcnt_lo_u32_b32 v228, -1, 0
    v_mbcnt_hi_u32_b32 v228, -1, v228
    s_mov_b32 m0, 0
    v_lshlrev_b32 v228, 7, v228
    v_mov_b32 v229, s5
    v_add_co_u32 v228, vcc, s4, v228
    v_addc_co_u32 v229, vcc, 0, v229, vcc
    global_load_lds_dword v[228:229], off
    v_mfma_f32_16x16x32_bf16 v[128:131], v[216:219], a[96:99], v[128:131]
    v_exp_f32 v192, v192
    v_mfma_f32_16x16x32_bf16 v[132:135], v[216:219], a[100:103], v[132:135]
    v_mfma_f32_16x16x32_bf16 v[136:139], v[216:219], a[104:107], v[136:139]
    v_exp_f32 v193, v193
    v_mfma_f32_16x16x32_bf16 v[140:143], v[216:219], a[108:111], v[140:143]
    v_cvt_pk_bf16_f32 v220, v192, v193
    v_mfma_f32_16x16x32_bf16 v[144:147], v[216:219], a[112:115], v[144:147]
    v_exp_f32 v194, v194
    v_mfma_f32_16x16x32_bf16 v[148:151], v[216:219], a[116:119], v[148:151]
    v_mfma_f32_16x16x32_bf16 v[152:155], v[216:219], a[120:123], v[152:155]
    v_exp_f32 v195, v195
    v_add_f32 v236, v244, v245
    v_add_f32 v237, v246, v247
    v_add_f32 v248, v248, v249
    v_add_f32 v250, v250, v251
    v_fmac_f32 v239, 0x3e800000, v248
    v_fmac_f32 v238, 0x3e800000, v250
    v_mfma_f32_16x16x32_bf16 v[156:159], v[216:219], a[124:127], v[156:159]
    v_cvt_pk_bf16_f32 v221, v194, v195
    s_waitcnt lgkmcnt(0)
    v_mfma_f32_16x16x32_bf16 v[200:203], a[32:35], a[144:147], v[252:255]
    v_exp_f32 v196, v196
    ds_read_b64_tr_b16 a[96:97], v232 offset:0
    ds_read_b64_tr_b16 a[98:99], v232 offset:4096
    ds_read_b64_tr_b16 a[100:101], v233 offset:0
    ds_read_b64_tr_b16 a[102:103], v233 offset:4096
    ds_read_b64_tr_b16 a[104:105], v232 offset:512
    ds_read_b64_tr_b16 a[106:107], v232 offset:4608
    ds_read_b64_tr_b16 a[108:109], v233 offset:512
    ds_read_b64_tr_b16 a[110:111], v233 offset:4608
    v_mfma_f32_16x16x32_bf16 v[200:203], a[36:39], a[148:151], v[200:203]
    v_mfma_f32_16x16x32_bf16 v[200:203], a[40:43], a[152:155], v[200:203]
    v_exp_f32 v197, v197
    v_mfma_f32_16x16x32_bf16 v[200:203], a[44:47], a[156:159], v[200:203]
    v_cvt_pk_bf16_f32 v222, v196, v197
    v_mfma_f32_16x16x32_bf16 v[204:207], a[48:51], a[144:147], v[252:255]
    v_exp_f32 v198, v198
    ds_read_b64_tr_b16 a[112:113], v232 offset:1024
    ds_read_b64_tr_b16 a[114:115], v232 offset:5120
    ds_read_b64_tr_b16 a[116:117], v233 offset:1024
    ds_read_b64_tr_b16 a[118:119], v233 offset:5120
    ds_read_b64_tr_b16 a[120:121], v232 offset:1536
    ds_read_b64_tr_b16 a[122:123], v232 offset:5632
    ds_read_b64_tr_b16 a[124:125], v233 offset:1536
    ds_read_b64_tr_b16 a[126:127], v233 offset:5632
    v_mfma_f32_16x16x32_bf16 v[204:207], a[52:55], a[148:151], v[204:207]
    v_mfma_f32_16x16x32_bf16 v[204:207], a[56:59], a[152:155], v[204:207]
    v_exp_f32 v199, v199
    v_mfma_f32_16x16x32_bf16 v[204:207], a[60:63], a[156:159], v[204:207]
    v_cvt_pk_bf16_f32 v223, v198, v199
    v_mfma_f32_16x16x32_bf16 v[208:211], a[0:3], a[128:131], v[252:255]
    v_exp_f32 v200, v200
    v_accvgpr_read_b32 v228, a248
    v_mfma_f32_16x16x32_bf16 v[208:211], a[4:7], a[132:135], v[208:211]
    v_accvgpr_read_b32 v230, a249
    v_mfma_f32_16x16x32_bf16 v[208:211], a[8:11], a[136:139], v[208:211]
    v_exp_f32 v201, v201
    v_mfma_f32_16x16x32_bf16 v[208:211], a[12:15], a[140:143], v[208:211]
    v_cvt_pk_bf16_f32 v224, v200, v201
    v_accvgpr_read_b32 v231, a250
    v_mfma_f32_16x16x32_bf16 v[212:215], a[16:19], a[128:131], v[252:255]
    v_exp_f32 v202, v202
    v_accvgpr_read_b32 v242, a251
    v_mfma_f32_16x16x32_bf16 v[212:215], a[20:23], a[132:135], v[212:215]
    v_mfma_f32_16x16x32_bf16 v[212:215], a[24:27], a[136:139], v[212:215]
    v_exp_f32 v203, v203
    s_lshl_b32 s33, s28, 10
    v_mfma_f32_16x16x32_bf16 v[212:215], a[28:31], a[140:143], v[212:215]
    v_cvt_pk_bf16_f32 v225, v202, v203
    v_add_u32 v229, s33, v242
    v_mfma_f32_16x16x32_bf16 v[32:35], v[220:223], a[64:67], v[32:35]
    v_exp_f32 v204, v204
    v_mfma_f32_16x16x32_bf16 v[36:39], v[220:223], a[68:71], v[36:39]
    v_add_u32 v245, 131072, v229
    v_mfma_f32_16x16x32_bf16 v[40:43], v[220:223], a[72:75], v[40:43]
    v_exp_f32 v205, v205
    v_cmp_gt_u32 vcc, 0x100, v242
    v_mfma_f32_16x16x32_bf16 v[44:47], v[220:223], a[76:79], v[44:47]
    v_cvt_pk_bf16_f32 v226, v204, v205
    v_mfma_f32_16x16x32_bf16 v[48:51], v[220:223], a[80:83], v[48:51]
    v_exp_f32 v206, v206
    s_nop 1
    v_mfma_f32_16x16x32_bf16 v[52:55], v[220:223], a[84:87], v[52:55]
    v_cndmask_b32_e64 v246, 0, 1.0, vcc
    v_mfma_f32_16x16x32_bf16 v[56:59], v[220:223], a[88:91], v[56:59]
    v_exp_f32 v207, v207
    v_mfma_f32_16x16x32_bf16 v[60:63], v[220:223], a[92:95], v[60:63]
    v_cvt_pk_bf16_f32 v227, v206, v207
    v_accvgpr_write_b32 a252, v246
    v_mfma_f32_16x16x32_bf16 a[228:231], a[236:239], v[220:223], a[228:231]
    v_mfma_f32_16x16x32_bf16 v[192:195], a[32:35], a[128:131], v[252:255]
    v_exp_f32 v208, v208
    ds_write_b128 v245, v[160:163] offset:0
    v_mfma_f32_16x16x32_bf16 v[192:195], a[36:39], a[132:135], v[192:195]
    ds_write_b128 v245, v[164:167] offset:4096
    v_mfma_f32_16x16x32_bf16 v[192:195], a[40:43], a[136:139], v[192:195]
    v_exp_f32 v209, v209
    v_mfma_f32_16x16x32_bf16 v[192:195], a[44:47], a[140:143], v[192:195]
    v_cvt_pk_bf16_f32 v216, v208, v209
    ds_write_b128 v245, v[168:171] offset:8192
    v_mfma_f32_16x16x32_bf16 v[196:199], a[48:51], a[128:131], v[252:255]
    v_exp_f32 v210, v210
    v_and_b32 v246, 0xf0, v242
    v_lshrrev_b32 v247, 8, v242
    v_lshlrev_b32 v247, 6, v247
    v_sub_u32 v246, v246, v247
    v_and_b32 v247, 16, v246
    v_mov_b32 v249, 0x3f80
    v_lshlrev_b32 v247, v247, v249
    v_cmp_gt_u32 vcc, 32, v246
    s_nop 1
    v_cndmask_b32 v249, 0, v247, vcc
    v_accvgpr_write_b32 a146, v249
    v_subrev_u32 v246, 32, v246
    v_cmp_gt_u32 vcc, 32, v246
    s_nop 1
    v_cndmask_b32 v249, 0, v247, vcc
    v_accvgpr_write_b32 a147, v249
    v_accvgpr_write_b32 a144, 0
    v_accvgpr_write_b32 a145, 0
    v_accvgpr_write_b32 a148, 0
    v_accvgpr_write_b32 a149, 0
    v_mfma_f32_16x16x32_bf16 v[196:199], a[52:55], a[132:135], v[196:199]
    ds_write_b128 v245, v[172:175] offset:12288
    v_mfma_f32_16x16x32_bf16 v[196:199], a[56:59], a[136:139], v[196:199]
    v_exp_f32 v211, v211
    v_accvgpr_read_b32 v248, a232
    v_mfma_f32_16x16x32_bf16 v[196:199], a[60:63], a[140:143], v[196:199]
    v_cvt_pk_bf16_f32 v217, v210, v211
    s_waitcnt lgkmcnt(4)
    v_mfma_f32_16x16x32_bf16 v[32:35], v[224:227], a[96:99], v[32:35]
    v_exp_f32 v212, v212
    ds_write_b128 v245, v[176:179] offset:16384
    v_mfma_f32_16x16x32_bf16 v[36:39], v[224:227], a[100:103], v[36:39]
    v_mfma_f32_16x16x32_bf16 v[40:43], v[224:227], a[104:107], v[40:43]
    v_exp_f32 v213, v213
    ds_write_b128 v245, v[180:183] offset:20480
    v_mfma_f32_16x16x32_bf16 v[44:47], v[224:227], a[108:111], v[44:47]
    v_cvt_pk_bf16_f32 v218, v212, v213
    ds_write_b128 v245, v[184:187] offset:24576
    v_mfma_f32_16x16x32_bf16 v[48:51], v[224:227], a[112:115], v[48:51]
    v_exp_f32 v214, v214
    v_mfma_f32_16x16x32_bf16 v[52:55], v[224:227], a[116:119], v[52:55]
    ds_write_b128 v245, v[188:191] offset:28672
    v_mfma_f32_16x16x32_bf16 v[56:59], v[224:227], a[120:123], v[56:59]
    v_exp_f32 v215, v215
    v_mfma_f32_16x16x32_bf16 v[60:63], v[224:227], a[124:127], v[60:63]
    v_cvt_pk_bf16_f32 v219, v214, v215
    ds_write_b32 v229, v248 offset:16384
    v_mfma_f32_16x16x32_bf16 a[228:231], a[236:239], v[224:227], a[228:231]
    v_mfma_f32_16x16x32_bf16 v[200:203], a[0:3], a[160:163], v[252:255]
    v_exp_f32 v192, v192
    v_mfma_f32_16x16x32_bf16 v[200:203], a[4:7], a[164:167], v[200:203]
    v_mfma_f32_16x16x32_bf16 v[200:203], a[8:11], a[168:171], v[200:203]
    v_exp_f32 v193, v193
    v_mfma_f32_16x16x32_bf16 v[200:203], a[12:15], a[172:175], v[200:203]
    v_cvt_pk_bf16_f32 v220, v192, v193
    v_mfma_f32_16x16x32_bf16 v[204:207], a[16:19], a[160:163], v[252:255]
    v_exp_f32 v194, v194
    v_accvgpr_read_b32 v246, a228
    v_add_f32 v237, v237, v246
    v_mov_b32 v243, v237
    v_mov_b32 v244, v237
    v_rcp_f32 v237, v237
    s_nop 0
    s_nop 0
    v_mfma_f32_16x16x4_f32 v[232:235], v237, a252, 0
    v_mfma_f32_16x16x32_bf16 v[204:207], a[20:23], a[164:167], v[204:207]
    v_mfma_f32_16x16x32_bf16 v[204:207], a[24:27], a[168:171], v[204:207]
    v_exp_f32 v195, v195
    v_mfma_f32_16x16x32_bf16 v[204:207], a[28:31], a[172:175], v[204:207]
    v_cvt_pk_bf16_f32 v221, v194, v195
    v_mfma_f32_16x16x32_bf16 v[0:3], v[216:219], a[64:67], v[0:3]
    v_exp_f32 v196, v196
    v_mfma_f32_16x16x32_bf16 v[4:7], v[216:219], a[68:71], v[4:7]
    v_mfma_f32_16x16x32_bf16 v[8:11], v[216:219], a[72:75], v[8:11]
    v_exp_f32 v197, v197
    v_mfma_f32_16x16x32_bf16 v[12:15], v[216:219], a[76:79], v[12:15]
    v_cvt_pk_bf16_f32 v222, v196, v197
    v_mfma_f32_16x16x32_bf16 v[16:19], v[216:219], a[80:83], v[16:19]
    v_exp_f32 v198, v198
    v_mfma_f32_16x16x32_bf16 v[20:23], v[216:219], a[84:87], v[20:23]
    v_mfma_f32_16x16x32_bf16 v[24:27], v[216:219], a[88:91], v[24:27]
    v_exp_f32 v199, v199
    v_mfma_f32_16x16x32_bf16 v[28:31], v[216:219], a[92:95], v[28:31]
    v_cvt_pk_bf16_f32 v223, v198, v199
    v_mfma_f32_16x16x32_bf16 a[224:227], a[236:239], v[216:219], a[224:227]
    v_pk_mul_f32 v[32:33], v[32:33], v[232:233]
    v_pk_mul_f32 v[34:35], v[34:35], v[234:235]
    v_pk_mul_f32 v[36:37], v[36:37], v[232:233]
    v_pk_mul_f32 v[38:39], v[38:39], v[234:235]
    v_pk_mul_f32 v[40:41], v[40:41], v[232:233]
    v_pk_mul_f32 v[42:43], v[42:43], v[234:235]
    v_pk_mul_f32 v[44:45], v[44:45], v[232:233]
    v_pk_mul_f32 v[46:47], v[46:47], v[234:235]
    v_cvt_pk_bf16_f32 v32, v32, v33
    v_cvt_pk_bf16_f32 v33, v34, v35
    s_waitcnt lgkmcnt(0)
    s_barrier
    v_cvt_pk_bf16_f32 v34, v36, v37
    v_cvt_pk_bf16_f32 v35, v38, v39
    v_cvt_pk_bf16_f32 v40, v40, v41
    v_cvt_pk_bf16_f32 v41, v42, v43
    v_cvt_pk_bf16_f32 v42, v44, v45
    v_cvt_pk_bf16_f32 v43, v46, v47
    v_mfma_f32_16x16x32_bf16 v[36:39], v[32:35], a[146:149], 0
    v_mfma_f32_16x16x32_bf16 v[44:47], v[32:35], a[144:147], 0
    v_mfma_f32_16x16x32_bf16 v[32:35], v[40:43], a[146:149], 0
    v_mfma_f32_16x16x32_bf16 v[188:191], v[40:43], a[144:147], 0
    s_nop 4
    v_cvt_pk_bf16_f32 v36, v36, v37
    v_cvt_pk_bf16_f32 v37, v38, v39
    v_cvt_pk_bf16_f32 v38, v44, v45
    v_cvt_pk_bf16_f32 v39, v46, v47
    ds_write2_b64 v228, v[36:37], v[38:39] offset0:0 offset1:4
    v_cvt_pk_bf16_f32 v32, v32, v33
    v_cvt_pk_bf16_f32 v33, v34, v35
    v_cvt_pk_bf16_f32 v34, v188, v189
    v_cvt_pk_bf16_f32 v35, v190, v191
    ds_write2_b64 v228, v[32:33], v[34:35] offset0:8 offset1:12
    ds_read_b128 v[32:35], v230 offset:0
    ds_read_b128 v[36:39], v230 offset:2176
    v_mfma_f32_16x16x32_bf16 v[208:211], a[32:35], a[160:163], v[252:255]
    v_exp_f32 v200, v200
    s_lshl_b32 s33, s58, 14
    s_add_u32 s33, s33, 131072
    v_add_u32 v245, s33, v242
    s_lshl_b32 s41, s58, 7
    s_add_u32 s41, s41, 81920
    ds_read_b128 v[160:163], v245 offset:0
    ds_read_b128 v[164:167], v245 offset:4096
    ds_read_b128 v[168:171], v245 offset:8192
    ds_read_b128 v[172:175], v245 offset:12288
    ds_read_b128 v[176:179], v245 offset:1024
    ds_read_b128 v[180:183], v245 offset:5120
    ds_read_b128 v[184:187], v245 offset:9216
    ds_read_b128 v[188:191], v245 offset:13312
    ds_read_b32 v241, v242 offset:16384
    ds_read_b32 v249, v242 offset:17408
    ds_read_b32 v250, v242 offset:18432
    ds_read_b32 v251, v242 offset:19456
    v_mfma_f32_16x16x32_bf16 v[208:211], a[36:39], a[164:167], v[208:211]
    v_add_f32 v238, v238, v200
    v_mfma_f32_16x16x32_bf16 v[208:211], a[40:43], a[168:171], v[208:211]
    v_exp_f32 v201, v201
    v_mfma_f32_16x16x32_bf16 v[208:211], a[44:47], a[172:175], v[208:211]
    v_cvt_pk_bf16_f32 v224, v200, v201
    v_add_f32 v238, v238, v201
    v_mfma_f32_16x16x32_bf16 v[212:215], a[48:51], a[160:163], v[252:255]
    v_exp_f32 v202, v202
    v_mfma_f32_16x16x32_bf16 v[212:215], a[52:55], a[164:167], v[212:215]
    v_add_f32 v238, v238, v202
    v_mfma_f32_16x16x32_bf16 v[212:215], a[56:59], a[168:171], v[212:215]
    v_exp_f32 v203, v203
    v_mfma_f32_16x16x32_bf16 v[212:215], a[60:63], a[172:175], v[212:215]
    v_cvt_pk_bf16_f32 v225, v202, v203
    v_add_f32 v238, v238, v203
    v_mfma_f32_16x16x32_bf16 v[0:3], v[220:223], a[96:99], v[0:3]
    v_exp_f32 v204, v204
    v_mfma_f32_16x16x32_bf16 v[4:7], v[220:223], a[100:103], v[4:7]
    v_add_f32 v238, v238, v204
    v_mfma_f32_16x16x32_bf16 v[8:11], v[220:223], a[104:107], v[8:11]
    v_exp_f32 v205, v205
    v_mfma_f32_16x16x32_bf16 v[12:15], v[220:223], a[108:111], v[12:15]
    v_cvt_pk_bf16_f32 v226, v204, v205
    v_add_f32 v238, v238, v205
    v_mfma_f32_16x16x32_bf16 v[16:19], v[220:223], a[112:115], v[16:19]
    v_exp_f32 v206, v206
    v_mfma_f32_16x16x32_bf16 v[20:23], v[220:223], a[116:119], v[20:23]
    v_add_f32 v238, v238, v206
    v_mfma_f32_16x16x32_bf16 v[24:27], v[220:223], a[120:123], v[24:27]
    v_exp_f32 v207, v207
    v_mfma_f32_16x16x32_bf16 v[28:31], v[220:223], a[124:127], v[28:31]
    v_cvt_pk_bf16_f32 v227, v206, v207
    v_add_f32 v238, v238, v207
    v_mfma_f32_16x16x32_bf16 a[224:227], a[236:239], v[220:223], a[224:227]
    s_waitcnt lgkmcnt(13)
    buffer_store_dwordx4 v[32:35], v231, s[20:23], s37 offen offset:0 nt
    s_waitcnt lgkmcnt(12)
    buffer_store_dwordx4 v[36:39], v231, s[20:23], s37 offen offset:2048 nt
    v_pk_mul_f32 v[48:49], v[48:49], v[232:233]
    v_pk_mul_f32 v[50:51], v[50:51], v[234:235]
    v_pk_mul_f32 v[52:53], v[52:53], v[232:233]
    v_pk_mul_f32 v[54:55], v[54:55], v[234:235]
    v_pk_mul_f32 v[56:57], v[56:57], v[232:233]
    v_pk_mul_f32 v[58:59], v[58:59], v[234:235]
    v_pk_mul_f32 v[60:61], v[60:61], v[232:233]
    v_pk_mul_f32 v[62:63], v[62:63], v[234:235]
    v_cvt_pk_bf16_f32 v48, v48, v49
    v_cvt_pk_bf16_f32 v49, v50, v51
    v_cvt_pk_bf16_f32 v50, v52, v53
    v_cvt_pk_bf16_f32 v51, v54, v55
    v_cvt_pk_bf16_f32 v56, v56, v57
    v_cvt_pk_bf16_f32 v57, v58, v59
    v_cvt_pk_bf16_f32 v58, v60, v61
    v_cvt_pk_bf16_f32 v59, v62, v63
    v_mfma_f32_16x16x32_bf16 v[52:55], v[48:51], a[146:149], 0
    v_mfma_f32_16x16x32_bf16 v[60:63], v[48:51], a[144:147], 0
    v_mfma_f32_16x16x32_bf16 v[48:51], v[56:59], a[146:149], 0
    v_mfma_f32_16x16x32_bf16 v[44:47], v[56:59], a[144:147], 0
    s_nop 4
    v_cvt_pk_bf16_f32 v52, v52, v53
    v_cvt_pk_bf16_f32 v53, v54, v55
    v_cvt_pk_bf16_f32 v54, v60, v61
    v_cvt_pk_bf16_f32 v55, v62, v63
    ds_write2_b64 v228, v[52:53], v[54:55] offset0:16 offset1:20
    v_cvt_pk_bf16_f32 v48, v48, v49
    v_cvt_pk_bf16_f32 v49, v50, v51
    v_cvt_pk_bf16_f32 v50, v44, v45
    v_cvt_pk_bf16_f32 v51, v46, v47
    ds_write2_b64 v228, v[48:49], v[50:51] offset0:24 offset1:28
    ds_read_b128 v[48:51], v230 offset:128
    ds_read_b128 v[52:55], v230 offset:2304
    s_waitcnt lgkmcnt(11)
    v_add_f32 v160, v160, v176
    v_add_f32 v161, v161, v177
    v_add_f32 v162, v162, v178
    v_add_f32 v163, v163, v179
    s_waitcnt lgkmcnt(10)
    v_add_f32 v164, v164, v180
    v_add_f32 v165, v165, v181
    v_add_f32 v166, v166, v182
    v_add_f32 v167, v167, v183
    s_waitcnt lgkmcnt(9)
    v_add_f32 v168, v168, v184
    v_add_f32 v169, v169, v185
    v_add_f32 v170, v170, v186
    v_add_f32 v171, v171, v187
    s_waitcnt lgkmcnt(8)
    v_add_f32 v172, v172, v188
    v_add_f32 v173, v173, v189
    v_add_f32 v174, v174, v190
    v_add_f32 v175, v175, v191
    v_mfma_f32_16x16x32_bf16 v[192:195], a[0:3], a[176:179], v[252:255]
    v_exp_f32 v208, v208
    ds_read_b128 v[176:179], v245 offset:2048
    ds_read_b128 v[180:183], v245 offset:6144
    ds_read_b128 v[184:187], v245 offset:10240
    ds_read_b128 v[188:191], v245 offset:14336
    v_mfma_f32_16x16x32_bf16 v[192:195], a[4:7], a[180:183], v[192:195]
    v_add_f32 v238, v238, v208
    v_mfma_f32_16x16x32_bf16 v[192:195], a[8:11], a[184:187], v[192:195]
    v_exp_f32 v209, v209
    v_mfma_f32_16x16x32_bf16 v[192:195], a[12:15], a[188:191], v[192:195]
    v_cvt_pk_bf16_f32 v216, v208, v209
    v_add_f32 v238, v238, v209
    v_mfma_f32_16x16x32_bf16 v[196:199], a[16:19], a[176:179], v[252:255]
    v_exp_f32 v210, v210
    v_accvgpr_read_b32 v246, a224
    v_add_f32 v236, v236, v246
    v_min_f32 v243, v243, v236
    v_max_f32 v244, v244, v236
    v_rcp_f32 v236, v236
    s_nop 0
    s_nop 0
    v_mfma_f32_16x16x4_f32 v[40:43], v236, a252, 0
    v_mfma_f32_16x16x32_bf16 v[196:199], a[20:23], a[180:183], v[196:199]
    v_add_f32 v238, v238, v210
    v_mfma_f32_16x16x32_bf16 v[196:199], a[24:27], a[184:187], v[196:199]
    v_exp_f32 v211, v211
    v_mfma_f32_16x16x32_bf16 v[196:199], a[28:31], a[188:191], v[196:199]
    v_cvt_pk_bf16_f32 v217, v210, v211
    v_add_f32 v238, v238, v211
    v_mfma_f32_16x16x32_bf16 v[64:67], v[224:227], a[64:67], v[64:67]
    v_exp_f32 v212, v212
    v_mfma_f32_16x16x32_bf16 v[68:71], v[224:227], a[68:71], v[68:71]
    v_add_f32 v238, v238, v212
    v_mfma_f32_16x16x32_bf16 v[72:75], v[224:227], a[72:75], v[72:75]
    v_exp_f32 v213, v213
    v_mfma_f32_16x16x32_bf16 v[76:79], v[224:227], a[76:79], v[76:79]
    v_cvt_pk_bf16_f32 v218, v212, v213
    v_add_f32 v238, v238, v213
    v_mfma_f32_16x16x32_bf16 v[80:83], v[224:227], a[80:83], v[80:83]
    v_exp_f32 v214, v214
    v_mfma_f32_16x16x32_bf16 v[84:87], v[224:227], a[84:87], v[84:87]
    v_add_f32 v238, v238, v214
    v_mfma_f32_16x16x32_bf16 v[88:91], v[224:227], a[88:91], v[88:91]
    v_exp_f32 v215, v215
    v_mfma_f32_16x16x32_bf16 v[92:95], v[224:227], a[92:95], v[92:95]
    v_cvt_pk_bf16_f32 v219, v214, v215
    v_add_f32 v238, v238, v215
    s_waitcnt lgkmcnt(5)
    buffer_store_dwordx4 v[48:51], v231, s[20:23], s37 offen offset:128 nt
    s_waitcnt lgkmcnt(4)
    buffer_store_dwordx4 v[52:55], v231, s[20:23], s37 offen offset:2176 nt
    v_pk_mul_f32 v[0:1], v[0:1], v[40:41]
    v_pk_mul_f32 v[2:3], v[2:3], v[42:43]
    v_pk_mul_f32 v[4:5], v[4:5], v[40:41]
    v_pk_mul_f32 v[6:7], v[6:7], v[42:43]
    v_pk_mul_f32 v[8:9], v[8:9], v[40:41]
    v_pk_mul_f32 v[10:11], v[10:11], v[42:43]
    v_pk_mul_f32 v[12:13], v[12:13], v[40:41]
    v_pk_mul_f32 v[14:15], v[14:15], v[42:43]
    v_cvt_pk_bf16_f32 v0, v0, v1
    v_cvt_pk_bf16_f32 v1, v2, v3
    v_cvt_pk_bf16_f32 v2, v4, v5
    v_cvt_pk_bf16_f32 v3, v6, v7
    v_cvt_pk_bf16_f32 v8, v8, v9
    v_cvt_pk_bf16_f32 v9, v10, v11
    v_cvt_pk_bf16_f32 v10, v12, v13
    v_cvt_pk_bf16_f32 v11, v14, v15
    v_mfma_f32_16x16x32_bf16 v[4:7], v[0:3], a[146:149], 0
    v_mfma_f32_16x16x32_bf16 v[12:15], v[0:3], a[144:147], 0
    v_mfma_f32_16x16x32_bf16 v[0:3], v[8:11], a[146:149], 0
    v_mfma_f32_16x16x32_bf16 v[44:47], v[8:11], a[144:147], 0
    s_nop 4
    v_cvt_pk_bf16_f32 v4, v4, v5
    v_cvt_pk_bf16_f32 v5, v6, v7
    v_cvt_pk_bf16_f32 v6, v12, v13
    v_cvt_pk_bf16_f32 v7, v14, v15
    ds_write2_b64 v228, v[4:5], v[6:7] offset0:0 offset1:4
    v_cvt_pk_bf16_f32 v0, v0, v1
    v_cvt_pk_bf16_f32 v1, v2, v3
    v_cvt_pk_bf16_f32 v2, v44, v45
    v_cvt_pk_bf16_f32 v3, v46, v47
    ds_write2_b64 v228, v[0:1], v[2:3] offset0:8 offset1:12
    ds_read_b128 v[0:3], v230 offset:0
    ds_read_b128 v[4:7], v230 offset:2176
    s_waitcnt lgkmcnt(7)
    v_add_f32 v160, v160, v176
    v_add_f32 v161, v161, v177
    v_add_f32 v162, v162, v178
    v_add_f32 v163, v163, v179
    s_waitcnt lgkmcnt(6)
    v_add_f32 v164, v164, v180
    v_add_f32 v165, v165, v181
    v_add_f32 v166, v166, v182
    v_add_f32 v167, v167, v183
    s_waitcnt lgkmcnt(5)
    v_add_f32 v168, v168, v184
    v_add_f32 v169, v169, v185
    v_add_f32 v170, v170, v186
    v_add_f32 v171, v171, v187
    s_waitcnt lgkmcnt(4)
    v_add_f32 v172, v172, v188
    v_add_f32 v173, v173, v189
    v_add_f32 v174, v174, v190
    v_add_f32 v175, v175, v191
    v_add_f32 v241, v241, v249
    v_add_f32 v250, v250, v251
    v_add_f32 v241, v241, v250
    v_mfma_f32_16x16x32_bf16 v[200:203], a[32:35], a[176:179], v[252:255]
    v_exp_f32 v192, v192
    ds_read_b128 v[176:179], v245 offset:3072
    ds_read_b128 v[180:183], v245 offset:7168
    ds_read_b128 v[184:187], v245 offset:11264
    ds_read_b128 v[188:191], v245 offset:15360
    v_mfma_f32_16x16x32_bf16 v[200:203], a[36:39], a[180:183], v[200:203]
    v_add_f32 v239, v239, v192
    v_mfma_f32_16x16x32_bf16 v[200:203], a[40:43], a[184:187], v[200:203]
    v_exp_f32 v193, v193
    v_mfma_f32_16x16x32_bf16 v[200:203], a[44:47], a[188:191], v[200:203]
    v_cvt_pk_bf16_f32 v220, v192, v193
    v_add_f32 v239, v239, v193
    v_mfma_f32_16x16x32_bf16 v[204:207], a[48:51], a[176:179], v[252:255]
    v_exp_f32 v194, v194
    v_mfma_f32_16x16x32_bf16 v[204:207], a[52:55], a[180:183], v[204:207]
    v_add_f32 v239, v239, v194
    v_mfma_f32_16x16x32_bf16 v[204:207], a[56:59], a[184:187], v[204:207]
    v_exp_f32 v195, v195
    v_mfma_f32_16x16x32_bf16 v[204:207], a[60:63], a[188:191], v[204:207]
    v_cvt_pk_bf16_f32 v221, v194, v195
    v_add_f32 v239, v239, v195
    v_mfma_f32_16x16x32_bf16 v[64:67], v[216:219], a[96:99], v[64:67]
    v_exp_f32 v196, v196
    v_mfma_f32_16x16x32_bf16 v[68:71], v[216:219], a[100:103], v[68:71]
    v_add_f32 v239, v239, v196
    v_mfma_f32_16x16x32_bf16 v[72:75], v[216:219], a[104:107], v[72:75]
    v_exp_f32 v197, v197
    v_mfma_f32_16x16x32_bf16 v[76:79], v[216:219], a[108:111], v[76:79]
    v_cvt_pk_bf16_f32 v222, v196, v197
    v_add_f32 v239, v239, v197
    v_mfma_f32_16x16x32_bf16 v[80:83], v[216:219], a[112:115], v[80:83]
    v_exp_f32 v198, v198
    v_mfma_f32_16x16x32_bf16 v[84:87], v[216:219], a[116:119], v[84:87]
    v_add_f32 v239, v239, v198
    v_mfma_f32_16x16x32_bf16 v[88:91], v[216:219], a[120:123], v[88:91]
    v_exp_f32 v199, v199
    v_mfma_f32_16x16x32_bf16 v[92:95], v[216:219], a[124:127], v[92:95]
    v_cvt_pk_bf16_f32 v223, v198, v199
    v_add_f32 v239, v239, v199
    s_waitcnt lgkmcnt(5)
    buffer_store_dwordx4 v[0:3], v231, s[20:23], s36 offen offset:0 nt
    s_waitcnt lgkmcnt(4)
    buffer_store_dwordx4 v[4:7], v231, s[20:23], s36 offen offset:2048 nt
    v_mov_b32 v247, v238
    v_pk_mul_f32 v[16:17], v[16:17], v[40:41]
    v_pk_mul_f32 v[18:19], v[18:19], v[42:43]
    v_permlane16_swap_b32 v238, v247
    v_pk_mul_f32 v[20:21], v[20:21], v[40:41]
    v_add_f32 v238, v238, v247
    v_mov_b32 v247, v238
    v_pk_mul_f32 v[22:23], v[22:23], v[42:43]
    v_pk_mul_f32 v[24:25], v[24:25], v[40:41]
    v_permlane32_swap_b32 v238, v247
    v_pk_mul_f32 v[26:27], v[26:27], v[42:43]
    v_add_f32 v238, v238, v247
    v_min_f32 v243, v243, v238
    v_max_f32 v244, v244, v238
    v_rcp_f32 v238, v238
    v_pk_mul_f32 v[28:29], v[28:29], v[40:41]
    v_pk_mul_f32 v[30:31], v[30:31], v[42:43]
    v_mfma_f32_16x16x4_f32 v[8:11], v238, a252, 0
    v_cvt_pk_bf16_f32 v16, v16, v17
    v_cvt_pk_bf16_f32 v17, v18, v19
    v_cvt_pk_bf16_f32 v18, v20, v21
    v_cvt_pk_bf16_f32 v19, v22, v23
    v_cvt_pk_bf16_f32 v24, v24, v25
    v_cvt_pk_bf16_f32 v25, v26, v27
    v_cvt_pk_bf16_f32 v26, v28, v29
    v_cvt_pk_bf16_f32 v27, v30, v31
    v_mfma_f32_16x16x32_bf16 v[20:23], v[16:19], a[146:149], 0
    v_mfma_f32_16x16x32_bf16 v[28:31], v[16:19], a[144:147], 0
    v_mfma_f32_16x16x32_bf16 v[16:19], v[24:27], a[146:149], 0
    v_mfma_f32_16x16x32_bf16 v[12:15], v[24:27], a[144:147], 0
    s_nop 4
    v_cvt_pk_bf16_f32 v20, v20, v21
    v_cvt_pk_bf16_f32 v21, v22, v23
    v_cvt_pk_bf16_f32 v22, v28, v29
    v_cvt_pk_bf16_f32 v23, v30, v31
    ds_write2_b64 v228, v[20:21], v[22:23] offset0:16 offset1:20
    v_cvt_pk_bf16_f32 v16, v16, v17
    v_cvt_pk_bf16_f32 v17, v18, v19
    v_cvt_pk_bf16_f32 v18, v12, v13
    v_cvt_pk_bf16_f32 v19, v14, v15
    ds_write2_b64 v228, v[16:17], v[18:19] offset0:24 offset1:28
    ds_read_b128 v[16:19], v230 offset:128
    ds_read_b128 v[20:23], v230 offset:2304
    v_min_f32 v243, v243, v241
    v_max_f32 v244, v244, v241
    v_rcp_f32 v241, v241
    s_waitcnt lgkmcnt(7)
    v_add_f32 v160, v160, v176
    v_add_f32 v161, v161, v177
    v_add_f32 v162, v162, v178
    v_add_f32 v163, v163, v179
    s_waitcnt lgkmcnt(6)
    v_add_f32 v164, v164, v180
    v_add_f32 v165, v165, v181
    v_add_f32 v166, v166, v182
    v_add_f32 v167, v167, v183
    s_waitcnt lgkmcnt(5)
    v_add_f32 v168, v168, v184
    v_add_f32 v169, v169, v185
    v_add_f32 v170, v170, v186
    v_add_f32 v171, v171, v187
    s_waitcnt lgkmcnt(4)
    v_add_f32 v172, v172, v188
    v_add_f32 v173, v173, v189
    v_add_f32 v174, v174, v190
    v_add_f32 v175, v175, v191
    v_mfma_f32_16x16x4_f32 v[176:179], v241, a252, 0
    v_mfma_f32_16x16x32_bf16 v[208:211], a[0:3], a[192:195], v[252:255]
    v_exp_f32 v200, v200
    v_mfma_f32_16x16x32_bf16 v[208:211], a[4:7], a[196:199], v[208:211]
    v_add_f32 v239, v239, v200
    v_mfma_f32_16x16x32_bf16 v[208:211], a[8:11], a[200:203], v[208:211]
    v_exp_f32 v201, v201
    v_mfma_f32_16x16x32_bf16 v[208:211], a[12:15], a[204:207], v[208:211]
    v_cvt_pk_bf16_f32 v224, v200, v201
    v_add_f32 v239, v239, v201
    v_mfma_f32_16x16x32_bf16 v[212:215], a[16:19], a[192:195], v[252:255]
    v_exp_f32 v202, v202
    v_mfma_f32_16x16x32_bf16 v[212:215], a[20:23], a[196:199], v[212:215]
    v_add_f32 v239, v239, v202
    v_mfma_f32_16x16x32_bf16 v[212:215], a[24:27], a[200:203], v[212:215]
    v_exp_f32 v203, v203
    v_mfma_f32_16x16x32_bf16 v[212:215], a[28:31], a[204:207], v[212:215]
    v_cvt_pk_bf16_f32 v225, v202, v203
    v_add_f32 v239, v239, v203
    v_mfma_f32_16x16x32_bf16 v[96:99], v[220:223], a[64:67], v[96:99]
    v_exp_f32 v204, v204
    v_mfma_f32_16x16x32_bf16 v[100:103], v[220:223], a[68:71], v[100:103]
    v_add_f32 v239, v239, v204
    v_mfma_f32_16x16x32_bf16 v[104:107], v[220:223], a[72:75], v[104:107]
    v_exp_f32 v205, v205
    v_mfma_f32_16x16x32_bf16 v[108:111], v[220:223], a[76:79], v[108:111]
    v_cvt_pk_bf16_f32 v226, v204, v205
    v_add_f32 v239, v239, v205
    v_mfma_f32_16x16x32_bf16 v[112:115], v[220:223], a[80:83], v[112:115]
    v_exp_f32 v206, v206
    v_mfma_f32_16x16x32_bf16 v[116:119], v[220:223], a[84:87], v[116:119]
    v_add_f32 v239, v239, v206
    v_mfma_f32_16x16x32_bf16 v[120:123], v[220:223], a[88:91], v[120:123]
    v_exp_f32 v207, v207
    v_mfma_f32_16x16x32_bf16 v[124:127], v[220:223], a[92:95], v[124:127]
    v_cvt_pk_bf16_f32 v227, v206, v207
    v_add_f32 v239, v239, v207
    s_waitcnt lgkmcnt(1)
    buffer_store_dwordx4 v[16:19], v231, s[20:23], s36 offen offset:128 nt
    s_waitcnt lgkmcnt(0)
    buffer_store_dwordx4 v[20:23], v231, s[20:23], s36 offen offset:2176 nt
    v_pk_mul_f32 v[64:65], v[64:65], v[8:9]
    v_pk_mul_f32 v[66:67], v[66:67], v[10:11]
    v_pk_mul_f32 v[68:69], v[68:69], v[8:9]
    v_pk_mul_f32 v[70:71], v[70:71], v[10:11]
    v_pk_mul_f32 v[72:73], v[72:73], v[8:9]
    v_pk_mul_f32 v[74:75], v[74:75], v[10:11]
    v_pk_mul_f32 v[76:77], v[76:77], v[8:9]
    v_pk_mul_f32 v[78:79], v[78:79], v[10:11]
    v_cvt_pk_bf16_f32 v64, v64, v65
    v_cvt_pk_bf16_f32 v65, v66, v67
    v_cvt_pk_bf16_f32 v66, v68, v69
    v_cvt_pk_bf16_f32 v67, v70, v71
    v_cvt_pk_bf16_f32 v72, v72, v73
    v_cvt_pk_bf16_f32 v73, v74, v75
    v_cvt_pk_bf16_f32 v74, v76, v77
    v_cvt_pk_bf16_f32 v75, v78, v79
    v_mfma_f32_16x16x32_bf16 v[68:71], v[64:67], a[146:149], 0
    v_mfma_f32_16x16x32_bf16 v[76:79], v[64:67], a[144:147], 0
    v_mfma_f32_16x16x32_bf16 v[64:67], v[72:75], a[146:149], 0
    v_mfma_f32_16x16x32_bf16 v[12:15], v[72:75], a[144:147], 0
    s_nop 4
    v_cvt_pk_bf16_f32 v68, v68, v69
    v_cvt_pk_bf16_f32 v69, v70, v71
    v_cvt_pk_bf16_f32 v70, v76, v77
    v_cvt_pk_bf16_f32 v71, v78, v79
    ds_write2_b64 v228, v[68:69], v[70:71] offset0:0 offset1:4
    v_cvt_pk_bf16_f32 v64, v64, v65
    v_cvt_pk_bf16_f32 v65, v66, v67
    v_cvt_pk_bf16_f32 v66, v12, v13
    v_cvt_pk_bf16_f32 v67, v14, v15
    ds_write2_b64 v228, v[64:65], v[66:67] offset0:8 offset1:12
    ds_read_b128 v[64:67], v230 offset:0
    ds_read_b128 v[68:71], v230 offset:2176
    v_pk_mul_f32 v[160:161], v[160:161], v[176:177]
    v_pk_mul_f32 v[162:163], v[162:163], v[178:179]
    v_pk_mul_f32 v[164:165], v[164:165], v[176:177]
    v_pk_mul_f32 v[166:167], v[166:167], v[178:179]
    v_pk_mul_f32 v[168:169], v[168:169], v[176:177]
    v_pk_mul_f32 v[170:171], v[170:171], v[178:179]
    v_pk_mul_f32 v[172:173], v[172:173], v[176:177]
    v_pk_mul_f32 v[174:175], v[174:175], v[178:179]
    v_cvt_pk_bf16_f32 v160, v160, v161
    v_cvt_pk_bf16_f32 v161, v162, v163
    v_cvt_pk_bf16_f32 v162, v164, v165
    v_cvt_pk_bf16_f32 v163, v166, v167
    v_cvt_pk_bf16_f32 v168, v168, v169
    v_cvt_pk_bf16_f32 v169, v170, v171
    v_cvt_pk_bf16_f32 v170, v172, v173
    v_cvt_pk_bf16_f32 v171, v174, v175
    v_mfma_f32_16x16x32_bf16 v[164:167], v[160:163], a[146:149], 0
    v_mfma_f32_16x16x32_bf16 v[172:175], v[160:163], a[144:147], 0
    v_mfma_f32_16x16x32_bf16 v[160:163], v[168:171], a[146:149], 0
    v_mfma_f32_16x16x32_bf16 v[180:183], v[168:171], a[144:147], 0
    s_nop 4
    v_cvt_pk_bf16_f32 v164, v164, v165
    v_cvt_pk_bf16_f32 v165, v166, v167
    v_cvt_pk_bf16_f32 v166, v172, v173
    v_cvt_pk_bf16_f32 v167, v174, v175
    ds_write2_b64 v228, v[164:165], v[166:167] offset0:0 offset1:4
    v_cvt_pk_bf16_f32 v160, v160, v161
    v_cvt_pk_bf16_f32 v161, v162, v163
    v_cvt_pk_bf16_f32 v162, v180, v181
    v_cvt_pk_bf16_f32 v163, v182, v183
    ds_write2_b64 v228, v[160:161], v[162:163] offset0:8 offset1:12
    ds_read_b128 v[160:163], v230 offset:0
    ds_read_b128 v[164:167], v230 offset:2176
    v_mfma_f32_16x16x32_bf16 v[192:195], a[32:35], a[192:195], v[252:255]
    v_exp_f32 v208, v208
    v_mfma_f32_16x16x32_bf16 v[192:195], a[36:39], a[196:199], v[192:195]
    v_add_f32 v240, v240, v208
    v_mfma_f32_16x16x32_bf16 v[192:195], a[40:43], a[200:203], v[192:195]
    v_exp_f32 v209, v209
    v_mfma_f32_16x16x32_bf16 v[192:195], a[44:47], a[204:207], v[192:195]
    v_cvt_pk_bf16_f32 v216, v208, v209
    v_add_f32 v240, v240, v209
    v_mfma_f32_16x16x32_bf16 v[196:199], a[48:51], a[192:195], v[252:255]
    v_exp_f32 v210, v210
    v_mfma_f32_16x16x32_bf16 v[196:199], a[52:55], a[196:199], v[196:199]
    v_add_f32 v240, v240, v210
    v_mfma_f32_16x16x32_bf16 v[196:199], a[56:59], a[200:203], v[196:199]
    v_exp_f32 v211, v211
    v_mfma_f32_16x16x32_bf16 v[196:199], a[60:63], a[204:207], v[196:199]
    v_cvt_pk_bf16_f32 v217, v210, v211
    v_add_f32 v240, v240, v211
    v_mfma_f32_16x16x32_bf16 v[96:99], v[224:227], a[96:99], v[96:99]
    v_exp_f32 v212, v212
    v_mfma_f32_16x16x32_bf16 v[100:103], v[224:227], a[100:103], v[100:103]
    v_add_f32 v240, v240, v212
    v_mfma_f32_16x16x32_bf16 v[104:107], v[224:227], a[104:107], v[104:107]
    v_exp_f32 v213, v213
    v_mfma_f32_16x16x32_bf16 v[108:111], v[224:227], a[108:111], v[108:111]
    v_cvt_pk_bf16_f32 v218, v212, v213
    v_add_f32 v240, v240, v213
    v_mfma_f32_16x16x32_bf16 v[112:115], v[224:227], a[112:115], v[112:115]
    v_exp_f32 v214, v214
    v_mfma_f32_16x16x32_bf16 v[116:119], v[224:227], a[116:119], v[116:119]
    v_add_f32 v240, v240, v214
    v_mfma_f32_16x16x32_bf16 v[120:123], v[224:227], a[120:123], v[120:123]
    v_exp_f32 v215, v215
    v_mfma_f32_16x16x32_bf16 v[124:127], v[224:227], a[124:127], v[124:127]
    v_cvt_pk_bf16_f32 v219, v214, v215
    v_add_f32 v240, v240, v215
    s_waitcnt lgkmcnt(5)
    buffer_store_dwordx4 v[64:67], v231, s[20:23], s38 offen offset:0 nt
    s_waitcnt lgkmcnt(4)
    buffer_store_dwordx4 v[68:71], v231, s[20:23], s38 offen offset:2048 nt
    v_mov_b32 v247, v239
    v_pk_mul_f32 v[80:81], v[80:81], v[8:9]
    v_pk_mul_f32 v[82:83], v[82:83], v[10:11]
    v_permlane16_swap_b32 v239, v247
    v_pk_mul_f32 v[84:85], v[84:85], v[8:9]
    v_add_f32 v239, v239, v247
    v_mov_b32 v247, v239
    v_pk_mul_f32 v[86:87], v[86:87], v[10:11]
    v_pk_mul_f32 v[88:89], v[88:89], v[8:9]
    v_permlane32_swap_b32 v239, v247
    v_pk_mul_f32 v[90:91], v[90:91], v[10:11]
    v_add_f32 v239, v239, v247
    v_min_f32 v243, v243, v239
    v_max_f32 v244, v244, v239
    v_rcp_f32 v239, v239
    v_pk_mul_f32 v[92:93], v[92:93], v[8:9]
    v_pk_mul_f32 v[94:95], v[94:95], v[10:11]
    v_mfma_f32_16x16x4_f32 v[72:75], v239, a252, 0
    v_cvt_pk_bf16_f32 v80, v80, v81
    v_cvt_pk_bf16_f32 v81, v82, v83
    v_cvt_pk_bf16_f32 v82, v84, v85
    v_cvt_pk_bf16_f32 v83, v86, v87
    v_cvt_pk_bf16_f32 v88, v88, v89
    v_cvt_pk_bf16_f32 v89, v90, v91
    v_cvt_pk_bf16_f32 v90, v92, v93
    v_cvt_pk_bf16_f32 v91, v94, v95
    v_mfma_f32_16x16x32_bf16 v[84:87], v[80:83], a[146:149], 0
    v_mfma_f32_16x16x32_bf16 v[92:95], v[80:83], a[144:147], 0
    v_mfma_f32_16x16x32_bf16 v[80:83], v[88:91], a[146:149], 0
    v_mfma_f32_16x16x32_bf16 v[76:79], v[88:91], a[144:147], 0
    s_nop 4
    v_cvt_pk_bf16_f32 v84, v84, v85
    v_cvt_pk_bf16_f32 v85, v86, v87
    v_cvt_pk_bf16_f32 v86, v92, v93
    v_cvt_pk_bf16_f32 v87, v94, v95
    ds_write2_b64 v228, v[84:85], v[86:87] offset0:16 offset1:20
    v_cvt_pk_bf16_f32 v80, v80, v81
    v_cvt_pk_bf16_f32 v81, v82, v83
    v_cvt_pk_bf16_f32 v82, v76, v77
    v_cvt_pk_bf16_f32 v83, v78, v79
    ds_write2_b64 v228, v[80:81], v[82:83] offset0:24 offset1:28
    ds_read_b128 v[80:83], v230 offset:128
    ds_read_b128 v[84:87], v230 offset:2304
    s_waitcnt lgkmcnt(5)
    buffer_store_dwordx4 v[160:163], v231, s[20:23], s41 offen offset:0 nt
    s_waitcnt lgkmcnt(4)
    buffer_store_dwordx4 v[164:167], v231, s[20:23], s41 offen offset:2048 nt
    s_nop 1
    v_mfma_f32_16x16x32_bf16 v[128:131], v[216:219], a[64:67], v[128:131]
    v_exp_f32 v192, v192
    v_mfma_f32_16x16x32_bf16 v[132:135], v[216:219], a[68:71], v[132:135]
    v_add_f32 v240, v240, v192
    v_exp_f32 v193, v193
    v_mfma_f32_16x16x32_bf16 v[136:139], v[216:219], a[72:75], v[136:139]
    v_cvt_pk_bf16_f32 v220, v192, v193
    v_add_f32 v240, v240, v193
    v_exp_f32 v194, v194
    v_mfma_f32_16x16x32_bf16 v[140:143], v[216:219], a[76:79], v[140:143]
    v_add_f32 v240, v240, v194
    v_exp_f32 v195, v195
    v_mfma_f32_16x16x32_bf16 v[144:147], v[216:219], a[80:83], v[144:147]
    v_cvt_pk_bf16_f32 v221, v194, v195
    v_add_f32 v240, v240, v195
    v_exp_f32 v196, v196
    v_mfma_f32_16x16x32_bf16 v[148:151], v[216:219], a[84:87], v[148:151]
    v_add_f32 v240, v240, v196
    v_exp_f32 v197, v197
    v_mfma_f32_16x16x32_bf16 v[152:155], v[216:219], a[88:91], v[152:155]
    v_cvt_pk_bf16_f32 v222, v196, v197
    v_add_f32 v240, v240, v197
    v_exp_f32 v198, v198
    v_mfma_f32_16x16x32_bf16 v[156:159], v[216:219], a[92:95], v[156:159]
    v_add_f32 v240, v240, v198
    v_exp_f32 v199, v199
    s_nop 0
    v_cvt_pk_bf16_f32 v223, v198, v199
    v_add_f32 v240, v240, v199
    s_waitcnt lgkmcnt(1)
    buffer_store_dwordx4 v[80:83], v231, s[20:23], s38 offen offset:128 nt
    s_waitcnt lgkmcnt(0)
    buffer_store_dwordx4 v[84:87], v231, s[20:23], s38 offen offset:2176 nt
    v_pk_mul_f32 v[96:97], v[96:97], v[72:73]
    v_pk_mul_f32 v[98:99], v[98:99], v[74:75]
    v_pk_mul_f32 v[100:101], v[100:101], v[72:73]
    v_pk_mul_f32 v[102:103], v[102:103], v[74:75]
    v_pk_mul_f32 v[104:105], v[104:105], v[72:73]
    v_pk_mul_f32 v[106:107], v[106:107], v[74:75]
    v_pk_mul_f32 v[108:109], v[108:109], v[72:73]
    v_pk_mul_f32 v[110:111], v[110:111], v[74:75]
    v_cvt_pk_bf16_f32 v96, v96, v97
    v_cvt_pk_bf16_f32 v97, v98, v99
    v_cvt_pk_bf16_f32 v98, v100, v101
    v_cvt_pk_bf16_f32 v99, v102, v103
    v_cvt_pk_bf16_f32 v104, v104, v105
    v_cvt_pk_bf16_f32 v105, v106, v107
    v_cvt_pk_bf16_f32 v106, v108, v109
    v_cvt_pk_bf16_f32 v107, v110, v111
    v_mfma_f32_16x16x32_bf16 v[100:103], v[96:99], a[146:149], 0
    v_mfma_f32_16x16x32_bf16 v[108:111], v[96:99], a[144:147], 0
    v_mfma_f32_16x16x32_bf16 v[96:99], v[104:107], a[146:149], 0
    v_mfma_f32_16x16x32_bf16 v[76:79], v[104:107], a[144:147], 0
    s_nop 4
    v_cvt_pk_bf16_f32 v100, v100, v101
    v_cvt_pk_bf16_f32 v101, v102, v103
    v_cvt_pk_bf16_f32 v102, v108, v109
    v_cvt_pk_bf16_f32 v103, v110, v111
    ds_write2_b64 v228, v[100:101], v[102:103] offset0:0 offset1:4
    v_cvt_pk_bf16_f32 v96, v96, v97
    v_cvt_pk_bf16_f32 v97, v98, v99
    v_cvt_pk_bf16_f32 v98, v76, v77
    v_cvt_pk_bf16_f32 v99, v78, v79
    ds_write2_b64 v228, v[96:97], v[98:99] offset0:8 offset1:12
    ds_read_b128 v[96:99], v230 offset:0
    ds_read_b128 v[100:103], v230 offset:2176
    s_nop 1
    v_mfma_f32_16x16x32_bf16 v[128:131], v[220:223], a[96:99], v[128:131]
    v_mfma_f32_16x16x32_bf16 v[132:135], v[220:223], a[100:103], v[132:135]
    v_mfma_f32_16x16x32_bf16 v[136:139], v[220:223], a[104:107], v[136:139]
    v_mfma_f32_16x16x32_bf16 v[140:143], v[220:223], a[108:111], v[140:143]
    v_mfma_f32_16x16x32_bf16 v[144:147], v[220:223], a[112:115], v[144:147]
    v_mfma_f32_16x16x32_bf16 v[148:151], v[220:223], a[116:119], v[148:151]
    v_mfma_f32_16x16x32_bf16 v[152:155], v[220:223], a[120:123], v[152:155]
    v_mfma_f32_16x16x32_bf16 v[156:159], v[220:223], a[124:127], v[156:159]
    s_waitcnt lgkmcnt(1)
    buffer_store_dwordx4 v[96:99], v231, s[20:23], s39 offen offset:0 nt
    s_waitcnt lgkmcnt(0)
    buffer_store_dwordx4 v[100:103], v231, s[20:23], s39 offen offset:2048 nt
    v_mov_b32 v247, v240
    v_pk_mul_f32 v[112:113], v[112:113], v[72:73]
    v_pk_mul_f32 v[114:115], v[114:115], v[74:75]
    v_permlane16_swap_b32 v240, v247
    v_pk_mul_f32 v[116:117], v[116:117], v[72:73]
    v_add_f32 v240, v240, v247
    v_mov_b32 v247, v240
    v_pk_mul_f32 v[118:119], v[118:119], v[74:75]
    v_pk_mul_f32 v[120:121], v[120:121], v[72:73]
    v_permlane32_swap_b32 v240, v247
    v_pk_mul_f32 v[122:123], v[122:123], v[74:75]
    v_add_f32 v240, v240, v247
    v_min_f32 v243, v243, v240
    v_max_f32 v244, v244, v240
    v_rcp_f32 v240, v240
    v_pk_mul_f32 v[124:125], v[124:125], v[72:73]
    v_pk_mul_f32 v[126:127], v[126:127], v[74:75]
    v_mfma_f32_16x16x4_f32 v[104:107], v240, a252, 0
    v_cvt_pk_bf16_f32 v112, v112, v113
    v_cvt_pk_bf16_f32 v113, v114, v115
    v_cvt_pk_bf16_f32 v114, v116, v117
    v_cvt_pk_bf16_f32 v115, v118, v119
    v_cvt_pk_bf16_f32 v120, v120, v121
    v_cvt_pk_bf16_f32 v121, v122, v123
    v_cvt_pk_bf16_f32 v122, v124, v125
    v_cvt_pk_bf16_f32 v123, v126, v127
    v_mfma_f32_16x16x32_bf16 v[116:119], v[112:115], a[146:149], 0
    v_mfma_f32_16x16x32_bf16 v[124:127], v[112:115], a[144:147], 0
    v_mfma_f32_16x16x32_bf16 v[112:115], v[120:123], a[146:149], 0
    v_mfma_f32_16x16x32_bf16 v[108:111], v[120:123], a[144:147], 0
    s_nop 4
    v_cvt_pk_bf16_f32 v116, v116, v117
    v_cvt_pk_bf16_f32 v117, v118, v119
    v_cvt_pk_bf16_f32 v118, v124, v125
    v_cvt_pk_bf16_f32 v119, v126, v127
    ds_write2_b64 v228, v[116:117], v[118:119] offset0:16 offset1:20
    v_cvt_pk_bf16_f32 v112, v112, v113
    v_cvt_pk_bf16_f32 v113, v114, v115
    v_cvt_pk_bf16_f32 v114, v108, v109
    v_cvt_pk_bf16_f32 v115, v110, v111
    ds_write2_b64 v228, v[112:113], v[114:115] offset0:24 offset1:28
    ds_read_b128 v[112:115], v230 offset:128
    ds_read_b128 v[116:119], v230 offset:2304
    v_pk_mul_f32 v[128:129], v[128:129], v[104:105]
    v_pk_mul_f32 v[130:131], v[130:131], v[106:107]
    v_pk_mul_f32 v[144:145], v[144:145], v[104:105]
    v_pk_mul_f32 v[146:147], v[146:147], v[106:107]
    v_pk_mul_f32 v[132:133], v[132:133], v[104:105]
    v_pk_mul_f32 v[134:135], v[134:135], v[106:107]
    v_pk_mul_f32 v[148:149], v[148:149], v[104:105]
    v_pk_mul_f32 v[150:151], v[150:151], v[106:107]
    s_waitcnt lgkmcnt(1)
    buffer_store_dwordx4 v[112:115], v231, s[20:23], s39 offen offset:128 nt
    s_waitcnt lgkmcnt(0)
    buffer_store_dwordx4 v[116:119], v231, s[20:23], s39 offen offset:2176 nt
    v_pk_mul_f32 v[136:137], v[136:137], v[104:105]
    v_pk_mul_f32 v[138:139], v[138:139], v[106:107]
    v_pk_mul_f32 v[152:153], v[152:153], v[104:105]
    v_pk_mul_f32 v[154:155], v[154:155], v[106:107]
    v_pk_mul_f32 v[140:141], v[140:141], v[104:105]
    v_pk_mul_f32 v[142:143], v[142:143], v[106:107]
    v_pk_mul_f32 v[156:157], v[156:157], v[104:105]
    v_pk_mul_f32 v[158:159], v[158:159], v[106:107]
    v_cvt_pk_bf16_f32 v128, v128, v129
    v_cvt_pk_bf16_f32 v129, v130, v131
    v_cvt_pk_bf16_f32 v144, v144, v145
    v_cvt_pk_bf16_f32 v145, v146, v147
    v_cvt_pk_bf16_f32 v130, v132, v133
    v_cvt_pk_bf16_f32 v131, v134, v135
    v_cvt_pk_bf16_f32 v146, v148, v149
    v_cvt_pk_bf16_f32 v147, v150, v151
    v_cvt_pk_bf16_f32 v136, v136, v137
    v_cvt_pk_bf16_f32 v137, v138, v139
    v_cvt_pk_bf16_f32 v152, v152, v153
    v_cvt_pk_bf16_f32 v153, v154, v155
    v_cvt_pk_bf16_f32 v138, v140, v141
    v_cvt_pk_bf16_f32 v139, v142, v143
    v_cvt_pk_bf16_f32 v154, v156, v157
    v_cvt_pk_bf16_f32 v155, v158, v159
    v_mfma_f32_16x16x32_bf16 v[132:135], v[128:131], a[146:149], 0
    v_mfma_f32_16x16x32_bf16 v[140:143], v[128:131], a[144:147], 0
    v_mfma_f32_16x16x32_bf16 v[148:151], v[144:147], a[146:149], 0
    v_mfma_f32_16x16x32_bf16 v[156:159], v[144:147], a[144:147], 0
    v_mfma_f32_16x16x32_bf16 v[128:131], v[136:139], a[146:149], 0
    v_mfma_f32_16x16x32_bf16 v[108:111], v[136:139], a[144:147], 0
    v_mfma_f32_16x16x32_bf16 v[144:147], v[152:155], a[146:149], 0
    v_mfma_f32_16x16x32_bf16 v[76:79], v[152:155], a[144:147], 0
    s_nop 0
    v_cvt_pk_bf16_f32 v132, v132, v133
    v_cvt_pk_bf16_f32 v133, v134, v135
    v_cvt_pk_bf16_f32 v148, v148, v149
    v_cvt_pk_bf16_f32 v149, v150, v151
    v_cvt_pk_bf16_f32 v134, v140, v141
    v_cvt_pk_bf16_f32 v135, v142, v143
    v_cvt_pk_bf16_f32 v150, v156, v157
    v_cvt_pk_bf16_f32 v151, v158, v159
    ds_write2_b64 v228, v[132:133], v[134:135] offset0:0 offset1:4
    v_cvt_pk_bf16_f32 v128, v128, v129
    ds_write2_b64 v228, v[148:149], v[150:151] offset0:16 offset1:20
    v_cvt_pk_bf16_f32 v144, v144, v145
    v_cvt_pk_bf16_f32 v129, v130, v131
    v_cvt_pk_bf16_f32 v130, v108, v109
    v_cvt_pk_bf16_f32 v145, v146, v147
    v_cvt_pk_bf16_f32 v146, v76, v77
    v_cvt_pk_bf16_f32 v131, v110, v111
    ds_write2_b64 v228, v[128:129], v[130:131] offset0:8 offset1:12
    v_cvt_pk_bf16_f32 v147, v78, v79
    ds_write2_b64 v228, v[144:145], v[146:147] offset0:24 offset1:28
    ds_read_b128 v[128:131], v230 offset:0
    ds_read_b128 v[132:135], v230 offset:2176
    ds_read_b128 v[144:147], v230 offset:128
    ds_read_b128 v[148:151], v230 offset:2304
    s_waitcnt lgkmcnt(3)
    buffer_store_dwordx4 v[128:131], v231, s[20:23], s40 offen offset:0 nt
    s_waitcnt lgkmcnt(2)
    buffer_store_dwordx4 v[132:135], v231, s[20:23], s40 offen offset:2048 nt
    s_waitcnt lgkmcnt(1)
    buffer_store_dwordx4 v[144:147], v231, s[20:23], s40 offen offset:128 nt
    s_waitcnt lgkmcnt(0)
    buffer_store_dwordx4 v[148:151], v231, s[20:23], s40 offen offset:2176 nt
L_epi0:
    v_cmp_nge_f32 vcc, v243, s62
    s_mov_b64 s[44:45], vcc
    v_cmp_nle_f32 vcc, v244, s63
    s_or_b64 s[44:45], s[44:45], vcc
    s_cmp_lg_u64 s[44:45], 0
    s_cselect_b32 s34, 1, 0
    v_mov_b32 v246, s34
    ds_write_b32 v229, v246 offset:20480
    s_waitcnt lgkmcnt(0)
    s_barrier
    ds_read_b32 v247, v242 offset:20480
    ds_read_b32 v248, v242 offset:21504
    ds_read_b32 v249, v242 offset:22528
    ds_read_b32 v250, v242 offset:23552
    s_waitcnt lgkmcnt(0)
    v_or_b32 v247, v247, v248
    v_or3_b32 v247, v247, v249, v250
    v_cmp_ne_u32 vcc, 0, v247
    s_nop 1
    s_cmp_lg_u64 vcc, 0
    s_cbranch_scc1 L_fallback
    s_endpgm
L_cls1:
    v_mfma_f32_16x16x32_bf16 v[192:195], a[0:3], a[144:147], v[252:255]
    v_mfma_f32_16x16x32_bf16 v[192:195], a[4:7], a[148:151], v[192:195]
    v_mfma_f32_16x16x32_bf16 v[192:195], a[8:11], a[152:155], v[192:195]
    v_mfma_f32_16x16x32_bf16 v[192:195], a[12:15], a[156:159], v[192:195]
    v_mfma_f32_16x16x32_bf16 v[196:199], a[16:19], a[144:147], v[252:255]
    v_mfma_f32_16x16x32_bf16 v[196:199], a[20:23], a[148:151], v[196:199]
    v_mfma_f32_16x16x32_bf16 v[196:199], a[24:27], a[152:155], v[196:199]
    v_mfma_f32_16x16x32_bf16 v[196:199], a[28:31], a[156:159], v[196:199]
    s_nop 7
    s_mov_b32 s29, 15
    s_branch L_mid1
    .p2align 6
L_loop1:
    v_mfma_f32_16x16x32_bf16 v[208:211], a[32:35], a[192:195], v[252:255]
    v_exp_f32 v200, v200
    v_mfma_f32_16x16x32_bf16 v[208:211], a[36:39], a[196:199], v[208:211]
    ds_read_b128 a[24:27], v228 offset:6144
    v_mfma_f32_16x16x32_bf16 v[208:211], a[40:43], a[200:203], v[208:211]
    v_exp_f32 v201, v201
    v_mfma_f32_16x16x32_bf16 v[208:211], a[44:47], a[204:207], v[208:211]
    s_add_u32 s48, s30, 12288
    ds_read_b64_tr_b16 a[82:83], v230 offset:5120
    v_cvt_pk_bf16_f32 v220, v200, v201
    v_mfma_f32_16x16x32_bf16 v[212:215], a[48:51], a[192:195], v[252:255]
    s_add_u32 m0, s31, 12288
    v_exp_f32 v202, v202
    v_mfma_f32_16x16x32_bf16 v[212:215], a[52:55], a[196:199], v[212:215]
    buffer_load_dwordx4 v234, s[12:15], s48 offen nt lds
    v_mfma_f32_16x16x32_bf16 v[212:215], a[56:59], a[200:203], v[212:215]
    v_exp_f32 v203, v203
    v_mfma_f32_16x16x32_bf16 v[212:215], a[60:63], a[204:207], v[212:215]
    v_cvt_pk_bf16_f32 v221, v202, v203
    v_mfma_f32_16x16x32_bf16 v[64:67], v[224:227], a[96:99], v[64:67]
    v_exp_f32 v204, v204
    v_mfma_f32_16x16x32_bf16 v[68:71], v[224:227], a[100:103], v[68:71]
    ds_read_b128 a[28:31], v228 offset:6656
    v_mfma_f32_16x16x32_bf16 v[72:75], v[224:227], a[104:107], v[72:75]
    v_exp_f32 v205, v205
    v_mfma_f32_16x16x32_bf16 v[76:79], v[224:227], a[108:111], v[76:79]
    ds_read_b64_tr_b16 a[84:85], v231 offset:1024
    v_cvt_pk_bf16_f32 v222, v204, v205
    v_mfma_f32_16x16x32_bf16 v[80:83], v[224:227], a[112:115], v[80:83]
    v_exp_f32 v206, v206
    v_mfma_f32_16x16x32_bf16 v[84:87], v[224:227], a[116:119], v[84:87]
    ds_read_b64_tr_b16 a[86:87], v231 offset:5120
    v_xor_b32 v233, 0x8000, v233
    v_mfma_f32_16x16x32_bf16 v[88:91], v[224:227], a[120:123], v[88:91]
    v_exp_f32 v207, v207
    v_mfma_f32_16x16x32_bf16 v[92:95], v[224:227], a[124:127], v[92:95]
    s_waitcnt lgkmcnt(2)
    ds_read_b64_tr_b16 a[88:89], v230 offset:1536
    v_cvt_pk_bf16_f32 v223, v206, v207
    v_mfma_f32_16x16x32_bf16 v[192:195], a[0:3], a[144:147], v[252:255]
    v_exp_f32 v208, v208
    v_mfma_f32_16x16x32_bf16 v[192:195], a[4:7], a[148:151], v[192:195]
    v_add_f32 v240, v240, v208
    v_mfma_f32_16x16x32_bf16 v[192:195], a[8:11], a[152:155], v[192:195]
    v_exp_f32 v209, v209
    v_mfma_f32_16x16x32_bf16 v[192:195], a[12:15], a[156:159], v[192:195]
    v_cvt_pk_bf16_f32 v216, v208, v209
    v_add_f32 v240, v240, v209
    v_mfma_f32_16x16x32_bf16 v[196:199], a[16:19], a[144:147], v[252:255]
    v_exp_f32 v210, v210
    v_mfma_f32_16x16x32_bf16 v[196:199], a[20:23], a[148:151], v[196:199]
    ds_read_b64_tr_b16 a[90:91], v230 offset:5632
    v_add_f32 v240, v240, v210
    v_mfma_f32_16x16x32_bf16 v[196:199], a[24:27], a[152:155], v[196:199]
    v_exp_f32 v211, v211
    v_mfma_f32_16x16x32_bf16 v[196:199], a[28:31], a[156:159], v[196:199]
    v_cvt_pk_bf16_f32 v217, v210, v211
    v_add_f32 v240, v240, v211
    v_mfma_f32_16x16x32_bf16 v[96:99], v[220:223], a[96:99], v[96:99]
    v_exp_f32 v212, v212
    v_mfma_f32_16x16x32_bf16 v[100:103], v[220:223], a[100:103], v[100:103]
    ds_read_b64_tr_b16 a[92:93], v231 offset:1536
    v_add_f32 v240, v240, v212
    v_mfma_f32_16x16x32_bf16 v[104:107], v[220:223], a[104:107], v[104:107]
    v_exp_f32 v213, v213
    v_mfma_f32_16x16x32_bf16 v[108:111], v[220:223], a[108:111], v[108:111]
    v_cvt_pk_bf16_f32 v218, v212, v213
    v_add_f32 v240, v240, v213
    v_mfma_f32_16x16x32_bf16 v[112:115], v[220:223], a[112:115], v[112:115]
    v_exp_f32 v214, v214
    v_mfma_f32_16x16x32_bf16 v[116:119], v[220:223], a[116:119], v[116:119]
    ds_read_b64_tr_b16 a[94:95], v231 offset:5632
    v_add_f32 v240, v240, v214
    v_mfma_f32_16x16x32_bf16 v[120:123], v[220:223], a[120:123], v[120:123]
    v_exp_f32 v215, v215
    v_mfma_f32_16x16x32_bf16 v[124:127], v[220:223], a[124:127], v[124:127]
    v_cvt_pk_bf16_f32 v219, v214, v215
    v_add_f32 v240, v240, v215
    v_smfmac_f32_16x16x64_bf16 v[248:251], a[252:255], v[220:227], v243
L_mid1:
    v_mfma_f32_16x16x32_bf16 v[200:203], a[0:3], a[128:131], v[252:255]
    v_exp_f32 v192, v192
    v_mfma_f32_16x16x32_bf16 v[200:203], a[4:7], a[132:135], v[200:203]
    v_mfma_f32_16x16x32_bf16 v[200:203], a[8:11], a[136:139], v[200:203]
    v_exp_f32 v193, v193
    v_mfma_f32_16x16x32_bf16 v[200:203], a[12:15], a[140:143], v[200:203]
    v_cvt_pk_bf16_f32 v220, v192, v193
    v_mfma_f32_16x16x32_bf16 v[204:207], a[16:19], a[128:131], v[252:255]
    v_exp_f32 v194, v194
    v_mfma_f32_16x16x32_bf16 v[204:207], a[20:23], a[132:135], v[204:207]
    v_mfma_f32_16x16x32_bf16 v[204:207], a[24:27], a[136:139], v[204:207]
    v_exp_f32 v195, v195
    v_mfma_f32_16x16x32_bf16 v[204:207], a[28:31], a[140:143], v[204:207]
    v_cvt_pk_bf16_f32 v221, v194, v195
    v_mfma_f32_16x16x32_bf16 v[128:131], v[216:219], a[96:99], v[128:131]
    v_exp_f32 v196, v196
    v_mfma_f32_16x16x32_bf16 v[132:135], v[216:219], a[100:103], v[132:135]
    ds_read_b128 a[32:35], v229 offset:0
    v_mfma_f32_16x16x32_bf16 v[136:139], v[216:219], a[104:107], v[136:139]
    v_exp_f32 v197, v197
    v_mfma_f32_16x16x32_bf16 v[140:143], v[216:219], a[108:111], v[140:143]
    v_cvt_pk_bf16_f32 v222, v196, v197
    v_mfma_f32_16x16x32_bf16 v[144:147], v[216:219], a[112:115], v[144:147]
    v_exp_f32 v198, v198
    v_mfma_f32_16x16x32_bf16 v[148:151], v[216:219], a[116:119], v[148:151]
    v_mfma_f32_16x16x32_bf16 v[152:155], v[216:219], a[120:123], v[152:155]
    v_exp_f32 v199, v199
    v_mfma_f32_16x16x32_bf16 v[156:159], v[216:219], a[124:127], v[156:159]
    v_cvt_pk_bf16_f32 v223, v198, v199
    v_mfma_f32_16x16x32_bf16 v[208:211], a[0:3], a[208:211], v[252:255]
    v_exp_f32 v200, v200
    v_mfma_f32_16x16x32_bf16 v[208:211], a[4:7], a[212:215], v[208:211]
    ds_read_b128 a[36:39], v229 offset:512
    v_mfma_f32_16x16x32_bf16 v[208:211], a[8:11], a[216:219], v[208:211]
    v_exp_f32 v201, v201
    v_mfma_f32_16x16x32_bf16 v[208:211], a[12:15], a[220:223], v[208:211]
    s_add_u32 s48, s30, 0
    ds_read_b64_tr_b16 a[96:97], v232 offset:0
    v_cvt_pk_bf16_f32 v216, v200, v201
    v_mfma_f32_16x16x32_bf16 v[212:215], a[16:19], a[208:211], v[252:255]
    s_add_u32 m0, s31, 65536
    v_exp_f32 v202, v202
    v_mfma_f32_16x16x32_bf16 v[212:215], a[20:23], a[212:215], v[212:215]
    buffer_load_dwordx4 v235, s[16:19], s48 offen nt lds
    v_mfma_f32_16x16x32_bf16 v[212:215], a[24:27], a[216:219], v[212:215]
    v_exp_f32 v203, v203
    v_mfma_f32_16x16x32_bf16 v[212:215], a[28:31], a[220:223], v[212:215]
    s_waitcnt lgkmcnt(3)
    ds_read_b128 a[40:43], v229 offset:2048
    v_cvt_pk_bf16_f32 v217, v202, v203
    v_mfma_f32_16x16x32_bf16 v[32:35], v[220:223], a[64:67], v[32:35]
    v_exp_f32 v204, v204
    v_mfma_f32_16x16x32_bf16 v[36:39], v[220:223], a[68:71], v[36:39]
    ds_read_b64_tr_b16 a[98:99], v232 offset:4096
    v_mfma_f32_16x16x32_bf16 v[40:43], v[220:223], a[72:75], v[40:43]
    v_exp_f32 v205, v205
    v_mfma_f32_16x16x32_bf16 v[44:47], v[220:223], a[76:79], v[44:47]
    v_cvt_pk_bf16_f32 v218, v204, v205
    v_mfma_f32_16x16x32_bf16 v[48:51], v[220:223], a[80:83], v[48:51]
    v_exp_f32 v206, v206
    v_mfma_f32_16x16x32_bf16 v[52:55], v[220:223], a[84:87], v[52:55]
    v_mfma_f32_16x16x32_bf16 v[56:59], v[220:223], a[88:91], v[56:59]
    v_exp_f32 v207, v207
    v_mfma_f32_16x16x32_bf16 v[60:63], v[220:223], a[92:95], v[60:63]
    ds_read_b128 a[44:47], v229 offset:2560
    v_cvt_pk_bf16_f32 v219, v206, v207
    v_mfma_f32_16x16x32_bf16 v[192:195], a[0:3], a[160:163], v[252:255]
    v_exp_f32 v208, v208
    v_mfma_f32_16x16x32_bf16 v[192:195], a[4:7], a[164:167], v[192:195]
    ds_read_b128 a[48:51], v229 offset:4096
    ds_read_b64_tr_b16 a[100:101], v233 offset:0
    v_mfma_f32_16x16x32_bf16 v[192:195], a[8:11], a[168:171], v[192:195]
    v_exp_f32 v209, v209
    v_mfma_f32_16x16x32_bf16 v[192:195], a[12:15], a[172:175], v[192:195]
    s_add_u32 s48, s30, 4096
    ds_read_b64_tr_b16 a[102:103], v233 offset:4096
    v_cvt_pk_bf16_f32 v224, v208, v209
    v_mfma_f32_16x16x32_bf16 v[196:199], a[16:19], a[160:163], v[252:255]
    s_add_u32 m0, s31, 69632
    v_exp_f32 v210, v210
    v_mfma_f32_16x16x32_bf16 v[196:199], a[20:23], a[164:167], v[196:199]
    buffer_load_dwordx4 v235, s[16:19], s48 offen nt lds
    v_mfma_f32_16x16x32_bf16 v[196:199], a[24:27], a[168:171], v[196:199]
    v_exp_f32 v211, v211
    v_mfma_f32_16x16x32_bf16 v[196:199], a[28:31], a[172:175], v[196:199]
    ds_read_b64_tr_b16 a[104:105], v232 offset:512
    v_cvt_pk_bf16_f32 v225, v210, v211
    v_mfma_f32_16x16x32_bf16 v[0:3], v[216:219], a[64:67], v[0:3]
    v_exp_f32 v212, v212
    v_mfma_f32_16x16x32_bf16 v[4:7], v[216:219], a[68:71], v[4:7]
    v_mfma_f32_16x16x32_bf16 v[8:11], v[216:219], a[72:75], v[8:11]
    v_exp_f32 v213, v213
    v_mfma_f32_16x16x32_bf16 v[12:15], v[216:219], a[76:79], v[12:15]
    s_add_u32 s48, s30, 8192
    ds_read_b64_tr_b16 a[106:107], v232 offset:4608
    v_cvt_pk_bf16_f32 v226, v212, v213
    v_mfma_f32_16x16x32_bf16 v[16:19], v[216:219], a[80:83], v[16:19]
    s_add_u32 m0, s31, 73728
    v_exp_f32 v214, v214
    v_mfma_f32_16x16x32_bf16 v[20:23], v[216:219], a[84:87], v[20:23]
    buffer_load_dwordx4 v235, s[16:19], s48 offen nt lds
    v_mfma_f32_16x16x32_bf16 v[24:27], v[216:219], a[88:91], v[24:27]
    v_exp_f32 v215, v215
    v_mfma_f32_16x16x32_bf16 v[28:31], v[216:219], a[92:95], v[28:31]
    ds_read_b64_tr_b16 a[108:109], v233 offset:512
    v_cvt_pk_bf16_f32 v227, v214, v215
    v_smfmac_f32_16x16x64_bf16 v[244:247], a[252:255], v[216:223], v243
    v_mfma_f32_16x16x32_bf16 v[200:203], a[0:3], a[176:179], v[252:255]
    v_exp_f32 v192, v192
    v_mfma_f32_16x16x32_bf16 v[200:203], a[4:7], a[180:183], v[200:203]
    ds_read_b128 a[52:55], v229 offset:4608
    v_mfma_f32_16x16x32_bf16 v[200:203], a[8:11], a[184:187], v[200:203]
    v_exp_f32 v193, v193
    v_mfma_f32_16x16x32_bf16 v[200:203], a[12:15], a[188:191], v[200:203]
    ds_read_b64_tr_b16 a[110:111], v233 offset:4608
    v_cvt_pk_bf16_f32 v220, v192, v193
    v_mfma_f32_16x16x32_bf16 v[204:207], a[16:19], a[176:179], v[252:255]
    v_exp_f32 v194, v194
    v_mfma_f32_16x16x32_bf16 v[204:207], a[20:23], a[180:183], v[204:207]
    ds_read_b128 a[56:59], v229 offset:6144
    v_mfma_f32_16x16x32_bf16 v[204:207], a[24:27], a[184:187], v[204:207]
    v_exp_f32 v195, v195
    v_mfma_f32_16x16x32_bf16 v[204:207], a[28:31], a[188:191], v[204:207]
    v_cvt_pk_bf16_f32 v221, v194, v195
    v_mfma_f32_16x16x32_bf16 v[160:163], v[224:227], a[64:67], v[160:163]
    v_exp_f32 v196, v196
    v_mfma_f32_16x16x32_bf16 v[164:167], v[224:227], a[68:71], v[164:167]
    ds_read_b64_tr_b16 a[112:113], v232 offset:1024
    v_mfma_f32_16x16x32_bf16 v[168:171], v[224:227], a[72:75], v[168:171]
    v_exp_f32 v197, v197
    v_mfma_f32_16x16x32_bf16 v[172:175], v[224:227], a[76:79], v[172:175]
    ds_read_b64_tr_b16 a[114:115], v232 offset:5120
    v_cvt_pk_bf16_f32 v222, v196, v197
    v_mfma_f32_16x16x32_bf16 v[176:179], v[224:227], a[80:83], v[176:179]
    v_exp_f32 v198, v198
    v_mfma_f32_16x16x32_bf16 v[180:183], v[224:227], a[84:87], v[180:183]
    ds_read_b128 a[60:63], v229 offset:6656
    v_mfma_f32_16x16x32_bf16 v[184:187], v[224:227], a[88:91], v[184:187]
    v_exp_f32 v199, v199
    v_mfma_f32_16x16x32_bf16 v[188:191], v[224:227], a[92:95], v[188:191]
    v_cvt_pk_bf16_f32 v223, v198, v199
    v_mfma_f32_16x16x32_bf16 a[232:235], a[236:239], v[224:227], a[232:235]
    ds_read_b64_tr_b16 a[116:117], v233 offset:1024
    v_mfma_f32_16x16x32_bf16 v[208:211], a[0:3], a[192:195], v[252:255]
    v_exp_f32 v200, v200
    v_mfma_f32_16x16x32_bf16 v[208:211], a[4:7], a[196:199], v[208:211]
    ds_read_b64_tr_b16 a[118:119], v233 offset:5120
    v_mfma_f32_16x16x32_bf16 v[208:211], a[8:11], a[200:203], v[208:211]
    v_exp_f32 v201, v201
    v_mfma_f32_16x16x32_bf16 v[208:211], a[12:15], a[204:207], v[208:211]
    v_cvt_pk_bf16_f32 v216, v200, v201
    v_mfma_f32_16x16x32_bf16 v[212:215], a[16:19], a[192:195], v[252:255]
    v_exp_f32 v202, v202
    v_mfma_f32_16x16x32_bf16 v[212:215], a[20:23], a[196:199], v[212:215]
    ds_read_b64_tr_b16 a[120:121], v232 offset:1536
    ds_read_b64_tr_b16 a[122:123], v232 offset:5632
    v_mfma_f32_16x16x32_bf16 v[212:215], a[24:27], a[200:203], v[212:215]
    v_exp_f32 v203, v203
    v_mfma_f32_16x16x32_bf16 v[212:215], a[28:31], a[204:207], v[212:215]
    v_cvt_pk_bf16_f32 v217, v202, v203
    v_mfma_f32_16x16x32_bf16 v[64:67], v[220:223], a[64:67], v[64:67]
    v_exp_f32 v204, v204
    v_mfma_f32_16x16x32_bf16 v[68:71], v[220:223], a[68:71], v[68:71]
    v_mfma_f32_16x16x32_bf16 v[72:75], v[220:223], a[72:75], v[72:75]
    v_exp_f32 v205, v205
    v_mfma_f32_16x16x32_bf16 v[76:79], v[220:223], a[76:79], v[76:79]
    s_add_u32 s48, s30, 12288
    v_cvt_pk_bf16_f32 v218, v204, v205
    v_mfma_f32_16x16x32_bf16 v[80:83], v[220:223], a[80:83], v[80:83]
    s_add_u32 m0, s31, 77824
    v_exp_f32 v206, v206
    v_mfma_f32_16x16x32_bf16 v[84:87], v[220:223], a[84:87], v[84:87]
    buffer_load_dwordx4 v235, s[16:19], s48 offen nt lds
    v_mfma_f32_16x16x32_bf16 v[88:91], v[220:223], a[88:91], v[88:91]
    s_add_u32 s30, s30, 16384
    v_exp_f32 v207, v207
    v_mfma_f32_16x16x32_bf16 v[92:95], v[220:223], a[92:95], v[92:95]
    s_waitcnt lgkmcnt(4)
    s_add_u32 s31, s31, 16384
    ds_read_b64_tr_b16 a[124:125], v233 offset:1536
    v_cvt_pk_bf16_f32 v219, v206, v207
    v_mfma_f32_16x16x32_bf16 v[192:195], a[32:35], a[144:147], v[252:255]
    s_and_b32 s31, s31, 0xffff
    v_exp_f32 v208, v208
    v_mfma_f32_16x16x32_bf16 v[192:195], a[36:39], a[148:151], v[192:195]
    ds_read_b64_tr_b16 a[126:127], v233 offset:5632
    v_add_f32 v240, v240, v208
    v_mfma_f32_16x16x32_bf16 v[192:195], a[40:43], a[152:155], v[192:195]
    v_exp_f32 v209, v209
    v_mfma_f32_16x16x32_bf16 v[192:195], a[44:47], a[156:159], v[192:195]
    v_cvt_pk_bf16_f32 v224, v208, v209
    v_add_f32 v240, v240, v209
    v_mfma_f32_16x16x32_bf16 v[196:199], a[48:51], a[144:147], v[252:255]
    v_exp_f32 v210, v210
    v_mfma_f32_16x16x32_bf16 v[196:199], a[52:55], a[148:151], v[196:199]
    v_add_f32 v240, v240, v210
    v_mfma_f32_16x16x32_bf16 v[196:199], a[56:59], a[152:155], v[196:199]
    v_exp_f32 v211, v211
    v_mfma_f32_16x16x32_bf16 v[196:199], a[60:63], a[156:159], v[196:199]
    v_cvt_pk_bf16_f32 v225, v210, v211
    v_add_f32 v240, v240, v211
    v_mfma_f32_16x16x32_bf16 v[96:99], v[216:219], a[64:67], v[96:99]
    v_exp_f32 v212, v212
    v_mfma_f32_16x16x32_bf16 v[100:103], v[216:219], a[68:71], v[100:103]
    v_add_f32 v240, v240, v212
    v_mfma_f32_16x16x32_bf16 v[104:107], v[216:219], a[72:75], v[104:107]
    v_exp_f32 v213, v213
    v_mfma_f32_16x16x32_bf16 v[108:111], v[216:219], a[76:79], v[108:111]
    v_cvt_pk_bf16_f32 v226, v212, v213
    v_add_f32 v240, v240, v213
    v_mfma_f32_16x16x32_bf16 v[112:115], v[216:219], a[80:83], v[112:115]
    s_waitcnt vmcnt(8)
    v_exp_f32 v214, v214
    v_mfma_f32_16x16x32_bf16 v[116:119], v[216:219], a[84:87], v[116:119]
    s_barrier
    v_add_f32 v240, v240, v214
    v_mfma_f32_16x16x32_bf16 v[120:123], v[216:219], a[88:91], v[120:123]
    v_exp_f32 v215, v215
    v_mfma_f32_16x16x32_bf16 v[124:127], v[216:219], a[92:95], v[124:127]
    v_cvt_pk_bf16_f32 v227, v214, v215
    v_add_f32 v240, v240, v215
    v_smfmac_f32_16x16x64_bf16 v[248:251], a[252:255], v[216:223], v243
    v_mfma_f32_16x16x32_bf16 v[200:203], a[32:35], a[128:131], v[252:255]
    v_exp_f32 v192, v192
    v_mfma_f32_16x16x32_bf16 v[200:203], a[36:39], a[132:135], v[200:203]
    v_mfma_f32_16x16x32_bf16 v[200:203], a[40:43], a[136:139], v[200:203]
    v_exp_f32 v193, v193
    v_mfma_f32_16x16x32_bf16 v[200:203], a[44:47], a[140:143], v[200:203]
    s_add_u32 s48, s30, 0
    v_cvt_pk_bf16_f32 v220, v192, v193
    v_mfma_f32_16x16x32_bf16 v[204:207], a[48:51], a[128:131], v[252:255]
    s_add_u32 m0, s31, 0
    v_exp_f32 v194, v194
    v_mfma_f32_16x16x32_bf16 v[204:207], a[52:55], a[132:135], v[204:207]
    buffer_load_dwordx4 v234, s[12:15], s48 offen nt lds
    v_mfma_f32_16x16x32_bf16 v[204:207], a[56:59], a[136:139], v[204:207]
    v_exp_f32 v195, v195
    v_mfma_f32_16x16x32_bf16 v[204:207], a[60:63], a[140:143], v[204:207]
    ds_read_b128 a[0:3], v228 offset:16384
    v_cvt_pk_bf16_f32 v221, v194, v195
    v_mfma_f32_16x16x32_bf16 v[128:131], v[224:227], a[64:67], v[128:131]
    v_exp_f32 v196, v196
    v_mfma_f32_16x16x32_bf16 v[132:135], v[224:227], a[68:71], v[132:135]
    ds_read_b128 a[4:7], v228 offset:16896
    v_mfma_f32_16x16x32_bf16 v[136:139], v[224:227], a[72:75], v[136:139]
    v_exp_f32 v197, v197
    v_mfma_f32_16x16x32_bf16 v[140:143], v[224:227], a[76:79], v[140:143]
    v_cvt_pk_bf16_f32 v222, v196, v197
    v_mfma_f32_16x16x32_bf16 v[144:147], v[224:227], a[80:83], v[144:147]
    v_exp_f32 v198, v198
    v_mfma_f32_16x16x32_bf16 v[148:151], v[224:227], a[84:87], v[148:151]
    v_mfma_f32_16x16x32_bf16 v[152:155], v[224:227], a[88:91], v[152:155]
    v_exp_f32 v199, v199
    v_mfma_f32_16x16x32_bf16 v[156:159], v[224:227], a[92:95], v[156:159]
    v_cvt_pk_bf16_f32 v223, v198, v199
    v_mfma_f32_16x16x32_bf16 v[208:211], a[32:35], a[160:163], v[252:255]
    v_exp_f32 v200, v200
    v_mfma_f32_16x16x32_bf16 v[208:211], a[36:39], a[164:167], v[208:211]
    ds_read_b64_tr_b16 a[64:65], v230 offset:16384
    ds_read_b64_tr_b16 a[66:67], v230 offset:20480
    v_mfma_f32_16x16x32_bf16 v[208:211], a[40:43], a[168:171], v[208:211]
    v_exp_f32 v201, v201
    v_mfma_f32_16x16x32_bf16 v[208:211], a[44:47], a[172:175], v[208:211]
    v_cvt_pk_bf16_f32 v216, v200, v201
    v_mfma_f32_16x16x32_bf16 v[212:215], a[48:51], a[160:163], v[252:255]
    v_exp_f32 v202, v202
    v_mfma_f32_16x16x32_bf16 v[212:215], a[52:55], a[164:167], v[212:215]
    ds_read_b128 a[8:11], v228 offset:18432
    v_mfma_f32_16x16x32_bf16 v[212:215], a[56:59], a[168:171], v[212:215]
    v_exp_f32 v203, v203
    v_mfma_f32_16x16x32_bf16 v[212:215], a[60:63], a[172:175], v[212:215]
    s_waitcnt lgkmcnt(5)
    v_cvt_pk_bf16_f32 v217, v202, v203
    v_mfma_f32_16x16x32_bf16 v[32:35], v[220:223], a[96:99], v[32:35]
    v_exp_f32 v204, v204
    v_mfma_f32_16x16x32_bf16 v[36:39], v[220:223], a[100:103], v[36:39]
    ds_read_b128 a[12:15], v228 offset:18944
    v_mfma_f32_16x16x32_bf16 v[40:43], v[220:223], a[104:107], v[40:43]
    v_exp_f32 v205, v205
    v_mfma_f32_16x16x32_bf16 v[44:47], v[220:223], a[108:111], v[44:47]
    s_add_u32 s48, s30, 4096
    v_cvt_pk_bf16_f32 v218, v204, v205
    v_mfma_f32_16x16x32_bf16 v[48:51], v[220:223], a[112:115], v[48:51]
    s_add_u32 m0, s31, 4096
    v_exp_f32 v206, v206
    v_mfma_f32_16x16x32_bf16 v[52:55], v[220:223], a[116:119], v[52:55]
    buffer_load_dwordx4 v234, s[12:15], s48 offen nt lds
    v_mfma_f32_16x16x32_bf16 v[56:59], v[220:223], a[120:123], v[56:59]
    v_exp_f32 v207, v207
    v_mfma_f32_16x16x32_bf16 v[60:63], v[220:223], a[124:127], v[60:63]
    v_cvt_pk_bf16_f32 v219, v206, v207
    v_mfma_f32_16x16x32_bf16 v[192:195], a[32:35], a[176:179], v[252:255]
    v_exp_f32 v208, v208
    v_mfma_f32_16x16x32_bf16 v[192:195], a[36:39], a[180:183], v[192:195]
    ds_read_b128 a[16:19], v228 offset:20480
    ds_read_b64_tr_b16 a[68:69], v231 offset:16384
    v_mfma_f32_16x16x32_bf16 v[192:195], a[40:43], a[184:187], v[192:195]
    v_exp_f32 v209, v209
    v_mfma_f32_16x16x32_bf16 v[192:195], a[44:47], a[188:191], v[192:195]
    ds_read_b64_tr_b16 a[70:71], v231 offset:20480
    v_cvt_pk_bf16_f32 v224, v208, v209
    v_mfma_f32_16x16x32_bf16 v[196:199], a[48:51], a[176:179], v[252:255]
    v_exp_f32 v210, v210
    v_mfma_f32_16x16x32_bf16 v[196:199], a[52:55], a[180:183], v[196:199]
    ds_read_b128 a[20:23], v228 offset:20992
    ds_read_b64_tr_b16 a[72:73], v230 offset:16896
    v_mfma_f32_16x16x32_bf16 v[196:199], a[56:59], a[184:187], v[196:199]
    v_exp_f32 v211, v211
    v_mfma_f32_16x16x32_bf16 v[196:199], a[60:63], a[188:191], v[196:199]
    s_add_u32 s48, s30, 8192
    v_cvt_pk_bf16_f32 v225, v210, v211
    v_mfma_f32_16x16x32_bf16 v[0:3], v[216:219], a[96:99], v[0:3]
    s_add_u32 m0, s31, 8192
    v_exp_f32 v212, v212
    v_mfma_f32_16x16x32_bf16 v[4:7], v[216:219], a[100:103], v[4:7]
    buffer_load_dwordx4 v234, s[12:15], s48 offen nt lds
    v_mfma_f32_16x16x32_bf16 v[8:11], v[216:219], a[104:107], v[8:11]
    v_exp_f32 v213, v213
    v_mfma_f32_16x16x32_bf16 v[12:15], v[216:219], a[108:111], v[12:15]
    ds_read_b64_tr_b16 a[74:75], v230 offset:20992
    v_cvt_pk_bf16_f32 v226, v212, v213
    v_mfma_f32_16x16x32_bf16 v[16:19], v[216:219], a[112:115], v[16:19]
    v_exp_f32 v214, v214
    v_mfma_f32_16x16x32_bf16 v[20:23], v[216:219], a[116:119], v[20:23]
    v_mfma_f32_16x16x32_bf16 v[24:27], v[216:219], a[120:123], v[24:27]
    v_exp_f32 v215, v215
    v_mfma_f32_16x16x32_bf16 v[28:31], v[216:219], a[124:127], v[28:31]
    v_cvt_pk_bf16_f32 v227, v214, v215
    v_smfmac_f32_16x16x64_bf16 v[244:247], a[252:255], v[216:223], v243
    ds_read_b64_tr_b16 a[76:77], v231 offset:16896
    ds_read_b64_tr_b16 a[78:79], v231 offset:20992
    v_mfma_f32_16x16x32_bf16 v[200:203], a[32:35], a[192:195], v[252:255]
    v_exp_f32 v192, v192
    v_mfma_f32_16x16x32_bf16 v[200:203], a[36:39], a[196:199], v[200:203]
    ds_read_b128 a[24:27], v228 offset:22528
    v_mfma_f32_16x16x32_bf16 v[200:203], a[40:43], a[200:203], v[200:203]
    v_exp_f32 v193, v193
    v_mfma_f32_16x16x32_bf16 v[200:203], a[44:47], a[204:207], v[200:203]
    s_add_u32 s48, s30, 12288
    ds_read_b64_tr_b16 a[80:81], v230 offset:17408
    v_cvt_pk_bf16_f32 v220, v192, v193
    v_mfma_f32_16x16x32_bf16 v[204:207], a[48:51], a[192:195], v[252:255]
    s_add_u32 m0, s31, 12288
    v_exp_f32 v194, v194
    v_mfma_f32_16x16x32_bf16 v[204:207], a[52:55], a[196:199], v[204:207]
    buffer_load_dwordx4 v234, s[12:15], s48 offen nt lds
    v_mfma_f32_16x16x32_bf16 v[204:207], a[56:59], a[200:203], v[204:207]
    v_exp_f32 v195, v195
    v_mfma_f32_16x16x32_bf16 v[204:207], a[60:63], a[204:207], v[204:207]
    ds_read_b128 a[28:31], v228 offset:23040
    v_cvt_pk_bf16_f32 v221, v194, v195
    v_mfma_f32_16x16x32_bf16 v[64:67], v[224:227], a[96:99], v[64:67]
    v_exp_f32 v196, v196
    v_mfma_f32_16x16x32_bf16 v[68:71], v[224:227], a[100:103], v[68:71]
    ds_read_b64_tr_b16 a[82:83], v230 offset:21504
    v_mfma_f32_16x16x32_bf16 v[72:75], v[224:227], a[104:107], v[72:75]
    v_exp_f32 v197, v197
    v_mfma_f32_16x16x32_bf16 v[76:79], v[224:227], a[108:111], v[76:79]
    ds_read_b64_tr_b16 a[84:85], v231 offset:17408
    v_cvt_pk_bf16_f32 v222, v196, v197
    v_mfma_f32_16x16x32_bf16 v[80:83], v[224:227], a[112:115], v[80:83]
    v_exp_f32 v198, v198
    v_mfma_f32_16x16x32_bf16 v[84:87], v[224:227], a[116:119], v[84:87]
    ds_read_b64_tr_b16 a[86:87], v231 offset:21504
    ds_read_b64_tr_b16 a[88:89], v230 offset:17920
    v_mfma_f32_16x16x32_bf16 v[88:91], v[224:227], a[120:123], v[88:91]
    v_exp_f32 v199, v199
    v_mfma_f32_16x16x32_bf16 v[92:95], v[224:227], a[124:127], v[92:95]
    s_waitcnt lgkmcnt(4)
    ds_read_b64_tr_b16 a[90:91], v230 offset:22016
    v_cvt_pk_bf16_f32 v223, v198, v199
    v_mfma_f32_16x16x32_bf16 v[208:211], a[0:3], a[144:147], v[252:255]
    v_exp_f32 v200, v200
    v_mfma_f32_16x16x32_bf16 v[208:211], a[4:7], a[148:151], v[208:211]
    v_add_f32 v240, v240, v200
    v_mfma_f32_16x16x32_bf16 v[208:211], a[8:11], a[152:155], v[208:211]
    v_exp_f32 v201, v201
    v_mfma_f32_16x16x32_bf16 v[208:211], a[12:15], a[156:159], v[208:211]
    v_cvt_pk_bf16_f32 v216, v200, v201
    v_add_f32 v240, v240, v201
    v_mfma_f32_16x16x32_bf16 v[212:215], a[16:19], a[144:147], v[252:255]
    v_exp_f32 v202, v202
    v_mfma_f32_16x16x32_bf16 v[212:215], a[20:23], a[148:151], v[212:215]
    v_add_f32 v240, v240, v202
    v_mfma_f32_16x16x32_bf16 v[212:215], a[24:27], a[152:155], v[212:215]
    v_exp_f32 v203, v203
    v_mfma_f32_16x16x32_bf16 v[212:215], a[28:31], a[156:159], v[212:215]
    v_cvt_pk_bf16_f32 v217, v202, v203
    v_add_f32 v240, v240, v203
    v_mfma_f32_16x16x32_bf16 v[96:99], v[220:223], a[96:99], v[96:99]
    v_exp_f32 v204, v204
    v_mfma_f32_16x16x32_bf16 v[100:103], v[220:223], a[100:103], v[100:103]
    v_add_f32 v240, v240, v204
    v_mfma_f32_16x16x32_bf16 v[104:107], v[220:223], a[104:107], v[104:107]
    v_exp_f32 v205, v205
    v_mfma_f32_16x16x32_bf16 v[108:111], v[220:223], a[108:111], v[108:111]
    v_cvt_pk_bf16_f32 v218, v204, v205
    v_add_f32 v240, v240, v205
    v_mfma_f32_16x16x32_bf16 v[112:115], v[220:223], a[112:115], v[112:115]
    v_exp_f32 v206, v206
    v_mfma_f32_16x16x32_bf16 v[116:119], v[220:223], a[116:119], v[116:119]
    ds_read_b64_tr_b16 a[92:93], v231 offset:17920
    v_add_f32 v240, v240, v206
    v_mfma_f32_16x16x32_bf16 v[120:123], v[220:223], a[120:123], v[120:123]
    v_exp_f32 v207, v207
    v_mfma_f32_16x16x32_bf16 v[124:127], v[220:223], a[124:127], v[124:127]
    v_cvt_pk_bf16_f32 v219, v206, v207
    v_add_f32 v240, v240, v207
    v_smfmac_f32_16x16x64_bf16 v[248:251], a[252:255], v[220:227], v243
    ds_read_b64_tr_b16 a[94:95], v231 offset:22016
    v_mfma_f32_16x16x32_bf16 v[192:195], a[0:3], a[128:131], v[252:255]
    v_exp_f32 v208, v208
    v_mfma_f32_16x16x32_bf16 v[192:195], a[4:7], a[132:135], v[192:195]
    v_xor_b32 v228, 0x8000, v228
    v_mfma_f32_16x16x32_bf16 v[192:195], a[8:11], a[136:139], v[192:195]
    v_exp_f32 v209, v209
    v_mfma_f32_16x16x32_bf16 v[192:195], a[12:15], a[140:143], v[192:195]
    ds_read_b128 a[32:35], v229 offset:16384
    v_cvt_pk_bf16_f32 v220, v208, v209
    v_mfma_f32_16x16x32_bf16 v[196:199], a[16:19], a[128:131], v[252:255]
    v_exp_f32 v210, v210
    v_mfma_f32_16x16x32_bf16 v[196:199], a[20:23], a[132:135], v[196:199]
    ds_read_b128 a[36:39], v229 offset:16896
    v_mfma_f32_16x16x32_bf16 v[196:199], a[24:27], a[136:139], v[196:199]
    v_exp_f32 v211, v211
    v_mfma_f32_16x16x32_bf16 v[196:199], a[28:31], a[140:143], v[196:199]
    s_add_u32 s48, s30, 0
    v_cvt_pk_bf16_f32 v221, v210, v211
    v_mfma_f32_16x16x32_bf16 v[128:131], v[216:219], a[96:99], v[128:131]
    s_add_u32 m0, s31, 65536
    v_exp_f32 v212, v212
    v_mfma_f32_16x16x32_bf16 v[132:135], v[216:219], a[100:103], v[132:135]
    buffer_load_dwordx4 v235, s[16:19], s48 offen nt lds
    v_mfma_f32_16x16x32_bf16 v[136:139], v[216:219], a[104:107], v[136:139]
    v_exp_f32 v213, v213
    v_mfma_f32_16x16x32_bf16 v[140:143], v[216:219], a[108:111], v[140:143]
    s_add_u32 s48, s30, 4096
    v_cvt_pk_bf16_f32 v222, v212, v213
    v_mfma_f32_16x16x32_bf16 v[144:147], v[216:219], a[112:115], v[144:147]
    s_add_u32 m0, s31, 69632
    v_exp_f32 v214, v214
    v_mfma_f32_16x16x32_bf16 v[148:151], v[216:219], a[116:119], v[148:151]
    buffer_load_dwordx4 v235, s[16:19], s48 offen nt lds
    v_mfma_f32_16x16x32_bf16 v[152:155], v[216:219], a[120:123], v[152:155]
    v_exp_f32 v215, v215
    v_mfma_f32_16x16x32_bf16 v[156:159], v[216:219], a[124:127], v[156:159]
    v_cvt_pk_bf16_f32 v223, v214, v215
    v_mfma_f32_16x16x32_bf16 v[200:203], a[0:3], a[160:163], v[252:255]
    v_exp_f32 v192, v192
    v_mfma_f32_16x16x32_bf16 v[200:203], a[4:7], a[164:167], v[200:203]
    ds_read_b64_tr_b16 a[96:97], v232 offset:16384
    v_mfma_f32_16x16x32_bf16 v[200:203], a[8:11], a[168:171], v[200:203]
    v_exp_f32 v193, v193
    v_mfma_f32_16x16x32_bf16 v[200:203], a[12:15], a[172:175], v[200:203]
    ds_read_b64_tr_b16 a[98:99], v232 offset:20480
    v_cvt_pk_bf16_f32 v216, v192, v193
    v_mfma_f32_16x16x32_bf16 v[204:207], a[16:19], a[160:163], v[252:255]
    v_exp_f32 v194, v194
    v_mfma_f32_16x16x32_bf16 v[204:207], a[20:23], a[164:167], v[204:207]
    ds_read_b128 a[40:43], v229 offset:18432
    v_mfma_f32_16x16x32_bf16 v[204:207], a[24:27], a[168:171], v[204:207]
    v_exp_f32 v195, v195
    v_mfma_f32_16x16x32_bf16 v[204:207], a[28:31], a[172:175], v[204:207]
    s_waitcnt lgkmcnt(5)
    ds_read_b64_tr_b16 a[100:101], v233 offset:16384
    v_cvt_pk_bf16_f32 v217, v194, v195
    v_mfma_f32_16x16x32_bf16 v[32:35], v[220:223], a[64:67], v[32:35]
    v_exp_f32 v196, v196
    v_mfma_f32_16x16x32_bf16 v[36:39], v[220:223], a[68:71], v[36:39]
    ds_read_b128 a[44:47], v229 offset:18944
    v_mfma_f32_16x16x32_bf16 v[40:43], v[220:223], a[72:75], v[40:43]
    v_exp_f32 v197, v197
    v_mfma_f32_16x16x32_bf16 v[44:47], v[220:223], a[76:79], v[44:47]
    s_add_u32 s48, s30, 8192
    v_cvt_pk_bf16_f32 v218, v196, v197
    v_mfma_f32_16x16x32_bf16 v[48:51], v[220:223], a[80:83], v[48:51]
    s_add_u32 m0, s31, 73728
    v_exp_f32 v198, v198
    v_mfma_f32_16x16x32_bf16 v[52:55], v[220:223], a[84:87], v[52:55]
    buffer_load_dwordx4 v235, s[16:19], s48 offen nt lds
    v_mfma_f32_16x16x32_bf16 v[56:59], v[220:223], a[88:91], v[56:59]
    v_exp_f32 v199, v199
    v_mfma_f32_16x16x32_bf16 v[60:63], v[220:223], a[92:95], v[60:63]
    ds_read_b64_tr_b16 a[102:103], v233 offset:20480
    v_cvt_pk_bf16_f32 v219, v198, v199
    v_mfma_f32_16x16x32_bf16 v[208:211], a[0:3], a[176:179], v[252:255]
    v_exp_f32 v200, v200
    v_mfma_f32_16x16x32_bf16 v[208:211], a[4:7], a[180:183], v[208:211]
    ds_read_b64_tr_b16 a[104:105], v232 offset:16896
    v_mfma_f32_16x16x32_bf16 v[208:211], a[8:11], a[184:187], v[208:211]
    v_exp_f32 v201, v201
    v_mfma_f32_16x16x32_bf16 v[208:211], a[12:15], a[188:191], v[208:211]
    ds_read_b128 a[48:51], v229 offset:20480
    v_cvt_pk_bf16_f32 v224, v200, v201
    v_mfma_f32_16x16x32_bf16 v[212:215], a[16:19], a[176:179], v[252:255]
    v_exp_f32 v202, v202
    v_mfma_f32_16x16x32_bf16 v[212:215], a[20:23], a[180:183], v[212:215]
    ds_read_b64_tr_b16 a[106:107], v232 offset:20992
    v_mfma_f32_16x16x32_bf16 v[212:215], a[24:27], a[184:187], v[212:215]
    v_exp_f32 v203, v203
    v_mfma_f32_16x16x32_bf16 v[212:215], a[28:31], a[188:191], v[212:215]
    ds_read_b64_tr_b16 a[108:109], v233 offset:16896
    v_cvt_pk_bf16_f32 v225, v202, v203
    v_mfma_f32_16x16x32_bf16 v[0:3], v[216:219], a[64:67], v[0:3]
    v_exp_f32 v204, v204
    v_mfma_f32_16x16x32_bf16 v[4:7], v[216:219], a[68:71], v[4:7]
    ds_read_b64_tr_b16 a[110:111], v233 offset:20992
    v_mfma_f32_16x16x32_bf16 v[8:11], v[216:219], a[72:75], v[8:11]
    v_exp_f32 v205, v205
    v_mfma_f32_16x16x32_bf16 v[12:15], v[216:219], a[76:79], v[12:15]
    s_add_u32 s48, s30, 12288
    v_cvt_pk_bf16_f32 v226, v204, v205
    v_xor_b32 v230, 0x8000, v230
    v_mfma_f32_16x16x32_bf16 v[16:19], v[216:219], a[80:83], v[16:19]
    s_add_u32 m0, s31, 77824
    v_exp_f32 v206, v206
    v_mfma_f32_16x16x32_bf16 v[20:23], v[216:219], a[84:87], v[20:23]
    buffer_load_dwordx4 v235, s[16:19], s48 offen nt lds
    v_mfma_f32_16x16x32_bf16 v[24:27], v[216:219], a[88:91], v[24:27]
    s_add_u32 s30, s30, 16384
    v_exp_f32 v207, v207
    v_mfma_f32_16x16x32_bf16 v[28:31], v[216:219], a[92:95], v[28:31]
    s_add_u32 s31, s31, 16384
    v_cvt_pk_bf16_f32 v227, v206, v207
    v_smfmac_f32_16x16x64_bf16 v[244:247], a[252:255], v[216:223], v243
    s_and_b32 s31, s31, 0xffff
    ds_read_b128 a[52:55], v229 offset:20992
    ds_read_b64_tr_b16 a[112:113], v232 offset:17408
    v_mfma_f32_16x16x32_bf16 v[192:195], a[0:3], a[192:195], v[252:255]
    v_exp_f32 v208, v208
    v_mfma_f32_16x16x32_bf16 v[192:195], a[4:7], a[196:199], v[192:195]
    v_mfma_f32_16x16x32_bf16 v[192:195], a[8:11], a[200:203], v[192:195]
    v_exp_f32 v209, v209
    v_mfma_f32_16x16x32_bf16 v[192:195], a[12:15], a[204:207], v[192:195]
    ds_read_b128 a[56:59], v229 offset:22528
    v_cvt_pk_bf16_f32 v220, v208, v209
    v_mfma_f32_16x16x32_bf16 v[196:199], a[16:19], a[192:195], v[252:255]
    v_exp_f32 v210, v210
    v_mfma_f32_16x16x32_bf16 v[196:199], a[20:23], a[196:199], v[196:199]
    ds_read_b64_tr_b16 a[114:115], v232 offset:21504
    ds_read_b64_tr_b16 a[116:117], v233 offset:17408
    v_mfma_f32_16x16x32_bf16 v[196:199], a[24:27], a[200:203], v[196:199]
    v_exp_f32 v211, v211
    v_mfma_f32_16x16x32_bf16 v[196:199], a[28:31], a[204:207], v[196:199]
    v_cvt_pk_bf16_f32 v221, v210, v211
    v_mfma_f32_16x16x32_bf16 v[64:67], v[224:227], a[64:67], v[64:67]
    v_exp_f32 v212, v212
    v_mfma_f32_16x16x32_bf16 v[68:71], v[224:227], a[68:71], v[68:71]
    ds_read_b128 a[60:63], v229 offset:23040
    v_xor_b32 v231, 0x8000, v231
    v_mfma_f32_16x16x32_bf16 v[72:75], v[224:227], a[72:75], v[72:75]
    v_exp_f32 v213, v213
    v_mfma_f32_16x16x32_bf16 v[76:79], v[224:227], a[76:79], v[76:79]
    ds_read_b64_tr_b16 a[118:119], v233 offset:21504
    v_cvt_pk_bf16_f32 v222, v212, v213
    v_mfma_f32_16x16x32_bf16 v[80:83], v[224:227], a[80:83], v[80:83]
    v_exp_f32 v214, v214
    v_mfma_f32_16x16x32_bf16 v[84:87], v[224:227], a[84:87], v[84:87]
    ds_read_b64_tr_b16 a[120:121], v232 offset:17920
    v_mfma_f32_16x16x32_bf16 v[88:91], v[224:227], a[88:91], v[88:91]
    v_exp_f32 v215, v215
    v_mfma_f32_16x16x32_bf16 v[92:95], v[224:227], a[92:95], v[92:95]
    s_waitcnt lgkmcnt(2)
    v_cvt_pk_bf16_f32 v223, v214, v215
    v_mfma_f32_16x16x32_bf16 v[200:203], a[32:35], a[144:147], v[252:255]
    v_exp_f32 v192, v192
    v_mfma_f32_16x16x32_bf16 v[200:203], a[36:39], a[148:151], v[200:203]
    ds_read_b64_tr_b16 a[122:123], v232 offset:22016
    v_add_f32 v240, v240, v192
    v_mfma_f32_16x16x32_bf16 v[200:203], a[40:43], a[152:155], v[200:203]
    v_exp_f32 v193, v193
    v_mfma_f32_16x16x32_bf16 v[200:203], a[44:47], a[156:159], v[200:203]
    v_cvt_pk_bf16_f32 v216, v192, v193
    v_add_f32 v240, v240, v193
    v_mfma_f32_16x16x32_bf16 v[204:207], a[48:51], a[144:147], v[252:255]
    v_exp_f32 v194, v194
    v_mfma_f32_16x16x32_bf16 v[204:207], a[52:55], a[148:151], v[204:207]
    ds_read_b64_tr_b16 a[124:125], v233 offset:17920
    v_add_f32 v240, v240, v194
    v_mfma_f32_16x16x32_bf16 v[204:207], a[56:59], a[152:155], v[204:207]
    v_exp_f32 v195, v195
    v_mfma_f32_16x16x32_bf16 v[204:207], a[60:63], a[156:159], v[204:207]
    v_cvt_pk_bf16_f32 v217, v194, v195
    v_add_f32 v240, v240, v195
    v_mfma_f32_16x16x32_bf16 v[96:99], v[220:223], a[64:67], v[96:99]
    v_exp_f32 v196, v196
    v_mfma_f32_16x16x32_bf16 v[100:103], v[220:223], a[68:71], v[100:103]
    v_add_f32 v240, v240, v196
    v_mfma_f32_16x16x32_bf16 v[104:107], v[220:223], a[72:75], v[104:107]
    v_exp_f32 v197, v197
    v_mfma_f32_16x16x32_bf16 v[108:111], v[220:223], a[76:79], v[108:111]
    v_cvt_pk_bf16_f32 v218, v196, v197
    v_add_f32 v240, v240, v197
    v_mfma_f32_16x16x32_bf16 v[112:115], v[220:223], a[80:83], v[112:115]
    s_waitcnt vmcnt(8)
    v_exp_f32 v198, v198
    v_mfma_f32_16x16x32_bf16 v[116:119], v[220:223], a[84:87], v[116:119]
    s_barrier
    v_add_f32 v240, v240, v198
    v_mfma_f32_16x16x32_bf16 v[120:123], v[220:223], a[88:91], v[120:123]
    v_exp_f32 v199, v199
    v_mfma_f32_16x16x32_bf16 v[124:127], v[220:223], a[92:95], v[124:127]
    v_cvt_pk_bf16_f32 v219, v198, v199
    v_add_f32 v240, v240, v199
    v_smfmac_f32_16x16x64_bf16 v[248:251], a[252:255], v[220:227], v243
    ds_read_b64_tr_b16 a[126:127], v233 offset:22016
    v_mfma_f32_16x16x32_bf16 v[208:211], a[32:35], a[128:131], v[252:255]
    v_exp_f32 v200, v200
    v_mfma_f32_16x16x32_bf16 v[208:211], a[36:39], a[132:135], v[208:211]
    ds_read_b128 a[0:3], v228 offset:0
    v_mfma_f32_16x16x32_bf16 v[208:211], a[40:43], a[136:139], v[208:211]
    v_exp_f32 v201, v201
    v_mfma_f32_16x16x32_bf16 v[208:211], a[44:47], a[140:143], v[208:211]
    v_cvt_pk_bf16_f32 v220, v200, v201
    v_xor_b32 v229, 0x8000, v229
    v_mfma_f32_16x16x32_bf16 v[212:215], a[48:51], a[128:131], v[252:255]
    v_exp_f32 v202, v202
    v_mfma_f32_16x16x32_bf16 v[212:215], a[52:55], a[132:135], v[212:215]
    v_mfma_f32_16x16x32_bf16 v[212:215], a[56:59], a[136:139], v[212:215]
    v_exp_f32 v203, v203
    v_mfma_f32_16x16x32_bf16 v[212:215], a[60:63], a[140:143], v[212:215]
    v_cvt_pk_bf16_f32 v221, v202, v203
    v_mfma_f32_16x16x32_bf16 v[128:131], v[216:219], a[64:67], v[128:131]
    v_exp_f32 v204, v204
    v_mfma_f32_16x16x32_bf16 v[132:135], v[216:219], a[68:71], v[132:135]
    v_mfma_f32_16x16x32_bf16 v[136:139], v[216:219], a[72:75], v[136:139]
    v_exp_f32 v205, v205
    v_mfma_f32_16x16x32_bf16 v[140:143], v[216:219], a[76:79], v[140:143]
    s_add_u32 s48, s30, 0
    ds_read_b128 a[4:7], v228 offset:512
    v_cvt_pk_bf16_f32 v222, v204, v205
    v_mfma_f32_16x16x32_bf16 v[144:147], v[216:219], a[80:83], v[144:147]
    s_add_u32 m0, s31, 0
    v_exp_f32 v206, v206
    v_mfma_f32_16x16x32_bf16 v[148:151], v[216:219], a[84:87], v[148:151]
    buffer_load_dwordx4 v234, s[12:15], s48 offen nt lds
    v_mfma_f32_16x16x32_bf16 v[152:155], v[216:219], a[88:91], v[152:155]
    v_exp_f32 v207, v207
    v_mfma_f32_16x16x32_bf16 v[156:159], v[216:219], a[92:95], v[156:159]
    v_cvt_pk_bf16_f32 v223, v206, v207
    v_mfma_f32_16x16x32_bf16 v[192:195], a[32:35], a[160:163], v[252:255]
    v_exp_f32 v208, v208
    v_mfma_f32_16x16x32_bf16 v[192:195], a[36:39], a[164:167], v[192:195]
    ds_read_b64_tr_b16 a[64:65], v230 offset:0
    v_xor_b32 v232, 0x8000, v232
    v_mfma_f32_16x16x32_bf16 v[192:195], a[40:43], a[168:171], v[192:195]
    v_exp_f32 v209, v209
    v_mfma_f32_16x16x32_bf16 v[192:195], a[44:47], a[172:175], v[192:195]
    ds_read_b128 a[8:11], v228 offset:2048
    v_cvt_pk_bf16_f32 v216, v208, v209
    v_mfma_f32_16x16x32_bf16 v[196:199], a[48:51], a[160:163], v[252:255]
    v_exp_f32 v210, v210
    v_mfma_f32_16x16x32_bf16 v[196:199], a[52:55], a[164:167], v[196:199]
    ds_read_b64_tr_b16 a[66:67], v230 offset:4096
    ds_read_b64_tr_b16 a[68:69], v231 offset:0
    v_mfma_f32_16x16x32_bf16 v[196:199], a[56:59], a[168:171], v[196:199]
    v_exp_f32 v211, v211
    v_mfma_f32_16x16x32_bf16 v[196:199], a[60:63], a[172:175], v[196:199]
    s_waitcnt lgkmcnt(6)
    ds_read_b64_tr_b16 a[70:71], v231 offset:4096
    v_cvt_pk_bf16_f32 v217, v210, v211
    v_mfma_f32_16x16x32_bf16 v[32:35], v[220:223], a[96:99], v[32:35]
    v_exp_f32 v212, v212
    v_mfma_f32_16x16x32_bf16 v[36:39], v[220:223], a[100:103], v[36:39]
    ds_read_b128 a[12:15], v228 offset:2560
    ds_read_b64_tr_b16 a[72:73], v230 offset:512
    v_mfma_f32_16x16x32_bf16 v[40:43], v[220:223], a[104:107], v[40:43]
    v_exp_f32 v213, v213
    v_mfma_f32_16x16x32_bf16 v[44:47], v[220:223], a[108:111], v[44:47]
    v_cvt_pk_bf16_f32 v218, v212, v213
    v_mfma_f32_16x16x32_bf16 v[48:51], v[220:223], a[112:115], v[48:51]
    v_exp_f32 v214, v214
    v_mfma_f32_16x16x32_bf16 v[52:55], v[220:223], a[116:119], v[52:55]
    ds_read_b128 a[16:19], v228 offset:4096
    ds_read_b64_tr_b16 a[74:75], v230 offset:4608
    v_mfma_f32_16x16x32_bf16 v[56:59], v[220:223], a[120:123], v[56:59]
    v_exp_f32 v215, v215
    v_mfma_f32_16x16x32_bf16 v[60:63], v[220:223], a[124:127], v[60:63]
    s_add_u32 s48, s30, 4096
    ds_read_b64_tr_b16 a[76:77], v231 offset:512
    v_cvt_pk_bf16_f32 v219, v214, v215
    v_mfma_f32_16x16x32_bf16 v[200:203], a[32:35], a[176:179], v[252:255]
    s_add_u32 m0, s31, 4096
    v_exp_f32 v192, v192
    v_mfma_f32_16x16x32_bf16 v[200:203], a[36:39], a[180:183], v[200:203]
    buffer_load_dwordx4 v234, s[12:15], s48 offen nt lds
    v_mfma_f32_16x16x32_bf16 v[200:203], a[40:43], a[184:187], v[200:203]
    v_exp_f32 v193, v193
    v_mfma_f32_16x16x32_bf16 v[200:203], a[44:47], a[188:191], v[200:203]
    s_add_u32 s48, s30, 8192
    ds_read_b64_tr_b16 a[78:79], v231 offset:4608
    v_cvt_pk_bf16_f32 v224, v192, v193
    v_mfma_f32_16x16x32_bf16 v[204:207], a[48:51], a[176:179], v[252:255]
    s_add_u32 m0, s31, 8192
    v_exp_f32 v194, v194
    v_mfma_f32_16x16x32_bf16 v[204:207], a[52:55], a[180:183], v[204:207]
    buffer_load_dwordx4 v234, s[12:15], s48 offen nt lds
    v_mfma_f32_16x16x32_bf16 v[204:207], a[56:59], a[184:187], v[204:207]
    v_exp_f32 v195, v195
    v_mfma_f32_16x16x32_bf16 v[204:207], a[60:63], a[188:191], v[204:207]
    v_cvt_pk_bf16_f32 v225, v194, v195
    v_mfma_f32_16x16x32_bf16 v[0:3], v[216:219], a[96:99], v[0:3]
    v_exp_f32 v196, v196
    v_mfma_f32_16x16x32_bf16 v[4:7], v[216:219], a[100:103], v[4:7]
    ds_read_b128 a[20:23], v228 offset:4608
    v_mfma_f32_16x16x32_bf16 v[8:11], v[216:219], a[104:107], v[8:11]
    v_exp_f32 v197, v197
    v_mfma_f32_16x16x32_bf16 v[12:15], v[216:219], a[108:111], v[12:15]
    ds_read_b64_tr_b16 a[80:81], v230 offset:1024
    v_cvt_pk_bf16_f32 v226, v196, v197
    v_mfma_f32_16x16x32_bf16 v[16:19], v[216:219], a[112:115], v[16:19]
    v_exp_f32 v198, v198
    v_mfma_f32_16x16x32_bf16 v[20:23], v[216:219], a[116:119], v[20:23]
    v_mfma_f32_16x16x32_bf16 v[24:27], v[216:219], a[120:123], v[24:27]
    v_exp_f32 v199, v199
    v_mfma_f32_16x16x32_bf16 v[28:31], v[216:219], a[124:127], v[28:31]
    s_sub_u32 s29, s29, 1
    s_cmp_lg_u32 s29, 0
    v_cvt_pk_bf16_f32 v227, v198, v199
    v_smfmac_f32_16x16x64_bf16 v[244:247], a[252:255], v[216:223], v243
    s_cbranch_scc1 L_loop1
    v_mfma_f32_16x16x32_bf16 v[208:211], a[32:35], a[192:195], v[252:255]
    v_exp_f32 v200, v200
    v_mfma_f32_16x16x32_bf16 v[208:211], a[36:39], a[196:199], v[208:211]
    ds_read_b128 a[24:27], v228 offset:6144
    v_mfma_f32_16x16x32_bf16 v[208:211], a[40:43], a[200:203], v[208:211]
    v_exp_f32 v201, v201
    v_mfma_f32_16x16x32_bf16 v[208:211], a[44:47], a[204:207], v[208:211]
    s_add_u32 s48, s30, 12288
    ds_read_b64_tr_b16 a[82:83], v230 offset:5120
    v_cvt_pk_bf16_f32 v220, v200, v201
    v_mfma_f32_16x16x32_bf16 v[212:215], a[48:51], a[192:195], v[252:255]
    s_add_u32 m0, s31, 12288
    v_exp_f32 v202, v202
    v_mfma_f32_16x16x32_bf16 v[212:215], a[52:55], a[196:199], v[212:215]
    buffer_load_dwordx4 v234, s[12:15], s48 offen nt lds
    v_mfma_f32_16x16x32_bf16 v[212:215], a[56:59], a[200:203], v[212:215]
    v_exp_f32 v203, v203
    v_mfma_f32_16x16x32_bf16 v[212:215], a[60:63], a[204:207], v[212:215]
    v_cvt_pk_bf16_f32 v221, v202, v203
    v_mfma_f32_16x16x32_bf16 v[64:67], v[224:227], a[96:99], v[64:67]
    v_exp_f32 v204, v204
    v_mfma_f32_16x16x32_bf16 v[68:71], v[224:227], a[100:103], v[68:71]
    ds_read_b128 a[28:31], v228 offset:6656
    v_mfma_f32_16x16x32_bf16 v[72:75], v[224:227], a[104:107], v[72:75]
    v_exp_f32 v205, v205
    v_mfma_f32_16x16x32_bf16 v[76:79], v[224:227], a[108:111], v[76:79]
    ds_read_b64_tr_b16 a[84:85], v231 offset:1024
    v_cvt_pk_bf16_f32 v222, v204, v205
    v_mfma_f32_16x16x32_bf16 v[80:83], v[224:227], a[112:115], v[80:83]
    v_exp_f32 v206, v206
    v_mfma_f32_16x16x32_bf16 v[84:87], v[224:227], a[116:119], v[84:87]
    ds_read_b64_tr_b16 a[86:87], v231 offset:5120
    v_xor_b32 v233, 0x8000, v233
    v_mfma_f32_16x16x32_bf16 v[88:91], v[224:227], a[120:123], v[88:91]
    v_exp_f32 v207, v207
    v_mfma_f32_16x16x32_bf16 v[92:95], v[224:227], a[124:127], v[92:95]
    s_waitcnt lgkmcnt(2)
    ds_read_b64_tr_b16 a[88:89], v230 offset:1536
    v_cvt_pk_bf16_f32 v223, v206, v207
    v_mfma_f32_16x16x32_bf16 v[192:195], a[0:3], a[144:147], v[252:255]
    v_exp_f32 v208, v208
    v_mfma_f32_16x16x32_bf16 v[192:195], a[4:7], a[148:151], v[192:195]
    v_add_f32 v240, v240, v208
    v_mfma_f32_16x16x32_bf16 v[192:195], a[8:11], a[152:155], v[192:195]
    v_exp_f32 v209, v209
    v_mfma_f32_16x16x32_bf16 v[192:195], a[12:15], a[156:159], v[192:195]
    v_cvt_pk_bf16_f32 v216, v208, v209
    v_add_f32 v240, v240, v209
    v_mfma_f32_16x16x32_bf16 v[196:199], a[16:19], a[144:147], v[252:255]
    v_exp_f32 v210, v210
    v_mfma_f32_16x16x32_bf16 v[196:199], a[20:23], a[148:151], v[196:199]
    ds_read_b64_tr_b16 a[90:91], v230 offset:5632
    v_add_f32 v240, v240, v210
    v_mfma_f32_16x16x32_bf16 v[196:199], a[24:27], a[152:155], v[196:199]
    v_exp_f32 v211, v211
    v_mfma_f32_16x16x32_bf16 v[196:199], a[28:31], a[156:159], v[196:199]
    v_cvt_pk_bf16_f32 v217, v210, v211
    v_add_f32 v240, v240, v211
    v_mfma_f32_16x16x32_bf16 v[96:99], v[220:223], a[96:99], v[96:99]
    v_exp_f32 v212, v212
    v_mfma_f32_16x16x32_bf16 v[100:103], v[220:223], a[100:103], v[100:103]
    ds_read_b64_tr_b16 a[92:93], v231 offset:1536
    v_add_f32 v240, v240, v212
    v_mfma_f32_16x16x32_bf16 v[104:107], v[220:223], a[104:107], v[104:107]
    v_exp_f32 v213, v213
    v_mfma_f32_16x16x32_bf16 v[108:111], v[220:223], a[108:111], v[108:111]
    v_cvt_pk_bf16_f32 v218, v212, v213
    v_add_f32 v240, v240, v213
    v_mfma_f32_16x16x32_bf16 v[112:115], v[220:223], a[112:115], v[112:115]
    v_exp_f32 v214, v214
    v_mfma_f32_16x16x32_bf16 v[116:119], v[220:223], a[116:119], v[116:119]
    ds_read_b64_tr_b16 a[94:95], v231 offset:5632
    v_add_f32 v240, v240, v214
    v_mfma_f32_16x16x32_bf16 v[120:123], v[220:223], a[120:123], v[120:123]
    v_exp_f32 v215, v215
    v_mfma_f32_16x16x32_bf16 v[124:127], v[220:223], a[124:127], v[124:127]
    v_cvt_pk_bf16_f32 v219, v214, v215
    v_add_f32 v240, v240, v215
    v_smfmac_f32_16x16x64_bf16 v[248:251], a[252:255], v[220:227], v243
    ds_read_b128 a[32:35], v229 offset:0
    ds_read_b128 a[36:39], v229 offset:512
    ds_read_b128 a[40:43], v229 offset:2048
    ds_read_b128 a[44:47], v229 offset:2560
    ds_read_b128 a[48:51], v229 offset:4096
    ds_read_b128 a[52:55], v229 offset:4608
    ds_read_b128 a[56:59], v229 offset:6144
    ds_read_b128 a[60:63], v229 offset:6656
L_tail1:
    s_getpc_b64 s[4:5]
    v_mbcnt_lo_u32_b32 v228, -1, 0
    v_mbcnt_hi_u32_b32 v228, -1, v228
    s_mov_b32 m0, 0
    v_lshlrev_b32 v228, 7, v228
    v_mov_b32 v229, s5
    v_add_co_u32 v228, vcc, s4, v228
    v_addc_co_u32 v229, vcc, 0, v229, vcc
    global_load_lds_dword v[228:229], off
    v_mfma_f32_16x16x32_bf16 v[200:203], a[0:3], a[208:211], v[252:255]
    v_exp_f32 v192, v192
    v_mfma_f32_16x16x32_bf16 v[200:203], a[4:7], a[212:215], v[200:203]
    v_mfma_f32_16x16x32_bf16 v[200:203], a[8:11], a[216:219], v[200:203]
    v_exp_f32 v193, v193
    v_mfma_f32_16x16x32_bf16 v[200:203], a[12:15], a[220:223], v[200:203]
    v_cvt_pk_bf16_f32 v220, v192, v193
    v_mfma_f32_16x16x32_bf16 v[204:207], a[16:19], a[208:211], v[252:255]
    v_exp_f32 v194, v194
    v_mfma_f32_16x16x32_bf16 v[204:207], a[20:23], a[212:215], v[204:207]
    v_mfma_f32_16x16x32_bf16 v[204:207], a[24:27], a[216:219], v[204:207]
    v_exp_f32 v195, v195
    v_add_f32 v236, v244, v245
    v_add_f32 v237, v246, v247
    v_add_f32 v248, v248, v249
    v_add_f32 v250, v250, v251
    v_fmac_f32 v239, 0x3e800000, v248
    v_fmac_f32 v238, 0x3e800000, v250
    v_mfma_f32_16x16x32_bf16 v[204:207], a[28:31], a[220:223], v[204:207]
    v_cvt_pk_bf16_f32 v221, v194, v195
    v_mfma_f32_16x16x32_bf16 v[128:131], v[216:219], a[96:99], v[128:131]
    v_exp_f32 v196, v196
    v_mfma_f32_16x16x32_bf16 v[132:135], v[216:219], a[100:103], v[132:135]
    v_mfma_f32_16x16x32_bf16 v[136:139], v[216:219], a[104:107], v[136:139]
    v_exp_f32 v197, v197
    v_mfma_f32_16x16x32_bf16 v[140:143], v[216:219], a[108:111], v[140:143]
    v_cvt_pk_bf16_f32 v222, v196, v197
    v_mfma_f32_16x16x32_bf16 v[144:147], v[216:219], a[112:115], v[144:147]
    v_exp_f32 v198, v198
    v_mfma_f32_16x16x32_bf16 v[148:151], v[216:219], a[116:119], v[148:151]
    v_mfma_f32_16x16x32_bf16 v[152:155], v[216:219], a[120:123], v[152:155]
    v_exp_f32 v199, v199
    v_mfma_f32_16x16x32_bf16 v[156:159], v[216:219], a[124:127], v[156:159]
    v_cvt_pk_bf16_f32 v223, v198, v199
    ds_read_b64_tr_b16 a[96:97], v232 offset:0
    ds_read_b64_tr_b16 a[98:99], v232 offset:4096
    ds_read_b64_tr_b16 a[100:101], v233 offset:0
    ds_read_b64_tr_b16 a[102:103], v233 offset:4096
    ds_read_b64_tr_b16 a[104:105], v232 offset:512
    ds_read_b64_tr_b16 a[106:107], v232 offset:4608
    ds_read_b64_tr_b16 a[108:109], v233 offset:512
    ds_read_b64_tr_b16 a[110:111], v233 offset:4608
    ds_read_b64_tr_b16 a[112:113], v232 offset:1024
    ds_read_b64_tr_b16 a[114:115], v232 offset:5120
    ds_read_b64_tr_b16 a[116:117], v233 offset:1024
    ds_read_b64_tr_b16 a[118:119], v233 offset:5120
    ds_read_b64_tr_b16 a[120:121], v232 offset:1536
    ds_read_b64_tr_b16 a[122:123], v232 offset:5632
    ds_read_b64_tr_b16 a[124:125], v233 offset:1536
    ds_read_b64_tr_b16 a[126:127], v233 offset:5632
    s_waitcnt lgkmcnt(15)
    v_mfma_f32_16x16x32_bf16 v[208:211], a[32:35], a[144:147], v[252:255]
    v_exp_f32 v200, v200
    v_accvgpr_read_b32 v228, a248
    v_mfma_f32_16x16x32_bf16 v[208:211], a[36:39], a[148:151], v[208:211]
    v_accvgpr_read_b32 v230, a249
    v_mfma_f32_16x16x32_bf16 v[208:211], a[40:43], a[152:155], v[208:211]
    v_exp_f32 v201, v201
    v_mfma_f32_16x16x32_bf16 v[208:211], a[44:47], a[156:159], v[208:211]
    v_cvt_pk_bf16_f32 v224, v200, v201
    v_accvgpr_read_b32 v231, a250
    v_mfma_f32_16x16x32_bf16 v[212:215], a[48:51], a[144:147], v[252:255]
    v_exp_f32 v202, v202
    v_accvgpr_read_b32 v242, a251
    v_mfma_f32_16x16x32_bf16 v[212:215], a[52:55], a[148:151], v[212:215]
    v_mfma_f32_16x16x32_bf16 v[212:215], a[56:59], a[152:155], v[212:215]
    v_exp_f32 v203, v203
    s_lshl_b32 s33, s28, 10
    v_mfma_f32_16x16x32_bf16 v[212:215], a[60:63], a[156:159], v[212:215]
    v_cvt_pk_bf16_f32 v225, v202, v203
    v_add_u32 v229, s33, v242
    v_mfma_f32_16x16x32_bf16 v[32:35], v[220:223], a[64:67], v[32:35]
    v_exp_f32 v204, v204
    v_mfma_f32_16x16x32_bf16 v[36:39], v[220:223], a[68:71], v[36:39]
    v_add_u32 v245, 131072, v229
    v_mfma_f32_16x16x32_bf16 v[40:43], v[220:223], a[72:75], v[40:43]
    v_exp_f32 v205, v205
    v_cmp_gt_u32 vcc, 0x100, v242
    v_mfma_f32_16x16x32_bf16 v[44:47], v[220:223], a[76:79], v[44:47]
    v_cvt_pk_bf16_f32 v226, v204, v205
    v_mfma_f32_16x16x32_bf16 v[48:51], v[220:223], a[80:83], v[48:51]
    v_exp_f32 v206, v206
    s_nop 1
    v_mfma_f32_16x16x32_bf16 v[52:55], v[220:223], a[84:87], v[52:55]
    v_cndmask_b32_e64 v246, 0, 1.0, vcc
    v_mfma_f32_16x16x32_bf16 v[56:59], v[220:223], a[88:91], v[56:59]
    v_exp_f32 v207, v207
    v_mfma_f32_16x16x32_bf16 v[60:63], v[220:223], a[92:95], v[60:63]
    v_cvt_pk_bf16_f32 v227, v206, v207
    v_accvgpr_write_b32 a252, v246
    v_mfma_f32_16x16x32_bf16 a[228:231], a[236:239], v[220:223], a[228:231]
    v_mfma_f32_16x16x32_bf16 v[192:195], a[0:3], a[128:131], v[252:255]
    v_exp_f32 v208, v208
    v_mfma_f32_16x16x32_bf16 v[192:195], a[4:7], a[132:135], v[192:195]
    v_mfma_f32_16x16x32_bf16 v[192:195], a[8:11], a[136:139], v[192:195]
    v_exp_f32 v209, v209
    v_mfma_f32_16x16x32_bf16 v[192:195], a[12:15], a[140:143], v[192:195]
    v_cvt_pk_bf16_f32 v216, v208, v209
    v_mfma_f32_16x16x32_bf16 v[196:199], a[16:19], a[128:131], v[252:255]
    v_exp_f32 v210, v210
    v_and_b32 v246, 0xf0, v242
    v_lshrrev_b32 v247, 8, v242
    v_lshlrev_b32 v247, 6, v247
    v_sub_u32 v246, v246, v247
    v_and_b32 v247, 16, v246
    v_mov_b32 v249, 0x3f80
    v_lshlrev_b32 v247, v247, v249
    v_cmp_gt_u32 vcc, 32, v246
    s_nop 1
    v_cndmask_b32 v249, 0, v247, vcc
    v_accvgpr_write_b32 a146, v249
    v_subrev_u32 v246, 32, v246
    v_cmp_gt_u32 vcc, 32, v246
    s_nop 1
    v_cndmask_b32 v249, 0, v247, vcc
    v_accvgpr_write_b32 a147, v249
    v_accvgpr_write_b32 a144, 0
    v_accvgpr_write_b32 a145, 0
    v_accvgpr_write_b32 a148, 0
    v_accvgpr_write_b32 a149, 0
    v_mfma_f32_16x16x32_bf16 v[196:199], a[20:23], a[132:135], v[196:199]
    v_mfma_f32_16x16x32_bf16 v[196:199], a[24:27], a[136:139], v[196:199]
    v_exp_f32 v211, v211
    v_mfma_f32_16x16x32_bf16 v[196:199], a[28:31], a[140:143], v[196:199]
    v_cvt_pk_bf16_f32 v217, v210, v211
    v_mfma_f32_16x16x32_bf16 v[160:163], v[224:227], a[64:67], v[160:163]
    v_exp_f32 v212, v212
    v_mfma_f32_16x16x32_bf16 v[164:167], v[224:227], a[68:71], v[164:167]
    v_mfma_f32_16x16x32_bf16 v[168:171], v[224:227], a[72:75], v[168:171]
    v_exp_f32 v213, v213
    v_mfma_f32_16x16x32_bf16 v[172:175], v[224:227], a[76:79], v[172:175]
    v_cvt_pk_bf16_f32 v218, v212, v213
    v_mfma_f32_16x16x32_bf16 v[176:179], v[224:227], a[80:83], v[176:179]
    v_exp_f32 v214, v214
    v_mfma_f32_16x16x32_bf16 v[180:183], v[224:227], a[84:87], v[180:183]
    v_mfma_f32_16x16x32_bf16 v[184:187], v[224:227], a[88:91], v[184:187]
    v_exp_f32 v215, v215
    v_mfma_f32_16x16x32_bf16 v[188:191], v[224:227], a[92:95], v[188:191]
    v_cvt_pk_bf16_f32 v219, v214, v215
    v_mfma_f32_16x16x32_bf16 a[232:235], a[236:239], v[224:227], a[232:235]
    v_mfma_f32_16x16x32_bf16 v[200:203], a[32:35], a[128:131], v[252:255]
    v_exp_f32 v192, v192
    ds_write_b128 v245, v[160:163] offset:0
    v_mfma_f32_16x16x32_bf16 v[200:203], a[36:39], a[132:135], v[200:203]
    ds_write_b128 v245, v[164:167] offset:4096
    v_mfma_f32_16x16x32_bf16 v[200:203], a[40:43], a[136:139], v[200:203]
    v_exp_f32 v193, v193
    ds_write_b128 v245, v[168:171] offset:8192
    v_mfma_f32_16x16x32_bf16 v[200:203], a[44:47], a[140:143], v[200:203]
    v_cvt_pk_bf16_f32 v220, v192, v193
    ds_write_b128 v245, v[172:175] offset:12288
    v_mfma_f32_16x16x32_bf16 v[204:207], a[48:51], a[128:131], v[252:255]
    v_exp_f32 v194, v194
    v_accvgpr_read_b32 v248, a232
    v_mfma_f32_16x16x32_bf16 v[204:207], a[52:55], a[132:135], v[204:207]
    ds_write_b128 v245, v[176:179] offset:16384
    v_mfma_f32_16x16x32_bf16 v[204:207], a[56:59], a[136:139], v[204:207]
    v_exp_f32 v195, v195
    ds_write_b128 v245, v[180:183] offset:20480
    v_mfma_f32_16x16x32_bf16 v[204:207], a[60:63], a[140:143], v[204:207]
    v_cvt_pk_bf16_f32 v221, v194, v195
    ds_write_b128 v245, v[184:187] offset:24576
    s_waitcnt lgkmcnt(7)
    v_mfma_f32_16x16x32_bf16 v[32:35], v[216:219], a[96:99], v[32:35]
    v_exp_f32 v196, v196
    ds_write_b128 v245, v[188:191] offset:28672
    v_mfma_f32_16x16x32_bf16 v[36:39], v[216:219], a[100:103], v[36:39]
    ds_write_b32 v229, v248 offset:16384
    v_mfma_f32_16x16x32_bf16 v[40:43], v[216:219], a[104:107], v[40:43]
    v_exp_f32 v197, v197
    v_mfma_f32_16x16x32_bf16 v[44:47], v[216:219], a[108:111], v[44:47]
    v_cvt_pk_bf16_f32 v222, v196, v197
    v_mfma_f32_16x16x32_bf16 v[48:51], v[216:219], a[112:115], v[48:51]
    v_exp_f32 v198, v198
    v_mfma_f32_16x16x32_bf16 v[52:55], v[216:219], a[116:119], v[52:55]
    v_mfma_f32_16x16x32_bf16 v[56:59], v[216:219], a[120:123], v[56:59]
    v_exp_f32 v199, v199
    v_mfma_f32_16x16x32_bf16 v[60:63], v[216:219], a[124:127], v[60:63]
    v_cvt_pk_bf16_f32 v223, v198, v199
    v_mfma_f32_16x16x32_bf16 a[228:231], a[236:239], v[216:219], a[228:231]
    s_waitcnt lgkmcnt(0)
    s_barrier
    v_mfma_f32_16x16x32_bf16 v[208:211], a[0:3], a[160:163], v[252:255]
    v_exp_f32 v200, v200
    v_mfma_f32_16x16x32_bf16 v[208:211], a[4:7], a[164:167], v[208:211]
    v_mfma_f32_16x16x32_bf16 v[208:211], a[8:11], a[168:171], v[208:211]
    v_exp_f32 v201, v201
    v_mfma_f32_16x16x32_bf16 v[208:211], a[12:15], a[172:175], v[208:211]
    v_cvt_pk_bf16_f32 v224, v200, v201
    v_mfma_f32_16x16x32_bf16 v[212:215], a[16:19], a[160:163], v[252:255]
    v_exp_f32 v202, v202
    v_accvgpr_read_b32 v246, a228
    v_add_f32 v237, v237, v246
    v_mov_b32 v243, v237
    v_mov_b32 v244, v237
    v_rcp_f32 v237, v237
    s_nop 0
    s_nop 0
    v_mfma_f32_16x16x4_f32 v[232:235], v237, a252, 0
    v_mfma_f32_16x16x32_bf16 v[212:215], a[20:23], a[164:167], v[212:215]
    v_mfma_f32_16x16x32_bf16 v[212:215], a[24:27], a[168:171], v[212:215]
    v_exp_f32 v203, v203
    v_mfma_f32_16x16x32_bf16 v[212:215], a[28:31], a[172:175], v[212:215]
    v_cvt_pk_bf16_f32 v225, v202, v203
    v_mfma_f32_16x16x32_bf16 v[0:3], v[220:223], a[64:67], v[0:3]
    v_exp_f32 v204, v204
    v_mfma_f32_16x16x32_bf16 v[4:7], v[220:223], a[68:71], v[4:7]
    v_mfma_f32_16x16x32_bf16 v[8:11], v[220:223], a[72:75], v[8:11]
    v_exp_f32 v205, v205
    v_mfma_f32_16x16x32_bf16 v[12:15], v[220:223], a[76:79], v[12:15]
    v_cvt_pk_bf16_f32 v226, v204, v205
    v_mfma_f32_16x16x32_bf16 v[16:19], v[220:223], a[80:83], v[16:19]
    v_exp_f32 v206, v206
    v_mfma_f32_16x16x32_bf16 v[20:23], v[220:223], a[84:87], v[20:23]
    v_mfma_f32_16x16x32_bf16 v[24:27], v[220:223], a[88:91], v[24:27]
    v_exp_f32 v207, v207
    v_mfma_f32_16x16x32_bf16 v[28:31], v[220:223], a[92:95], v[28:31]
    v_cvt_pk_bf16_f32 v227, v206, v207
    v_mfma_f32_16x16x32_bf16 a[224:227], a[236:239], v[220:223], a[224:227]
    v_pk_mul_f32 v[32:33], v[32:33], v[232:233]
    v_pk_mul_f32 v[34:35], v[34:35], v[234:235]
    v_pk_mul_f32 v[36:37], v[36:37], v[232:233]
    v_pk_mul_f32 v[38:39], v[38:39], v[234:235]
    v_pk_mul_f32 v[40:41], v[40:41], v[232:233]
    v_pk_mul_f32 v[42:43], v[42:43], v[234:235]
    v_pk_mul_f32 v[44:45], v[44:45], v[232:233]
    v_pk_mul_f32 v[46:47], v[46:47], v[234:235]
    v_cvt_pk_bf16_f32 v32, v32, v33
    v_cvt_pk_bf16_f32 v33, v34, v35
    v_cvt_pk_bf16_f32 v34, v36, v37
    v_cvt_pk_bf16_f32 v35, v38, v39
    v_cvt_pk_bf16_f32 v40, v40, v41
    v_cvt_pk_bf16_f32 v41, v42, v43
    v_cvt_pk_bf16_f32 v42, v44, v45
    v_cvt_pk_bf16_f32 v43, v46, v47
    v_mfma_f32_16x16x32_bf16 v[36:39], v[32:35], a[146:149], 0
    v_mfma_f32_16x16x32_bf16 v[44:47], v[32:35], a[144:147], 0
    v_mfma_f32_16x16x32_bf16 v[32:35], v[40:43], a[146:149], 0
    v_mfma_f32_16x16x32_bf16 v[188:191], v[40:43], a[144:147], 0
    s_nop 4
    v_cvt_pk_bf16_f32 v36, v36, v37
    v_cvt_pk_bf16_f32 v37, v38, v39
    v_cvt_pk_bf16_f32 v38, v44, v45
    v_cvt_pk_bf16_f32 v39, v46, v47
    ds_write2_b64 v228, v[36:37], v[38:39] offset0:0 offset1:4
    v_cvt_pk_bf16_f32 v32, v32, v33
    v_cvt_pk_bf16_f32 v33, v34, v35
    v_cvt_pk_bf16_f32 v34, v188, v189
    v_cvt_pk_bf16_f32 v35, v190, v191
    ds_write2_b64 v228, v[32:33], v[34:35] offset0:8 offset1:12
    ds_read_b128 v[32:35], v230 offset:0
    ds_read_b128 v[36:39], v230 offset:2176
    v_mfma_f32_16x16x32_bf16 v[192:195], a[32:35], a[160:163], v[252:255]
    v_exp_f32 v208, v208
    v_mfma_f32_16x16x32_bf16 v[192:195], a[36:39], a[164:167], v[192:195]
    v_add_f32 v238, v238, v208
    v_mfma_f32_16x16x32_bf16 v[192:195], a[40:43], a[168:171], v[192:195]
    v_exp_f32 v209, v209
    v_mfma_f32_16x16x32_bf16 v[192:195], a[44:47], a[172:175], v[192:195]
    v_cvt_pk_bf16_f32 v216, v208, v209
    v_add_f32 v238, v238, v209
    v_mfma_f32_16x16x32_bf16 v[196:199], a[48:51], a[160:163], v[252:255]
    v_exp_f32 v210, v210
    v_mfma_f32_16x16x32_bf16 v[196:199], a[52:55], a[164:167], v[196:199]
    v_add_f32 v238, v238, v210
    v_mfma_f32_16x16x32_bf16 v[196:199], a[56:59], a[168:171], v[196:199]
    v_exp_f32 v211, v211
    v_mfma_f32_16x16x32_bf16 v[196:199], a[60:63], a[172:175], v[196:199]
    v_cvt_pk_bf16_f32 v217, v210, v211
    v_add_f32 v238, v238, v211
    v_mfma_f32_16x16x32_bf16 v[0:3], v[224:227], a[96:99], v[0:3]
    v_exp_f32 v212, v212
    v_mfma_f32_16x16x32_bf16 v[4:7], v[224:227], a[100:103], v[4:7]
    v_add_f32 v238, v238, v212
    v_mfma_f32_16x16x32_bf16 v[8:11], v[224:227], a[104:107], v[8:11]
    v_exp_f32 v213, v213
    v_mfma_f32_16x16x32_bf16 v[12:15], v[224:227], a[108:111], v[12:15]
    v_cvt_pk_bf16_f32 v218, v212, v213
    v_add_f32 v238, v238, v213
    v_mfma_f32_16x16x32_bf16 v[16:19], v[224:227], a[112:115], v[16:19]
    v_exp_f32 v214, v214
    v_mfma_f32_16x16x32_bf16 v[20:23], v[224:227], a[116:119], v[20:23]
    v_add_f32 v238, v238, v214
    v_mfma_f32_16x16x32_bf16 v[24:27], v[224:227], a[120:123], v[24:27]
    v_exp_f32 v215, v215
    v_mfma_f32_16x16x32_bf16 v[28:31], v[224:227], a[124:127], v[28:31]
    v_cvt_pk_bf16_f32 v219, v214, v215
    v_add_f32 v238, v238, v215
    v_mfma_f32_16x16x32_bf16 a[224:227], a[236:239], v[224:227], a[224:227]
    s_waitcnt lgkmcnt(1)
    buffer_store_dwordx4 v[32:35], v231, s[20:23], s37 offen offset:0 nt
    s_waitcnt lgkmcnt(0)
    buffer_store_dwordx4 v[36:39], v231, s[20:23], s37 offen offset:2048 nt
    v_pk_mul_f32 v[48:49], v[48:49], v[232:233]
    v_pk_mul_f32 v[50:51], v[50:51], v[234:235]
    v_pk_mul_f32 v[52:53], v[52:53], v[232:233]
    v_pk_mul_f32 v[54:55], v[54:55], v[234:235]
    v_pk_mul_f32 v[56:57], v[56:57], v[232:233]
    v_pk_mul_f32 v[58:59], v[58:59], v[234:235]
    v_pk_mul_f32 v[60:61], v[60:61], v[232:233]
    v_pk_mul_f32 v[62:63], v[62:63], v[234:235]
    v_cvt_pk_bf16_f32 v48, v48, v49
    v_cvt_pk_bf16_f32 v49, v50, v51
    v_cvt_pk_bf16_f32 v50, v52, v53
    v_cvt_pk_bf16_f32 v51, v54, v55
    v_cvt_pk_bf16_f32 v56, v56, v57
    v_cvt_pk_bf16_f32 v57, v58, v59
    v_cvt_pk_bf16_f32 v58, v60, v61
    v_cvt_pk_bf16_f32 v59, v62, v63
    v_mfma_f32_16x16x32_bf16 v[52:55], v[48:51], a[146:149], 0
    v_mfma_f32_16x16x32_bf16 v[60:63], v[48:51], a[144:147], 0
    v_mfma_f32_16x16x32_bf16 v[48:51], v[56:59], a[146:149], 0
    v_mfma_f32_16x16x32_bf16 v[44:47], v[56:59], a[144:147], 0
    s_nop 4
    v_cvt_pk_bf16_f32 v52, v52, v53
    v_cvt_pk_bf16_f32 v53, v54, v55
    v_cvt_pk_bf16_f32 v54, v60, v61
    v_cvt_pk_bf16_f32 v55, v62, v63
    ds_write2_b64 v228, v[52:53], v[54:55] offset0:16 offset1:20
    v_cvt_pk_bf16_f32 v48, v48, v49
    v_cvt_pk_bf16_f32 v49, v50, v51
    v_cvt_pk_bf16_f32 v50, v44, v45
    v_cvt_pk_bf16_f32 v51, v46, v47
    ds_write2_b64 v228, v[48:49], v[50:51] offset0:24 offset1:28
    ds_read_b128 v[48:51], v230 offset:128
    ds_read_b128 v[52:55], v230 offset:2304
    v_mfma_f32_16x16x32_bf16 v[200:203], a[0:3], a[176:179], v[252:255]
    v_exp_f32 v192, v192
    v_mfma_f32_16x16x32_bf16 v[200:203], a[4:7], a[180:183], v[200:203]
    v_add_f32 v238, v238, v192
    v_mfma_f32_16x16x32_bf16 v[200:203], a[8:11], a[184:187], v[200:203]
    v_exp_f32 v193, v193
    v_mfma_f32_16x16x32_bf16 v[200:203], a[12:15], a[188:191], v[200:203]
    v_cvt_pk_bf16_f32 v220, v192, v193
    v_add_f32 v238, v238, v193
    v_mfma_f32_16x16x32_bf16 v[204:207], a[16:19], a[176:179], v[252:255]
    v_exp_f32 v194, v194
    v_accvgpr_read_b32 v246, a224
    v_add_f32 v236, v236, v246
    v_min_f32 v243, v243, v236
    v_max_f32 v244, v244, v236
    v_rcp_f32 v236, v236
    s_nop 0
    s_nop 0
    v_mfma_f32_16x16x4_f32 v[40:43], v236, a252, 0
    v_mfma_f32_16x16x32_bf16 v[204:207], a[20:23], a[180:183], v[204:207]
    v_add_f32 v238, v238, v194
    v_mfma_f32_16x16x32_bf16 v[204:207], a[24:27], a[184:187], v[204:207]
    v_exp_f32 v195, v195
    v_mfma_f32_16x16x32_bf16 v[204:207], a[28:31], a[188:191], v[204:207]
    v_cvt_pk_bf16_f32 v221, v194, v195
    v_add_f32 v238, v238, v195
    v_mfma_f32_16x16x32_bf16 v[64:67], v[216:219], a[64:67], v[64:67]
    v_exp_f32 v196, v196
    v_mfma_f32_16x16x32_bf16 v[68:71], v[216:219], a[68:71], v[68:71]
    v_add_f32 v238, v238, v196
    v_mfma_f32_16x16x32_bf16 v[72:75], v[216:219], a[72:75], v[72:75]
    v_exp_f32 v197, v197
    v_mfma_f32_16x16x32_bf16 v[76:79], v[216:219], a[76:79], v[76:79]
    v_cvt_pk_bf16_f32 v222, v196, v197
    v_add_f32 v238, v238, v197
    v_mfma_f32_16x16x32_bf16 v[80:83], v[216:219], a[80:83], v[80:83]
    v_exp_f32 v198, v198
    v_mfma_f32_16x16x32_bf16 v[84:87], v[216:219], a[84:87], v[84:87]
    v_add_f32 v238, v238, v198
    v_mfma_f32_16x16x32_bf16 v[88:91], v[216:219], a[88:91], v[88:91]
    v_exp_f32 v199, v199
    v_mfma_f32_16x16x32_bf16 v[92:95], v[216:219], a[92:95], v[92:95]
    v_cvt_pk_bf16_f32 v223, v198, v199
    v_add_f32 v238, v238, v199
    s_waitcnt lgkmcnt(1)
    buffer_store_dwordx4 v[48:51], v231, s[20:23], s37 offen offset:128 nt
    s_waitcnt lgkmcnt(0)
    buffer_store_dwordx4 v[52:55], v231, s[20:23], s37 offen offset:2176 nt
    v_pk_mul_f32 v[0:1], v[0:1], v[40:41]
    v_pk_mul_f32 v[2:3], v[2:3], v[42:43]
    v_pk_mul_f32 v[4:5], v[4:5], v[40:41]
    v_pk_mul_f32 v[6:7], v[6:7], v[42:43]
    v_pk_mul_f32 v[8:9], v[8:9], v[40:41]
    v_pk_mul_f32 v[10:11], v[10:11], v[42:43]
    v_pk_mul_f32 v[12:13], v[12:13], v[40:41]
    v_pk_mul_f32 v[14:15], v[14:15], v[42:43]
    v_cvt_pk_bf16_f32 v0, v0, v1
    v_cvt_pk_bf16_f32 v1, v2, v3
    v_cvt_pk_bf16_f32 v2, v4, v5
    v_cvt_pk_bf16_f32 v3, v6, v7
    v_cvt_pk_bf16_f32 v8, v8, v9
    v_cvt_pk_bf16_f32 v9, v10, v11
    v_cvt_pk_bf16_f32 v10, v12, v13
    v_cvt_pk_bf16_f32 v11, v14, v15
    v_mfma_f32_16x16x32_bf16 v[4:7], v[0:3], a[146:149], 0
    v_mfma_f32_16x16x32_bf16 v[12:15], v[0:3], a[144:147], 0
    v_mfma_f32_16x16x32_bf16 v[0:3], v[8:11], a[146:149], 0
    v_mfma_f32_16x16x32_bf16 v[44:47], v[8:11], a[144:147], 0
    s_nop 4
    v_cvt_pk_bf16_f32 v4, v4, v5
    v_cvt_pk_bf16_f32 v5, v6, v7
    v_cvt_pk_bf16_f32 v6, v12, v13
    v_cvt_pk_bf16_f32 v7, v14, v15
    ds_write2_b64 v228, v[4:5], v[6:7] offset0:0 offset1:4
    v_cvt_pk_bf16_f32 v0, v0, v1
    v_cvt_pk_bf16_f32 v1, v2, v3
    v_cvt_pk_bf16_f32 v2, v44, v45
    v_cvt_pk_bf16_f32 v3, v46, v47
    ds_write2_b64 v228, v[0:1], v[2:3] offset0:8 offset1:12
    ds_read_b128 v[0:3], v230 offset:0
    ds_read_b128 v[4:7], v230 offset:2176
    v_mfma_f32_16x16x32_bf16 v[208:211], a[32:35], a[176:179], v[252:255]
    v_exp_f32 v200, v200
    v_mfma_f32_16x16x32_bf16 v[208:211], a[36:39], a[180:183], v[208:211]
    v_add_f32 v239, v239, v200
    v_mfma_f32_16x16x32_bf16 v[208:211], a[40:43], a[184:187], v[208:211]
    v_exp_f32 v201, v201
    v_mfma_f32_16x16x32_bf16 v[208:211], a[44:47], a[188:191], v[208:211]
    v_cvt_pk_bf16_f32 v224, v200, v201
    v_add_f32 v239, v239, v201
    v_mfma_f32_16x16x32_bf16 v[212:215], a[48:51], a[176:179], v[252:255]
    v_exp_f32 v202, v202
    v_mfma_f32_16x16x32_bf16 v[212:215], a[52:55], a[180:183], v[212:215]
    v_add_f32 v239, v239, v202
    v_mfma_f32_16x16x32_bf16 v[212:215], a[56:59], a[184:187], v[212:215]
    v_exp_f32 v203, v203
    v_mfma_f32_16x16x32_bf16 v[212:215], a[60:63], a[188:191], v[212:215]
    v_cvt_pk_bf16_f32 v225, v202, v203
    v_add_f32 v239, v239, v203
    v_mfma_f32_16x16x32_bf16 v[64:67], v[220:223], a[96:99], v[64:67]
    v_exp_f32 v204, v204
    v_mfma_f32_16x16x32_bf16 v[68:71], v[220:223], a[100:103], v[68:71]
    v_add_f32 v239, v239, v204
    v_mfma_f32_16x16x32_bf16 v[72:75], v[220:223], a[104:107], v[72:75]
    v_exp_f32 v205, v205
    v_mfma_f32_16x16x32_bf16 v[76:79], v[220:223], a[108:111], v[76:79]
    v_cvt_pk_bf16_f32 v226, v204, v205
    v_add_f32 v239, v239, v205
    v_mfma_f32_16x16x32_bf16 v[80:83], v[220:223], a[112:115], v[80:83]
    v_exp_f32 v206, v206
    v_mfma_f32_16x16x32_bf16 v[84:87], v[220:223], a[116:119], v[84:87]
    v_add_f32 v239, v239, v206
    v_mfma_f32_16x16x32_bf16 v[88:91], v[220:223], a[120:123], v[88:91]
    v_exp_f32 v207, v207
    v_mfma_f32_16x16x32_bf16 v[92:95], v[220:223], a[124:127], v[92:95]
    v_cvt_pk_bf16_f32 v227, v206, v207
    v_add_f32 v239, v239, v207
    s_waitcnt lgkmcnt(1)
    buffer_store_dwordx4 v[0:3], v231, s[20:23], s36 offen offset:0 nt
    s_waitcnt lgkmcnt(0)
    buffer_store_dwordx4 v[4:7], v231, s[20:23], s36 offen offset:2048 nt
    v_mov_b32 v247, v238
    v_pk_mul_f32 v[16:17], v[16:17], v[40:41]
    v_pk_mul_f32 v[18:19], v[18:19], v[42:43]
    v_permlane16_swap_b32 v238, v247
    v_pk_mul_f32 v[20:21], v[20:21], v[40:41]
    v_add_f32 v238, v238, v247
    v_mov_b32 v247, v238
    v_pk_mul_f32 v[22:23], v[22:23], v[42:43]
    v_pk_mul_f32 v[24:25], v[24:25], v[40:41]
    v_permlane32_swap_b32 v238, v247
    v_pk_mul_f32 v[26:27], v[26:27], v[42:43]
    v_add_f32 v238, v238, v247
    v_min_f32 v243, v243, v238
    v_max_f32 v244, v244, v238
    v_rcp_f32 v238, v238
    v_pk_mul_f32 v[28:29], v[28:29], v[40:41]
    v_pk_mul_f32 v[30:31], v[30:31], v[42:43]
    v_mfma_f32_16x16x4_f32 v[8:11], v238, a252, 0
    v_cvt_pk_bf16_f32 v16, v16, v17
    v_cvt_pk_bf16_f32 v17, v18, v19
    v_cvt_pk_bf16_f32 v18, v20, v21
    v_cvt_pk_bf16_f32 v19, v22, v23
    v_cvt_pk_bf16_f32 v24, v24, v25
    v_cvt_pk_bf16_f32 v25, v26, v27
    v_cvt_pk_bf16_f32 v26, v28, v29
    v_cvt_pk_bf16_f32 v27, v30, v31
    v_mfma_f32_16x16x32_bf16 v[20:23], v[16:19], a[146:149], 0
    v_mfma_f32_16x16x32_bf16 v[28:31], v[16:19], a[144:147], 0
    v_mfma_f32_16x16x32_bf16 v[16:19], v[24:27], a[146:149], 0
    v_mfma_f32_16x16x32_bf16 v[12:15], v[24:27], a[144:147], 0
    s_nop 4
    v_cvt_pk_bf16_f32 v20, v20, v21
    v_cvt_pk_bf16_f32 v21, v22, v23
    v_cvt_pk_bf16_f32 v22, v28, v29
    v_cvt_pk_bf16_f32 v23, v30, v31
    ds_write2_b64 v228, v[20:21], v[22:23] offset0:16 offset1:20
    v_cvt_pk_bf16_f32 v16, v16, v17
    v_cvt_pk_bf16_f32 v17, v18, v19
    v_cvt_pk_bf16_f32 v18, v12, v13
    v_cvt_pk_bf16_f32 v19, v14, v15
    ds_write2_b64 v228, v[16:17], v[18:19] offset0:24 offset1:28
    ds_read_b128 v[16:19], v230 offset:128
    ds_read_b128 v[20:23], v230 offset:2304
    v_mfma_f32_16x16x32_bf16 v[192:195], a[0:3], a[192:195], v[252:255]
    v_exp_f32 v208, v208
    v_mfma_f32_16x16x32_bf16 v[192:195], a[4:7], a[196:199], v[192:195]
    v_add_f32 v239, v239, v208
    v_mfma_f32_16x16x32_bf16 v[192:195], a[8:11], a[200:203], v[192:195]
    v_exp_f32 v209, v209
    v_mfma_f32_16x16x32_bf16 v[192:195], a[12:15], a[204:207], v[192:195]
    v_cvt_pk_bf16_f32 v216, v208, v209
    v_add_f32 v239, v239, v209
    v_mfma_f32_16x16x32_bf16 v[196:199], a[16:19], a[192:195], v[252:255]
    v_exp_f32 v210, v210
    v_mfma_f32_16x16x32_bf16 v[196:199], a[20:23], a[196:199], v[196:199]
    v_add_f32 v239, v239, v210
    v_mfma_f32_16x16x32_bf16 v[196:199], a[24:27], a[200:203], v[196:199]
    v_exp_f32 v211, v211
    v_mfma_f32_16x16x32_bf16 v[196:199], a[28:31], a[204:207], v[196:199]
    v_cvt_pk_bf16_f32 v217, v210, v211
    v_add_f32 v239, v239, v211
    v_mfma_f32_16x16x32_bf16 v[96:99], v[224:227], a[64:67], v[96:99]
    v_exp_f32 v212, v212
    v_mfma_f32_16x16x32_bf16 v[100:103], v[224:227], a[68:71], v[100:103]
    v_add_f32 v239, v239, v212
    v_mfma_f32_16x16x32_bf16 v[104:107], v[224:227], a[72:75], v[104:107]
    v_exp_f32 v213, v213
    v_mfma_f32_16x16x32_bf16 v[108:111], v[224:227], a[76:79], v[108:111]
    v_cvt_pk_bf16_f32 v218, v212, v213
    v_add_f32 v239, v239, v213
    v_mfma_f32_16x16x32_bf16 v[112:115], v[224:227], a[80:83], v[112:115]
    v_exp_f32 v214, v214
    v_mfma_f32_16x16x32_bf16 v[116:119], v[224:227], a[84:87], v[116:119]
    v_add_f32 v239, v239, v214
    v_mfma_f32_16x16x32_bf16 v[120:123], v[224:227], a[88:91], v[120:123]
    v_exp_f32 v215, v215
    v_mfma_f32_16x16x32_bf16 v[124:127], v[224:227], a[92:95], v[124:127]
    v_cvt_pk_bf16_f32 v219, v214, v215
    v_add_f32 v239, v239, v215
    s_waitcnt lgkmcnt(1)
    buffer_store_dwordx4 v[16:19], v231, s[20:23], s36 offen offset:128 nt
    s_waitcnt lgkmcnt(0)
    buffer_store_dwordx4 v[20:23], v231, s[20:23], s36 offen offset:2176 nt
    v_pk_mul_f32 v[64:65], v[64:65], v[8:9]
    v_pk_mul_f32 v[66:67], v[66:67], v[10:11]
    v_pk_mul_f32 v[68:69], v[68:69], v[8:9]
    v_pk_mul_f32 v[70:71], v[70:71], v[10:11]
    v_pk_mul_f32 v[72:73], v[72:73], v[8:9]
    v_pk_mul_f32 v[74:75], v[74:75], v[10:11]
    v_pk_mul_f32 v[76:77], v[76:77], v[8:9]
    v_pk_mul_f32 v[78:79], v[78:79], v[10:11]
    v_cvt_pk_bf16_f32 v64, v64, v65
    v_cvt_pk_bf16_f32 v65, v66, v67
    v_cvt_pk_bf16_f32 v66, v68, v69
    v_cvt_pk_bf16_f32 v67, v70, v71
    v_cvt_pk_bf16_f32 v72, v72, v73
    v_cvt_pk_bf16_f32 v73, v74, v75
    v_cvt_pk_bf16_f32 v74, v76, v77
    v_cvt_pk_bf16_f32 v75, v78, v79
    v_mfma_f32_16x16x32_bf16 v[68:71], v[64:67], a[146:149], 0
    v_mfma_f32_16x16x32_bf16 v[76:79], v[64:67], a[144:147], 0
    v_mfma_f32_16x16x32_bf16 v[64:67], v[72:75], a[146:149], 0
    v_mfma_f32_16x16x32_bf16 v[12:15], v[72:75], a[144:147], 0
    s_nop 4
    v_cvt_pk_bf16_f32 v68, v68, v69
    v_cvt_pk_bf16_f32 v69, v70, v71
    v_cvt_pk_bf16_f32 v70, v76, v77
    v_cvt_pk_bf16_f32 v71, v78, v79
    ds_write2_b64 v228, v[68:69], v[70:71] offset0:0 offset1:4
    v_cvt_pk_bf16_f32 v64, v64, v65
    v_cvt_pk_bf16_f32 v65, v66, v67
    v_cvt_pk_bf16_f32 v66, v12, v13
    v_cvt_pk_bf16_f32 v67, v14, v15
    ds_write2_b64 v228, v[64:65], v[66:67] offset0:8 offset1:12
    ds_read_b128 v[64:67], v230 offset:0
    ds_read_b128 v[68:71], v230 offset:2176
    v_mfma_f32_16x16x32_bf16 v[200:203], a[32:35], a[192:195], v[252:255]
    v_exp_f32 v192, v192
    v_mfma_f32_16x16x32_bf16 v[200:203], a[36:39], a[196:199], v[200:203]
    v_add_f32 v240, v240, v192
    v_mfma_f32_16x16x32_bf16 v[200:203], a[40:43], a[200:203], v[200:203]
    v_exp_f32 v193, v193
    v_mfma_f32_16x16x32_bf16 v[200:203], a[44:47], a[204:207], v[200:203]
    v_cvt_pk_bf16_f32 v220, v192, v193
    v_add_f32 v240, v240, v193
    v_mfma_f32_16x16x32_bf16 v[204:207], a[48:51], a[192:195], v[252:255]
    v_exp_f32 v194, v194
    v_mfma_f32_16x16x32_bf16 v[204:207], a[52:55], a[196:199], v[204:207]
    v_add_f32 v240, v240, v194
    v_mfma_f32_16x16x32_bf16 v[204:207], a[56:59], a[200:203], v[204:207]
    v_exp_f32 v195, v195
    v_mfma_f32_16x16x32_bf16 v[204:207], a[60:63], a[204:207], v[204:207]
    v_cvt_pk_bf16_f32 v221, v194, v195
    v_add_f32 v240, v240, v195
    v_mfma_f32_16x16x32_bf16 v[96:99], v[216:219], a[96:99], v[96:99]
    v_exp_f32 v196, v196
    v_mfma_f32_16x16x32_bf16 v[100:103], v[216:219], a[100:103], v[100:103]
    v_add_f32 v240, v240, v196
    v_mfma_f32_16x16x32_bf16 v[104:107], v[216:219], a[104:107], v[104:107]
    v_exp_f32 v197, v197
    v_mfma_f32_16x16x32_bf16 v[108:111], v[216:219], a[108:111], v[108:111]
    v_cvt_pk_bf16_f32 v222, v196, v197
    v_add_f32 v240, v240, v197
    v_mfma_f32_16x16x32_bf16 v[112:115], v[216:219], a[112:115], v[112:115]
    v_exp_f32 v198, v198
    v_mfma_f32_16x16x32_bf16 v[116:119], v[216:219], a[116:119], v[116:119]
    v_add_f32 v240, v240, v198
    v_mfma_f32_16x16x32_bf16 v[120:123], v[216:219], a[120:123], v[120:123]
    v_exp_f32 v199, v199
    v_mfma_f32_16x16x32_bf16 v[124:127], v[216:219], a[124:127], v[124:127]
    v_cvt_pk_bf16_f32 v223, v198, v199
    v_add_f32 v240, v240, v199
    s_waitcnt lgkmcnt(1)
    buffer_store_dwordx4 v[64:67], v231, s[20:23], s38 offen offset:0 nt
    s_waitcnt lgkmcnt(0)
    buffer_store_dwordx4 v[68:71], v231, s[20:23], s38 offen offset:2048 nt
    v_mov_b32 v247, v239
    v_pk_mul_f32 v[80:81], v[80:81], v[8:9]
    v_pk_mul_f32 v[82:83], v[82:83], v[10:11]
    v_permlane16_swap_b32 v239, v247
    v_pk_mul_f32 v[84:85], v[84:85], v[8:9]
    v_add_f32 v239, v239, v247
    v_mov_b32 v247, v239
    v_pk_mul_f32 v[86:87], v[86:87], v[10:11]
    v_pk_mul_f32 v[88:89], v[88:89], v[8:9]
    v_permlane32_swap_b32 v239, v247
    v_pk_mul_f32 v[90:91], v[90:91], v[10:11]
    v_add_f32 v239, v239, v247
    v_min_f32 v243, v243, v239
    v_max_f32 v244, v244, v239
    v_rcp_f32 v239, v239
    v_pk_mul_f32 v[92:93], v[92:93], v[8:9]
    v_pk_mul_f32 v[94:95], v[94:95], v[10:11]
    v_mfma_f32_16x16x4_f32 v[72:75], v239, a252, 0
    v_cvt_pk_bf16_f32 v80, v80, v81
    v_cvt_pk_bf16_f32 v81, v82, v83
    v_cvt_pk_bf16_f32 v82, v84, v85
    v_cvt_pk_bf16_f32 v83, v86, v87
    v_cvt_pk_bf16_f32 v88, v88, v89
    v_cvt_pk_bf16_f32 v89, v90, v91
    v_cvt_pk_bf16_f32 v90, v92, v93
    v_cvt_pk_bf16_f32 v91, v94, v95
    v_mfma_f32_16x16x32_bf16 v[84:87], v[80:83], a[146:149], 0
    v_mfma_f32_16x16x32_bf16 v[92:95], v[80:83], a[144:147], 0
    v_mfma_f32_16x16x32_bf16 v[80:83], v[88:91], a[146:149], 0
    v_mfma_f32_16x16x32_bf16 v[76:79], v[88:91], a[144:147], 0
    s_nop 4
    v_cvt_pk_bf16_f32 v84, v84, v85
    v_cvt_pk_bf16_f32 v85, v86, v87
    v_cvt_pk_bf16_f32 v86, v92, v93
    v_cvt_pk_bf16_f32 v87, v94, v95
    ds_write2_b64 v228, v[84:85], v[86:87] offset0:16 offset1:20
    v_cvt_pk_bf16_f32 v80, v80, v81
    v_cvt_pk_bf16_f32 v81, v82, v83
    v_cvt_pk_bf16_f32 v82, v76, v77
    v_cvt_pk_bf16_f32 v83, v78, v79
    ds_write2_b64 v228, v[80:81], v[82:83] offset0:24 offset1:28
    ds_read_b128 v[80:83], v230 offset:128
    ds_read_b128 v[84:87], v230 offset:2304
    s_nop 1
    v_mfma_f32_16x16x32_bf16 v[128:131], v[220:223], a[64:67], v[128:131]
    v_exp_f32 v200, v200
    v_mfma_f32_16x16x32_bf16 v[132:135], v[220:223], a[68:71], v[132:135]
    v_add_f32 v240, v240, v200
    v_exp_f32 v201, v201
    v_mfma_f32_16x16x32_bf16 v[136:139], v[220:223], a[72:75], v[136:139]
    v_cvt_pk_bf16_f32 v224, v200, v201
    v_add_f32 v240, v240, v201
    v_exp_f32 v202, v202
    v_mfma_f32_16x16x32_bf16 v[140:143], v[220:223], a[76:79], v[140:143]
    v_add_f32 v240, v240, v202
    v_exp_f32 v203, v203
    v_mfma_f32_16x16x32_bf16 v[144:147], v[220:223], a[80:83], v[144:147]
    v_cvt_pk_bf16_f32 v225, v202, v203
    v_add_f32 v240, v240, v203
    v_exp_f32 v204, v204
    v_mfma_f32_16x16x32_bf16 v[148:151], v[220:223], a[84:87], v[148:151]
    v_add_f32 v240, v240, v204
    v_exp_f32 v205, v205
    v_mfma_f32_16x16x32_bf16 v[152:155], v[220:223], a[88:91], v[152:155]
    v_cvt_pk_bf16_f32 v226, v204, v205
    v_add_f32 v240, v240, v205
    v_exp_f32 v206, v206
    v_mfma_f32_16x16x32_bf16 v[156:159], v[220:223], a[92:95], v[156:159]
    v_add_f32 v240, v240, v206
    v_exp_f32 v207, v207
    s_nop 0
    v_cvt_pk_bf16_f32 v227, v206, v207
    v_add_f32 v240, v240, v207
    s_waitcnt lgkmcnt(1)
    buffer_store_dwordx4 v[80:83], v231, s[20:23], s38 offen offset:128 nt
    s_waitcnt lgkmcnt(0)
    buffer_store_dwordx4 v[84:87], v231, s[20:23], s38 offen offset:2176 nt
    v_pk_mul_f32 v[96:97], v[96:97], v[72:73]
    v_pk_mul_f32 v[98:99], v[98:99], v[74:75]
    v_pk_mul_f32 v[100:101], v[100:101], v[72:73]
    v_pk_mul_f32 v[102:103], v[102:103], v[74:75]
    v_pk_mul_f32 v[104:105], v[104:105], v[72:73]
    v_pk_mul_f32 v[106:107], v[106:107], v[74:75]
    v_pk_mul_f32 v[108:109], v[108:109], v[72:73]
    v_pk_mul_f32 v[110:111], v[110:111], v[74:75]
    v_cvt_pk_bf16_f32 v96, v96, v97
    v_cvt_pk_bf16_f32 v97, v98, v99
    v_cvt_pk_bf16_f32 v98, v100, v101
    v_cvt_pk_bf16_f32 v99, v102, v103
    v_cvt_pk_bf16_f32 v104, v104, v105
    v_cvt_pk_bf16_f32 v105, v106, v107
    v_cvt_pk_bf16_f32 v106, v108, v109
    v_cvt_pk_bf16_f32 v107, v110, v111
    v_mfma_f32_16x16x32_bf16 v[100:103], v[96:99], a[146:149], 0
    v_mfma_f32_16x16x32_bf16 v[108:111], v[96:99], a[144:147], 0
    v_mfma_f32_16x16x32_bf16 v[96:99], v[104:107], a[146:149], 0
    v_mfma_f32_16x16x32_bf16 v[76:79], v[104:107], a[144:147], 0
    s_nop 4
    v_cvt_pk_bf16_f32 v100, v100, v101
    v_cvt_pk_bf16_f32 v101, v102, v103
    v_cvt_pk_bf16_f32 v102, v108, v109
    v_cvt_pk_bf16_f32 v103, v110, v111
    ds_write2_b64 v228, v[100:101], v[102:103] offset0:0 offset1:4
    v_cvt_pk_bf16_f32 v96, v96, v97
    v_cvt_pk_bf16_f32 v97, v98, v99
    v_cvt_pk_bf16_f32 v98, v76, v77
    v_cvt_pk_bf16_f32 v99, v78, v79
    ds_write2_b64 v228, v[96:97], v[98:99] offset0:8 offset1:12
    ds_read_b128 v[96:99], v230 offset:0
    ds_read_b128 v[100:103], v230 offset:2176
    s_nop 1
    v_mfma_f32_16x16x32_bf16 v[128:131], v[224:227], a[96:99], v[128:131]
    v_mfma_f32_16x16x32_bf16 v[132:135], v[224:227], a[100:103], v[132:135]
    v_mfma_f32_16x16x32_bf16 v[136:139], v[224:227], a[104:107], v[136:139]
    v_mfma_f32_16x16x32_bf16 v[140:143], v[224:227], a[108:111], v[140:143]
    v_mfma_f32_16x16x32_bf16 v[144:147], v[224:227], a[112:115], v[144:147]
    v_mfma_f32_16x16x32_bf16 v[148:151], v[224:227], a[116:119], v[148:151]
    v_mfma_f32_16x16x32_bf16 v[152:155], v[224:227], a[120:123], v[152:155]
    v_mfma_f32_16x16x32_bf16 v[156:159], v[224:227], a[124:127], v[156:159]
    s_waitcnt lgkmcnt(1)
    buffer_store_dwordx4 v[96:99], v231, s[20:23], s39 offen offset:0 nt
    s_waitcnt lgkmcnt(0)
    buffer_store_dwordx4 v[100:103], v231, s[20:23], s39 offen offset:2048 nt
    v_mov_b32 v247, v240
    v_pk_mul_f32 v[112:113], v[112:113], v[72:73]
    v_pk_mul_f32 v[114:115], v[114:115], v[74:75]
    v_permlane16_swap_b32 v240, v247
    v_pk_mul_f32 v[116:117], v[116:117], v[72:73]
    v_add_f32 v240, v240, v247
    v_mov_b32 v247, v240
    v_pk_mul_f32 v[118:119], v[118:119], v[74:75]
    v_pk_mul_f32 v[120:121], v[120:121], v[72:73]
    v_permlane32_swap_b32 v240, v247
    v_pk_mul_f32 v[122:123], v[122:123], v[74:75]
    v_add_f32 v240, v240, v247
    v_min_f32 v243, v243, v240
    v_max_f32 v244, v244, v240
    v_rcp_f32 v240, v240
    v_pk_mul_f32 v[124:125], v[124:125], v[72:73]
    v_pk_mul_f32 v[126:127], v[126:127], v[74:75]
    v_mfma_f32_16x16x4_f32 v[104:107], v240, a252, 0
    v_cvt_pk_bf16_f32 v112, v112, v113
    v_cvt_pk_bf16_f32 v113, v114, v115
    v_cvt_pk_bf16_f32 v114, v116, v117
    v_cvt_pk_bf16_f32 v115, v118, v119
    v_cvt_pk_bf16_f32 v120, v120, v121
    v_cvt_pk_bf16_f32 v121, v122, v123
    v_cvt_pk_bf16_f32 v122, v124, v125
    v_cvt_pk_bf16_f32 v123, v126, v127
    v_mfma_f32_16x16x32_bf16 v[116:119], v[112:115], a[146:149], 0
    v_mfma_f32_16x16x32_bf16 v[124:127], v[112:115], a[144:147], 0
    v_mfma_f32_16x16x32_bf16 v[112:115], v[120:123], a[146:149], 0
    v_mfma_f32_16x16x32_bf16 v[108:111], v[120:123], a[144:147], 0
    s_nop 4
    v_cvt_pk_bf16_f32 v116, v116, v117
    v_cvt_pk_bf16_f32 v117, v118, v119
    v_cvt_pk_bf16_f32 v118, v124, v125
    v_cvt_pk_bf16_f32 v119, v126, v127
    ds_write2_b64 v228, v[116:117], v[118:119] offset0:16 offset1:20
    v_cvt_pk_bf16_f32 v112, v112, v113
    v_cvt_pk_bf16_f32 v113, v114, v115
    v_cvt_pk_bf16_f32 v114, v108, v109
    v_cvt_pk_bf16_f32 v115, v110, v111
    ds_write2_b64 v228, v[112:113], v[114:115] offset0:24 offset1:28
    ds_read_b128 v[112:115], v230 offset:128
    ds_read_b128 v[116:119], v230 offset:2304
    v_pk_mul_f32 v[128:129], v[128:129], v[104:105]
    v_pk_mul_f32 v[130:131], v[130:131], v[106:107]
    v_pk_mul_f32 v[144:145], v[144:145], v[104:105]
    v_pk_mul_f32 v[146:147], v[146:147], v[106:107]
    v_pk_mul_f32 v[132:133], v[132:133], v[104:105]
    v_pk_mul_f32 v[134:135], v[134:135], v[106:107]
    v_pk_mul_f32 v[148:149], v[148:149], v[104:105]
    v_pk_mul_f32 v[150:151], v[150:151], v[106:107]
    s_waitcnt lgkmcnt(1)
    buffer_store_dwordx4 v[112:115], v231, s[20:23], s39 offen offset:128 nt
    s_waitcnt lgkmcnt(0)
    buffer_store_dwordx4 v[116:119], v231, s[20:23], s39 offen offset:2176 nt
    v_pk_mul_f32 v[136:137], v[136:137], v[104:105]
    v_pk_mul_f32 v[138:139], v[138:139], v[106:107]
    v_pk_mul_f32 v[152:153], v[152:153], v[104:105]
    v_pk_mul_f32 v[154:155], v[154:155], v[106:107]
    v_pk_mul_f32 v[140:141], v[140:141], v[104:105]
    v_pk_mul_f32 v[142:143], v[142:143], v[106:107]
    v_pk_mul_f32 v[156:157], v[156:157], v[104:105]
    v_pk_mul_f32 v[158:159], v[158:159], v[106:107]
    v_cvt_pk_bf16_f32 v128, v128, v129
    v_cvt_pk_bf16_f32 v129, v130, v131
    v_cvt_pk_bf16_f32 v144, v144, v145
    v_cvt_pk_bf16_f32 v145, v146, v147
    v_cvt_pk_bf16_f32 v130, v132, v133
    v_cvt_pk_bf16_f32 v131, v134, v135
    v_cvt_pk_bf16_f32 v146, v148, v149
    v_cvt_pk_bf16_f32 v147, v150, v151
    v_cvt_pk_bf16_f32 v136, v136, v137
    v_cvt_pk_bf16_f32 v137, v138, v139
    v_cvt_pk_bf16_f32 v152, v152, v153
    v_cvt_pk_bf16_f32 v153, v154, v155
    v_cvt_pk_bf16_f32 v138, v140, v141
    v_cvt_pk_bf16_f32 v139, v142, v143
    v_cvt_pk_bf16_f32 v154, v156, v157
    v_cvt_pk_bf16_f32 v155, v158, v159
    v_mfma_f32_16x16x32_bf16 v[132:135], v[128:131], a[146:149], 0
    v_mfma_f32_16x16x32_bf16 v[140:143], v[128:131], a[144:147], 0
    v_mfma_f32_16x16x32_bf16 v[148:151], v[144:147], a[146:149], 0
    v_mfma_f32_16x16x32_bf16 v[156:159], v[144:147], a[144:147], 0
    v_mfma_f32_16x16x32_bf16 v[128:131], v[136:139], a[146:149], 0
    v_mfma_f32_16x16x32_bf16 v[108:111], v[136:139], a[144:147], 0
    v_mfma_f32_16x16x32_bf16 v[144:147], v[152:155], a[146:149], 0
    v_mfma_f32_16x16x32_bf16 v[76:79], v[152:155], a[144:147], 0
    s_nop 0
    v_cvt_pk_bf16_f32 v132, v132, v133
    v_cvt_pk_bf16_f32 v133, v134, v135
    v_cvt_pk_bf16_f32 v148, v148, v149
    v_cvt_pk_bf16_f32 v149, v150, v151
    v_cvt_pk_bf16_f32 v134, v140, v141
    v_cvt_pk_bf16_f32 v135, v142, v143
    v_cvt_pk_bf16_f32 v150, v156, v157
    v_cvt_pk_bf16_f32 v151, v158, v159
    ds_write2_b64 v228, v[132:133], v[134:135] offset0:0 offset1:4
    v_cvt_pk_bf16_f32 v128, v128, v129
    ds_write2_b64 v228, v[148:149], v[150:151] offset0:16 offset1:20
    v_cvt_pk_bf16_f32 v144, v144, v145
    v_cvt_pk_bf16_f32 v129, v130, v131
    v_cvt_pk_bf16_f32 v130, v108, v109
    v_cvt_pk_bf16_f32 v145, v146, v147
    v_cvt_pk_bf16_f32 v146, v76, v77
    v_cvt_pk_bf16_f32 v131, v110, v111
    ds_write2_b64 v228, v[128:129], v[130:131] offset0:8 offset1:12
    v_cvt_pk_bf16_f32 v147, v78, v79
    ds_write2_b64 v228, v[144:145], v[146:147] offset0:24 offset1:28
    ds_read_b128 v[128:131], v230 offset:0
    ds_read_b128 v[132:135], v230 offset:2176
    ds_read_b128 v[144:147], v230 offset:128
    ds_read_b128 v[148:151], v230 offset:2304
    s_waitcnt lgkmcnt(3)
    buffer_store_dwordx4 v[128:131], v231, s[20:23], s40 offen offset:0 nt
    s_waitcnt lgkmcnt(2)
    buffer_store_dwordx4 v[132:135], v231, s[20:23], s40 offen offset:2048 nt
    s_waitcnt lgkmcnt(1)
    buffer_store_dwordx4 v[144:147], v231, s[20:23], s40 offen offset:128 nt
    s_waitcnt lgkmcnt(0)
    buffer_store_dwordx4 v[148:151], v231, s[20:23], s40 offen offset:2176 nt
    s_branch L_epi
L_epi:
    v_cmp_nge_f32 vcc, v243, s62
    s_mov_b64 s[44:45], vcc
    v_cmp_nle_f32 vcc, v244, s63
    s_or_b64 s[44:45], s[44:45], vcc
    s_cmp_lg_u64 s[44:45], 0
    s_cselect_b32 s34, 1, 0
    v_mov_b32 v246, s34
    ds_write_b32 v229, v246 offset:20480
    s_waitcnt lgkmcnt(0)
    s_barrier
    ds_read_b32 v247, v242 offset:20480
    ds_read_b32 v248, v242 offset:21504
    ds_read_b32 v249, v242 offset:22528
    ds_read_b32 v250, v242 offset:23552
    s_waitcnt lgkmcnt(0)
    v_or_b32 v247, v247, v248
    v_or3_b32 v247, v247, v249, v250
    v_cmp_ne_u32 vcc, 0, v247
    s_nop 1
    s_cmp_lg_u64 vcc, 0
    s_cbranch_scc1 L_fallback
    s_endpgm
L_fallback:
    s_waitcnt vmcnt(0) lgkmcnt(0)
    s_barrier
    v_accvgpr_read_b32 v228, a240
    v_accvgpr_read_b32 v229, a241
    v_accvgpr_read_b32 v230, a242
    v_accvgpr_read_b32 v231, a243
    v_accvgpr_read_b32 v232, a244
    v_accvgpr_read_b32 v233, a245
    v_accvgpr_read_b32 v234, a246
    v_accvgpr_read_b32 v235, a247
    v_mbcnt_lo_u32_b32 v250, -1, 0
    v_mbcnt_hi_u32_b32 v250, -1, v250
    v_and_b32 v242, 15, v250
    v_lshrrev_b32 v243, 4, v250
    v_lshlrev_b32 v242, 8, v242
    v_lshl_add_u32 v242, v243, 4, v242
    s_mul_i32 s35, s28, 20480
    s_add_u32 s48, s35, 0
    buffer_load_dwordx4 v[0:3], v242, s[8:11], s48 offen offset:0
    buffer_load_dwordx4 v[4:7], v242, s[8:11], s48 offen offset:64
    buffer_load_dwordx4 v[8:11], v242, s[8:11], s48 offen offset:128
    buffer_load_dwordx4 v[12:15], v242, s[8:11], s48 offen offset:192
    s_waitcnt vmcnt(0)
    v_lshlrev_b32 v192, 16, v0
    v_and_b32 v193, s64, v0
    v_lshlrev_b32 v194, 16, v1
    v_and_b32 v195, s64, v1
    v_lshlrev_b32 v196, 16, v2
    v_and_b32 v197, s64, v2
    v_lshlrev_b32 v198, 16, v3
    v_and_b32 v199, s64, v3
    v_pk_mul_f32 v[192:193], v[192:193], s[60:61]
    v_pk_mul_f32 v[194:195], v[194:195], s[60:61]
    v_pk_mul_f32 v[196:197], v[196:197], s[60:61]
    v_pk_mul_f32 v[198:199], v[198:199], s[60:61]
    v_cvt_pk_bf16_f32 v0, v192, v193
    v_cvt_pk_bf16_f32 v1, v194, v195
    v_cvt_pk_bf16_f32 v2, v196, v197
    v_cvt_pk_bf16_f32 v3, v198, v199
    v_accvgpr_write_b32 a128, v0
    v_accvgpr_write_b32 a129, v1
    v_accvgpr_write_b32 a130, v2
    v_accvgpr_write_b32 a131, v3
    v_lshlrev_b32 v192, 16, v4
    v_and_b32 v193, s64, v4
    v_lshlrev_b32 v194, 16, v5
    v_and_b32 v195, s64, v5
    v_lshlrev_b32 v196, 16, v6
    v_and_b32 v197, s64, v6
    v_lshlrev_b32 v198, 16, v7
    v_and_b32 v199, s64, v7
    v_pk_mul_f32 v[192:193], v[192:193], s[60:61]
    v_pk_mul_f32 v[194:195], v[194:195], s[60:61]
    v_pk_mul_f32 v[196:197], v[196:197], s[60:61]
    v_pk_mul_f32 v[198:199], v[198:199], s[60:61]
    v_cvt_pk_bf16_f32 v4, v192, v193
    v_cvt_pk_bf16_f32 v5, v194, v195
    v_cvt_pk_bf16_f32 v6, v196, v197
    v_cvt_pk_bf16_f32 v7, v198, v199
    v_accvgpr_write_b32 a132, v4
    v_accvgpr_write_b32 a133, v5
    v_accvgpr_write_b32 a134, v6
    v_accvgpr_write_b32 a135, v7
    v_lshlrev_b32 v192, 16, v8
    v_and_b32 v193, s64, v8
    v_lshlrev_b32 v194, 16, v9
    v_and_b32 v195, s64, v9
    v_lshlrev_b32 v196, 16, v10
    v_and_b32 v197, s64, v10
    v_lshlrev_b32 v198, 16, v11
    v_and_b32 v199, s64, v11
    v_pk_mul_f32 v[192:193], v[192:193], s[60:61]
    v_pk_mul_f32 v[194:195], v[194:195], s[60:61]
    v_pk_mul_f32 v[196:197], v[196:197], s[60:61]
    v_pk_mul_f32 v[198:199], v[198:199], s[60:61]
    v_cvt_pk_bf16_f32 v8, v192, v193
    v_cvt_pk_bf16_f32 v9, v194, v195
    v_cvt_pk_bf16_f32 v10, v196, v197
    v_cvt_pk_bf16_f32 v11, v198, v199
    v_accvgpr_write_b32 a136, v8
    v_accvgpr_write_b32 a137, v9
    v_accvgpr_write_b32 a138, v10
    v_accvgpr_write_b32 a139, v11
    v_lshlrev_b32 v192, 16, v12
    v_and_b32 v193, s64, v12
    v_lshlrev_b32 v194, 16, v13
    v_and_b32 v195, s64, v13
    v_lshlrev_b32 v196, 16, v14
    v_and_b32 v197, s64, v14
    v_lshlrev_b32 v198, 16, v15
    v_and_b32 v199, s64, v15
    v_pk_mul_f32 v[192:193], v[192:193], s[60:61]
    v_pk_mul_f32 v[194:195], v[194:195], s[60:61]
    v_pk_mul_f32 v[196:197], v[196:197], s[60:61]
    v_pk_mul_f32 v[198:199], v[198:199], s[60:61]
    v_cvt_pk_bf16_f32 v12, v192, v193
    v_cvt_pk_bf16_f32 v13, v194, v195
    v_cvt_pk_bf16_f32 v14, v196, v197
    v_cvt_pk_bf16_f32 v15, v198, v199
    v_accvgpr_write_b32 a140, v12
    v_accvgpr_write_b32 a141, v13
    v_accvgpr_write_b32 a142, v14
    v_accvgpr_write_b32 a143, v15
    s_add_u32 s48, s35, 4096
    buffer_load_dwordx4 v[0:3], v242, s[8:11], s48 offen offset:0
    buffer_load_dwordx4 v[4:7], v242, s[8:11], s48 offen offset:64
    buffer_load_dwordx4 v[8:11], v242, s[8:11], s48 offen offset:128
    buffer_load_dwordx4 v[12:15], v242, s[8:11], s48 offen offset:192
    s_waitcnt vmcnt(0)
    v_lshlrev_b32 v192, 16, v0
    v_and_b32 v193, s64, v0
    v_lshlrev_b32 v194, 16, v1
    v_and_b32 v195, s64, v1
    v_lshlrev_b32 v196, 16, v2
    v_and_b32 v197, s64, v2
    v_lshlrev_b32 v198, 16, v3
    v_and_b32 v199, s64, v3
    v_pk_mul_f32 v[192:193], v[192:193], s[60:61]
    v_pk_mul_f32 v[194:195], v[194:195], s[60:61]
    v_pk_mul_f32 v[196:197], v[196:197], s[60:61]
    v_pk_mul_f32 v[198:199], v[198:199], s[60:61]
    v_cvt_pk_bf16_f32 v0, v192, v193
    v_cvt_pk_bf16_f32 v1, v194, v195
    v_cvt_pk_bf16_f32 v2, v196, v197
    v_cvt_pk_bf16_f32 v3, v198, v199
    v_accvgpr_write_b32 a144, v0
    v_accvgpr_write_b32 a145, v1
    v_accvgpr_write_b32 a146, v2
    v_accvgpr_write_b32 a147, v3
    v_lshlrev_b32 v192, 16, v4
    v_and_b32 v193, s64, v4
    v_lshlrev_b32 v194, 16, v5
    v_and_b32 v195, s64, v5
    v_lshlrev_b32 v196, 16, v6
    v_and_b32 v197, s64, v6
    v_lshlrev_b32 v198, 16, v7
    v_and_b32 v199, s64, v7
    v_pk_mul_f32 v[192:193], v[192:193], s[60:61]
    v_pk_mul_f32 v[194:195], v[194:195], s[60:61]
    v_pk_mul_f32 v[196:197], v[196:197], s[60:61]
    v_pk_mul_f32 v[198:199], v[198:199], s[60:61]
    v_cvt_pk_bf16_f32 v4, v192, v193
    v_cvt_pk_bf16_f32 v5, v194, v195
    v_cvt_pk_bf16_f32 v6, v196, v197
    v_cvt_pk_bf16_f32 v7, v198, v199
    v_accvgpr_write_b32 a148, v4
    v_accvgpr_write_b32 a149, v5
    v_accvgpr_write_b32 a150, v6
    v_accvgpr_write_b32 a151, v7
    v_lshlrev_b32 v192, 16, v8
    v_and_b32 v193, s64, v8
    v_lshlrev_b32 v194, 16, v9
    v_and_b32 v195, s64, v9
    v_lshlrev_b32 v196, 16, v10
    v_and_b32 v197, s64, v10
    v_lshlrev_b32 v198, 16, v11
    v_and_b32 v199, s64, v11
    v_pk_mul_f32 v[192:193], v[192:193], s[60:61]
    v_pk_mul_f32 v[194:195], v[194:195], s[60:61]
    v_pk_mul_f32 v[196:197], v[196:197], s[60:61]
    v_pk_mul_f32 v[198:199], v[198:199], s[60:61]
    v_cvt_pk_bf16_f32 v8, v192, v193
    v_cvt_pk_bf16_f32 v9, v194, v195
    v_cvt_pk_bf16_f32 v10, v196, v197
    v_cvt_pk_bf16_f32 v11, v198, v199
    v_accvgpr_write_b32 a152, v8
    v_accvgpr_write_b32 a153, v9
    v_accvgpr_write_b32 a154, v10
    v_accvgpr_write_b32 a155, v11
    v_lshlrev_b32 v192, 16, v12
    v_and_b32 v193, s64, v12
    v_lshlrev_b32 v194, 16, v13
    v_and_b32 v195, s64, v13
    v_lshlrev_b32 v196, 16, v14
    v_and_b32 v197, s64, v14
    v_lshlrev_b32 v198, 16, v15
    v_and_b32 v199, s64, v15
    v_pk_mul_f32 v[192:193], v[192:193], s[60:61]
    v_pk_mul_f32 v[194:195], v[194:195], s[60:61]
    v_pk_mul_f32 v[196:197], v[196:197], s[60:61]
    v_pk_mul_f32 v[198:199], v[198:199], s[60:61]
    v_cvt_pk_bf16_f32 v12, v192, v193
    v_cvt_pk_bf16_f32 v13, v194, v195
    v_cvt_pk_bf16_f32 v14, v196, v197
    v_cvt_pk_bf16_f32 v15, v198, v199
    v_accvgpr_write_b32 a156, v12
    v_accvgpr_write_b32 a157, v13
    v_accvgpr_write_b32 a158, v14
    v_accvgpr_write_b32 a159, v15
    s_add_u32 s48, s35, 8192
    buffer_load_dwordx4 v[0:3], v242, s[8:11], s48 offen offset:0
    buffer_load_dwordx4 v[4:7], v242, s[8:11], s48 offen offset:64
    buffer_load_dwordx4 v[8:11], v242, s[8:11], s48 offen offset:128
    buffer_load_dwordx4 v[12:15], v242, s[8:11], s48 offen offset:192
    s_waitcnt vmcnt(0)
    v_lshlrev_b32 v192, 16, v0
    v_and_b32 v193, s64, v0
    v_lshlrev_b32 v194, 16, v1
    v_and_b32 v195, s64, v1
    v_lshlrev_b32 v196, 16, v2
    v_and_b32 v197, s64, v2
    v_lshlrev_b32 v198, 16, v3
    v_and_b32 v199, s64, v3
    v_pk_mul_f32 v[192:193], v[192:193], s[60:61]
    v_pk_mul_f32 v[194:195], v[194:195], s[60:61]
    v_pk_mul_f32 v[196:197], v[196:197], s[60:61]
    v_pk_mul_f32 v[198:199], v[198:199], s[60:61]
    v_cvt_pk_bf16_f32 v0, v192, v193
    v_cvt_pk_bf16_f32 v1, v194, v195
    v_cvt_pk_bf16_f32 v2, v196, v197
    v_cvt_pk_bf16_f32 v3, v198, v199
    v_accvgpr_write_b32 a160, v0
    v_accvgpr_write_b32 a161, v1
    v_accvgpr_write_b32 a162, v2
    v_accvgpr_write_b32 a163, v3
    v_lshlrev_b32 v192, 16, v4
    v_and_b32 v193, s64, v4
    v_lshlrev_b32 v194, 16, v5
    v_and_b32 v195, s64, v5
    v_lshlrev_b32 v196, 16, v6
    v_and_b32 v197, s64, v6
    v_lshlrev_b32 v198, 16, v7
    v_and_b32 v199, s64, v7
    v_pk_mul_f32 v[192:193], v[192:193], s[60:61]
    v_pk_mul_f32 v[194:195], v[194:195], s[60:61]
    v_pk_mul_f32 v[196:197], v[196:197], s[60:61]
    v_pk_mul_f32 v[198:199], v[198:199], s[60:61]
    v_cvt_pk_bf16_f32 v4, v192, v193
    v_cvt_pk_bf16_f32 v5, v194, v195
    v_cvt_pk_bf16_f32 v6, v196, v197
    v_cvt_pk_bf16_f32 v7, v198, v199
    v_accvgpr_write_b32 a164, v4
    v_accvgpr_write_b32 a165, v5
    v_accvgpr_write_b32 a166, v6
    v_accvgpr_write_b32 a167, v7
    v_lshlrev_b32 v192, 16, v8
    v_and_b32 v193, s64, v8
    v_lshlrev_b32 v194, 16, v9
    v_and_b32 v195, s64, v9
    v_lshlrev_b32 v196, 16, v10
    v_and_b32 v197, s64, v10
    v_lshlrev_b32 v198, 16, v11
    v_and_b32 v199, s64, v11
    v_pk_mul_f32 v[192:193], v[192:193], s[60:61]
    v_pk_mul_f32 v[194:195], v[194:195], s[60:61]
    v_pk_mul_f32 v[196:197], v[196:197], s[60:61]
    v_pk_mul_f32 v[198:199], v[198:199], s[60:61]
    v_cvt_pk_bf16_f32 v8, v192, v193
    v_cvt_pk_bf16_f32 v9, v194, v195
    v_cvt_pk_bf16_f32 v10, v196, v197
    v_cvt_pk_bf16_f32 v11, v198, v199
    v_accvgpr_write_b32 a168, v8
    v_accvgpr_write_b32 a169, v9
    v_accvgpr_write_b32 a170, v10
    v_accvgpr_write_b32 a171, v11
    v_lshlrev_b32 v192, 16, v12
    v_and_b32 v193, s64, v12
    v_lshlrev_b32 v194, 16, v13
    v_and_b32 v195, s64, v13
    v_lshlrev_b32 v196, 16, v14
    v_and_b32 v197, s64, v14
    v_lshlrev_b32 v198, 16, v15
    v_and_b32 v199, s64, v15
    v_pk_mul_f32 v[192:193], v[192:193], s[60:61]
    v_pk_mul_f32 v[194:195], v[194:195], s[60:61]
    v_pk_mul_f32 v[196:197], v[196:197], s[60:61]
    v_pk_mul_f32 v[198:199], v[198:199], s[60:61]
    v_cvt_pk_bf16_f32 v12, v192, v193
    v_cvt_pk_bf16_f32 v13, v194, v195
    v_cvt_pk_bf16_f32 v14, v196, v197
    v_cvt_pk_bf16_f32 v15, v198, v199
    v_accvgpr_write_b32 a172, v12
    v_accvgpr_write_b32 a173, v13
    v_accvgpr_write_b32 a174, v14
    v_accvgpr_write_b32 a175, v15
    s_add_u32 s48, s35, 12288
    buffer_load_dwordx4 v[0:3], v242, s[8:11], s48 offen offset:0
    buffer_load_dwordx4 v[4:7], v242, s[8:11], s48 offen offset:64
    buffer_load_dwordx4 v[8:11], v242, s[8:11], s48 offen offset:128
    buffer_load_dwordx4 v[12:15], v242, s[8:11], s48 offen offset:192
    s_waitcnt vmcnt(0)
    v_lshlrev_b32 v192, 16, v0
    v_and_b32 v193, s64, v0
    v_lshlrev_b32 v194, 16, v1
    v_and_b32 v195, s64, v1
    v_lshlrev_b32 v196, 16, v2
    v_and_b32 v197, s64, v2
    v_lshlrev_b32 v198, 16, v3
    v_and_b32 v199, s64, v3
    v_pk_mul_f32 v[192:193], v[192:193], s[60:61]
    v_pk_mul_f32 v[194:195], v[194:195], s[60:61]
    v_pk_mul_f32 v[196:197], v[196:197], s[60:61]
    v_pk_mul_f32 v[198:199], v[198:199], s[60:61]
    v_cvt_pk_bf16_f32 v0, v192, v193
    v_cvt_pk_bf16_f32 v1, v194, v195
    v_cvt_pk_bf16_f32 v2, v196, v197
    v_cvt_pk_bf16_f32 v3, v198, v199
    v_accvgpr_write_b32 a176, v0
    v_accvgpr_write_b32 a177, v1
    v_accvgpr_write_b32 a178, v2
    v_accvgpr_write_b32 a179, v3
    v_lshlrev_b32 v192, 16, v4
    v_and_b32 v193, s64, v4
    v_lshlrev_b32 v194, 16, v5
    v_and_b32 v195, s64, v5
    v_lshlrev_b32 v196, 16, v6
    v_and_b32 v197, s64, v6
    v_lshlrev_b32 v198, 16, v7
    v_and_b32 v199, s64, v7
    v_pk_mul_f32 v[192:193], v[192:193], s[60:61]
    v_pk_mul_f32 v[194:195], v[194:195], s[60:61]
    v_pk_mul_f32 v[196:197], v[196:197], s[60:61]
    v_pk_mul_f32 v[198:199], v[198:199], s[60:61]
    v_cvt_pk_bf16_f32 v4, v192, v193
    v_cvt_pk_bf16_f32 v5, v194, v195
    v_cvt_pk_bf16_f32 v6, v196, v197
    v_cvt_pk_bf16_f32 v7, v198, v199
    v_accvgpr_write_b32 a180, v4
    v_accvgpr_write_b32 a181, v5
    v_accvgpr_write_b32 a182, v6
    v_accvgpr_write_b32 a183, v7
    v_lshlrev_b32 v192, 16, v8
    v_and_b32 v193, s64, v8
    v_lshlrev_b32 v194, 16, v9
    v_and_b32 v195, s64, v9
    v_lshlrev_b32 v196, 16, v10
    v_and_b32 v197, s64, v10
    v_lshlrev_b32 v198, 16, v11
    v_and_b32 v199, s64, v11
    v_pk_mul_f32 v[192:193], v[192:193], s[60:61]
    v_pk_mul_f32 v[194:195], v[194:195], s[60:61]
    v_pk_mul_f32 v[196:197], v[196:197], s[60:61]
    v_pk_mul_f32 v[198:199], v[198:199], s[60:61]
    v_cvt_pk_bf16_f32 v8, v192, v193
    v_cvt_pk_bf16_f32 v9, v194, v195
    v_cvt_pk_bf16_f32 v10, v196, v197
    v_cvt_pk_bf16_f32 v11, v198, v199
    v_accvgpr_write_b32 a184, v8
    v_accvgpr_write_b32 a185, v9
    v_accvgpr_write_b32 a186, v10
    v_accvgpr_write_b32 a187, v11
    v_lshlrev_b32 v192, 16, v12
    v_and_b32 v193, s64, v12
    v_lshlrev_b32 v194, 16, v13
    v_and_b32 v195, s64, v13
    v_lshlrev_b32 v196, 16, v14
    v_and_b32 v197, s64, v14
    v_lshlrev_b32 v198, 16, v15
    v_and_b32 v199, s64, v15
    v_pk_mul_f32 v[192:193], v[192:193], s[60:61]
    v_pk_mul_f32 v[194:195], v[194:195], s[60:61]
    v_pk_mul_f32 v[196:197], v[196:197], s[60:61]
    v_pk_mul_f32 v[198:199], v[198:199], s[60:61]
    v_cvt_pk_bf16_f32 v12, v192, v193
    v_cvt_pk_bf16_f32 v13, v194, v195
    v_cvt_pk_bf16_f32 v14, v196, v197
    v_cvt_pk_bf16_f32 v15, v198, v199
    v_accvgpr_write_b32 a188, v12
    v_accvgpr_write_b32 a189, v13
    v_accvgpr_write_b32 a190, v14
    v_accvgpr_write_b32 a191, v15
    s_add_u32 s48, s35, 16384
    buffer_load_dwordx4 v[0:3], v242, s[8:11], s48 offen offset:0
    buffer_load_dwordx4 v[4:7], v242, s[8:11], s48 offen offset:64
    buffer_load_dwordx4 v[8:11], v242, s[8:11], s48 offen offset:128
    buffer_load_dwordx4 v[12:15], v242, s[8:11], s48 offen offset:192
    s_waitcnt vmcnt(0)
    v_lshlrev_b32 v192, 16, v0
    v_and_b32 v193, s64, v0
    v_lshlrev_b32 v194, 16, v1
    v_and_b32 v195, s64, v1
    v_lshlrev_b32 v196, 16, v2
    v_and_b32 v197, s64, v2
    v_lshlrev_b32 v198, 16, v3
    v_and_b32 v199, s64, v3
    v_pk_mul_f32 v[192:193], v[192:193], s[60:61]
    v_pk_mul_f32 v[194:195], v[194:195], s[60:61]
    v_pk_mul_f32 v[196:197], v[196:197], s[60:61]
    v_pk_mul_f32 v[198:199], v[198:199], s[60:61]
    v_cvt_pk_bf16_f32 v0, v192, v193
    v_cvt_pk_bf16_f32 v1, v194, v195
    v_cvt_pk_bf16_f32 v2, v196, v197
    v_cvt_pk_bf16_f32 v3, v198, v199
    v_accvgpr_write_b32 a192, v0
    v_accvgpr_write_b32 a193, v1
    v_accvgpr_write_b32 a194, v2
    v_accvgpr_write_b32 a195, v3
    v_lshlrev_b32 v192, 16, v4
    v_and_b32 v193, s64, v4
    v_lshlrev_b32 v194, 16, v5
    v_and_b32 v195, s64, v5
    v_lshlrev_b32 v196, 16, v6
    v_and_b32 v197, s64, v6
    v_lshlrev_b32 v198, 16, v7
    v_and_b32 v199, s64, v7
    v_pk_mul_f32 v[192:193], v[192:193], s[60:61]
    v_pk_mul_f32 v[194:195], v[194:195], s[60:61]
    v_pk_mul_f32 v[196:197], v[196:197], s[60:61]
    v_pk_mul_f32 v[198:199], v[198:199], s[60:61]
    v_cvt_pk_bf16_f32 v4, v192, v193
    v_cvt_pk_bf16_f32 v5, v194, v195
    v_cvt_pk_bf16_f32 v6, v196, v197
    v_cvt_pk_bf16_f32 v7, v198, v199
    v_accvgpr_write_b32 a196, v4
    v_accvgpr_write_b32 a197, v5
    v_accvgpr_write_b32 a198, v6
    v_accvgpr_write_b32 a199, v7
    v_lshlrev_b32 v192, 16, v8
    v_and_b32 v193, s64, v8
    v_lshlrev_b32 v194, 16, v9
    v_and_b32 v195, s64, v9
    v_lshlrev_b32 v196, 16, v10
    v_and_b32 v197, s64, v10
    v_lshlrev_b32 v198, 16, v11
    v_and_b32 v199, s64, v11
    v_pk_mul_f32 v[192:193], v[192:193], s[60:61]
    v_pk_mul_f32 v[194:195], v[194:195], s[60:61]
    v_pk_mul_f32 v[196:197], v[196:197], s[60:61]
    v_pk_mul_f32 v[198:199], v[198:199], s[60:61]
    v_cvt_pk_bf16_f32 v8, v192, v193
    v_cvt_pk_bf16_f32 v9, v194, v195
    v_cvt_pk_bf16_f32 v10, v196, v197
    v_cvt_pk_bf16_f32 v11, v198, v199
    v_accvgpr_write_b32 a200, v8
    v_accvgpr_write_b32 a201, v9
    v_accvgpr_write_b32 a202, v10
    v_accvgpr_write_b32 a203, v11
    v_lshlrev_b32 v192, 16, v12
    v_and_b32 v193, s64, v12
    v_lshlrev_b32 v194, 16, v13
    v_and_b32 v195, s64, v13
    v_lshlrev_b32 v196, 16, v14
    v_and_b32 v197, s64, v14
    v_lshlrev_b32 v198, 16, v15
    v_and_b32 v199, s64, v15
    v_pk_mul_f32 v[192:193], v[192:193], s[60:61]
    v_pk_mul_f32 v[194:195], v[194:195], s[60:61]
    v_pk_mul_f32 v[196:197], v[196:197], s[60:61]
    v_pk_mul_f32 v[198:199], v[198:199], s[60:61]
    v_cvt_pk_bf16_f32 v12, v192, v193
    v_cvt_pk_bf16_f32 v13, v194, v195
    v_cvt_pk_bf16_f32 v14, v196, v197
    v_cvt_pk_bf16_f32 v15, v198, v199
    v_accvgpr_write_b32 a204, v12
    v_accvgpr_write_b32 a205, v13
    v_accvgpr_write_b32 a206, v14
    v_accvgpr_write_b32 a207, v15
    s_mov_b32 s48, 81920
    buffer_load_dwordx4 v[0:3], v242, s[8:11], s48 offen offset:0
    buffer_load_dwordx4 v[4:7], v242, s[8:11], s48 offen offset:64
    buffer_load_dwordx4 v[8:11], v242, s[8:11], s48 offen offset:128
    buffer_load_dwordx4 v[12:15], v242, s[8:11], s48 offen offset:192
    s_waitcnt vmcnt(0)
    v_lshlrev_b32 v192, 16, v0
    v_and_b32 v193, s64, v0
    v_lshlrev_b32 v194, 16, v1
    v_and_b32 v195, s64, v1
    v_lshlrev_b32 v196, 16, v2
    v_and_b32 v197, s64, v2
    v_lshlrev_b32 v198, 16, v3
    v_and_b32 v199, s64, v3
    v_pk_mul_f32 v[192:193], v[192:193], s[60:61]
    v_pk_mul_f32 v[194:195], v[194:195], s[60:61]
    v_pk_mul_f32 v[196:197], v[196:197], s[60:61]
    v_pk_mul_f32 v[198:199], v[198:199], s[60:61]
    v_cvt_pk_bf16_f32 v0, v192, v193
    v_cvt_pk_bf16_f32 v1, v194, v195
    v_cvt_pk_bf16_f32 v2, v196, v197
    v_cvt_pk_bf16_f32 v3, v198, v199
    v_accvgpr_write_b32 a208, v0
    v_accvgpr_write_b32 a209, v1
    v_accvgpr_write_b32 a210, v2
    v_accvgpr_write_b32 a211, v3
    v_lshlrev_b32 v192, 16, v4
    v_and_b32 v193, s64, v4
    v_lshlrev_b32 v194, 16, v5
    v_and_b32 v195, s64, v5
    v_lshlrev_b32 v196, 16, v6
    v_and_b32 v197, s64, v6
    v_lshlrev_b32 v198, 16, v7
    v_and_b32 v199, s64, v7
    v_pk_mul_f32 v[192:193], v[192:193], s[60:61]
    v_pk_mul_f32 v[194:195], v[194:195], s[60:61]
    v_pk_mul_f32 v[196:197], v[196:197], s[60:61]
    v_pk_mul_f32 v[198:199], v[198:199], s[60:61]
    v_cvt_pk_bf16_f32 v4, v192, v193
    v_cvt_pk_bf16_f32 v5, v194, v195
    v_cvt_pk_bf16_f32 v6, v196, v197
    v_cvt_pk_bf16_f32 v7, v198, v199
    v_accvgpr_write_b32 a212, v4
    v_accvgpr_write_b32 a213, v5
    v_accvgpr_write_b32 a214, v6
    v_accvgpr_write_b32 a215, v7
    v_lshlrev_b32 v192, 16, v8
    v_and_b32 v193, s64, v8
    v_lshlrev_b32 v194, 16, v9
    v_and_b32 v195, s64, v9
    v_lshlrev_b32 v196, 16, v10
    v_and_b32 v197, s64, v10
    v_lshlrev_b32 v198, 16, v11
    v_and_b32 v199, s64, v11
    v_pk_mul_f32 v[192:193], v[192:193], s[60:61]
    v_pk_mul_f32 v[194:195], v[194:195], s[60:61]
    v_pk_mul_f32 v[196:197], v[196:197], s[60:61]
    v_pk_mul_f32 v[198:199], v[198:199], s[60:61]
    v_cvt_pk_bf16_f32 v8, v192, v193
    v_cvt_pk_bf16_f32 v9, v194, v195
    v_cvt_pk_bf16_f32 v10, v196, v197
    v_cvt_pk_bf16_f32 v11, v198, v199
    v_accvgpr_write_b32 a216, v8
    v_accvgpr_write_b32 a217, v9
    v_accvgpr_write_b32 a218, v10
    v_accvgpr_write_b32 a219, v11
    v_lshlrev_b32 v192, 16, v12
    v_and_b32 v193, s64, v12
    v_lshlrev_b32 v194, 16, v13
    v_and_b32 v195, s64, v13
    v_lshlrev_b32 v196, 16, v14
    v_and_b32 v197, s64, v14
    v_lshlrev_b32 v198, 16, v15
    v_and_b32 v199, s64, v15
    v_pk_mul_f32 v[192:193], v[192:193], s[60:61]
    v_pk_mul_f32 v[194:195], v[194:195], s[60:61]
    v_pk_mul_f32 v[196:197], v[196:197], s[60:61]
    v_pk_mul_f32 v[198:199], v[198:199], s[60:61]
    v_cvt_pk_bf16_f32 v12, v192, v193
    v_cvt_pk_bf16_f32 v13, v194, v195
    v_cvt_pk_bf16_f32 v14, v196, v197
    v_cvt_pk_bf16_f32 v15, v198, v199
    v_accvgpr_write_b32 a220, v12
    v_accvgpr_write_b32 a221, v13
    v_accvgpr_write_b32 a222, v14
    v_accvgpr_write_b32 a223, v15
    v_mov_b32 v200, 0xff800000
    v_mov_b32 v201, 0xff800000
    v_mov_b32 v202, 0xff800000
    v_mov_b32 v203, 0xff800000
    v_mov_b32 v204, 0xff800000
    v_mov_b32 v205, 0xff800000
    v_mov_b32 v0, 0
    v_mov_b32 v1, 0
    v_mov_b32 v2, 0
    v_mov_b32 v3, 0
    v_mov_b32 v4, 0
    v_mov_b32 v5, 0
    v_mov_b32 v6, 0
    v_mov_b32 v7, 0
    v_mov_b32 v8, 0
    v_mov_b32 v9, 0
    v_mov_b32 v10, 0
    v_mov_b32 v11, 0
    v_mov_b32 v12, 0
    v_mov_b32 v13, 0
    v_mov_b32 v14, 0
    v_mov_b32 v15, 0
    v_mov_b32 v16, 0
    v_mov_b32 v17, 0
    v_mov_b32 v18, 0
    v_mov_b32 v19, 0
    v_mov_b32 v20, 0
    v_mov_b32 v21, 0
    v_mov_b32 v22, 0
    v_mov_b32 v23, 0
    v_mov_b32 v24, 0
    v_mov_b32 v25, 0
    v_mov_b32 v26, 0
    v_mov_b32 v27, 0
    v_mov_b32 v28, 0
    v_mov_b32 v29, 0
    v_mov_b32 v30, 0
    v_mov_b32 v31, 0
    v_mov_b32 v32, 0
    v_mov_b32 v33, 0
    v_mov_b32 v34, 0
    v_mov_b32 v35, 0
    v_mov_b32 v36, 0
    v_mov_b32 v37, 0
    v_mov_b32 v38, 0
    v_mov_b32 v39, 0
    v_mov_b32 v40, 0
    v_mov_b32 v41, 0
    v_mov_b32 v42, 0
    v_mov_b32 v43, 0
    v_mov_b32 v44, 0
    v_mov_b32 v45, 0
    v_mov_b32 v46, 0
    v_mov_b32 v47, 0
    v_mov_b32 v48, 0
    v_mov_b32 v49, 0
    v_mov_b32 v50, 0
    v_mov_b32 v51, 0
    v_mov_b32 v52, 0
    v_mov_b32 v53, 0
    v_mov_b32 v54, 0
    v_mov_b32 v55, 0
    v_mov_b32 v56, 0
    v_mov_b32 v57, 0
    v_mov_b32 v58, 0
    v_mov_b32 v59, 0
    v_mov_b32 v60, 0
    v_mov_b32 v61, 0
    v_mov_b32 v62, 0
    v_mov_b32 v63, 0
    v_mov_b32 v64, 0
    v_mov_b32 v65, 0
    v_mov_b32 v66, 0
    v_mov_b32 v67, 0
    v_mov_b32 v68, 0
    v_mov_b32 v69, 0
    v_mov_b32 v70, 0
    v_mov_b32 v71, 0
    v_mov_b32 v72, 0
    v_mov_b32 v73, 0
    v_mov_b32 v74, 0
    v_mov_b32 v75, 0
    v_mov_b32 v76, 0
    v_mov_b32 v77, 0
    v_mov_b32 v78, 0
    v_mov_b32 v79, 0
    v_mov_b32 v80, 0
    v_mov_b32 v81, 0
    v_mov_b32 v82, 0
    v_mov_b32 v83, 0
    v_mov_b32 v84, 0
    v_mov_b32 v85, 0
    v_mov_b32 v86, 0
    v_mov_b32 v87, 0
    v_mov_b32 v88, 0
    v_mov_b32 v89, 0
    v_mov_b32 v90, 0
    v_mov_b32 v91, 0
    v_mov_b32 v92, 0
    v_mov_b32 v93, 0
    v_mov_b32 v94, 0
    v_mov_b32 v95, 0
    v_mov_b32 v96, 0
    v_mov_b32 v97, 0
    v_mov_b32 v98, 0
    v_mov_b32 v99, 0
    v_mov_b32 v100, 0
    v_mov_b32 v101, 0
    v_mov_b32 v102, 0
    v_mov_b32 v103, 0
    v_mov_b32 v104, 0
    v_mov_b32 v105, 0
    v_mov_b32 v106, 0
    v_mov_b32 v107, 0
    v_mov_b32 v108, 0
    v_mov_b32 v109, 0
    v_mov_b32 v110, 0
    v_mov_b32 v111, 0
    v_mov_b32 v112, 0
    v_mov_b32 v113, 0
    v_mov_b32 v114, 0
    v_mov_b32 v115, 0
    v_mov_b32 v116, 0
    v_mov_b32 v117, 0
    v_mov_b32 v118, 0
    v_mov_b32 v119, 0
    v_mov_b32 v120, 0
    v_mov_b32 v121, 0
    v_mov_b32 v122, 0
    v_mov_b32 v123, 0
    v_mov_b32 v124, 0
    v_mov_b32 v125, 0
    v_mov_b32 v126, 0
    v_mov_b32 v127, 0
    v_mov_b32 v128, 0
    v_mov_b32 v129, 0
    v_mov_b32 v130, 0
    v_mov_b32 v131, 0
    v_mov_b32 v132, 0
    v_mov_b32 v133, 0
    v_mov_b32 v134, 0
    v_mov_b32 v135, 0
    v_mov_b32 v136, 0
    v_mov_b32 v137, 0
    v_mov_b32 v138, 0
    v_mov_b32 v139, 0
    v_mov_b32 v140, 0
    v_mov_b32 v141, 0
    v_mov_b32 v142, 0
    v_mov_b32 v143, 0
    v_mov_b32 v144, 0
    v_mov_b32 v145, 0
    v_mov_b32 v146, 0
    v_mov_b32 v147, 0
    v_mov_b32 v148, 0
    v_mov_b32 v149, 0
    v_mov_b32 v150, 0
    v_mov_b32 v151, 0
    v_mov_b32 v152, 0
    v_mov_b32 v153, 0
    v_mov_b32 v154, 0
    v_mov_b32 v155, 0
    v_mov_b32 v156, 0
    v_mov_b32 v157, 0
    v_mov_b32 v158, 0
    v_mov_b32 v159, 0
    v_mov_b32 v160, 0
    v_mov_b32 v161, 0
    v_mov_b32 v162, 0
    v_mov_b32 v163, 0
    v_mov_b32 v164, 0
    v_mov_b32 v165, 0
    v_mov_b32 v166, 0
    v_mov_b32 v167, 0
    v_mov_b32 v168, 0
    v_mov_b32 v169, 0
    v_mov_b32 v170, 0
    v_mov_b32 v171, 0
    v_mov_b32 v172, 0
    v_mov_b32 v173, 0
    v_mov_b32 v174, 0
    v_mov_b32 v175, 0
    v_mov_b32 v176, 0
    v_mov_b32 v177, 0
    v_mov_b32 v178, 0
    v_mov_b32 v179, 0
    v_mov_b32 v180, 0
    v_mov_b32 v181, 0
    v_mov_b32 v182, 0
    v_mov_b32 v183, 0
    v_mov_b32 v184, 0
    v_mov_b32 v185, 0
    v_mov_b32 v186, 0
    v_mov_b32 v187, 0
    v_mov_b32 v188, 0
    v_mov_b32 v189, 0
    v_mov_b32 v190, 0
    v_mov_b32 v191, 0
    v_mov_b32 v236, 0
    v_mov_b32 v237, 0
    v_mov_b32 v238, 0
    v_mov_b32 v239, 0
    v_mov_b32 v240, 0
    v_mov_b32 v241, 0
    s_lshl_b32 s31, s28, 10
    s_mov_b32 s30, 0
    s_mov_b32 s29, 32
L_fb0:
    s_barrier
    s_add_u32 m0, s31, 0
    s_add_u32 s48, s30, 0
    buffer_load_dwordx4 v234, s[12:15], s48 offen nt lds
    s_add_u32 m0, s31, 4096
    s_add_u32 s48, s30, 4096
    buffer_load_dwordx4 v234, s[12:15], s48 offen nt lds
    s_add_u32 m0, s31, 8192
    s_add_u32 s48, s30, 8192
    buffer_load_dwordx4 v234, s[12:15], s48 offen nt lds
    s_add_u32 m0, s31, 12288
    s_add_u32 s48, s30, 12288
    buffer_load_dwordx4 v234, s[12:15], s48 offen nt lds
    s_add_u32 s30, s30, 16384
    s_waitcnt vmcnt(0)
    s_barrier
    ds_read_b128 a[0:3], v228 offset:0
    ds_read_b128 a[4:7], v228 offset:512
    ds_read_b128 a[8:11], v228 offset:2048
    ds_read_b128 a[12:15], v228 offset:2560
    ds_read_b128 a[16:19], v228 offset:4096
    ds_read_b128 a[20:23], v228 offset:4608
    ds_read_b128 a[24:27], v228 offset:6144
    ds_read_b128 a[28:31], v228 offset:6656
    s_waitcnt lgkmcnt(0)
    v_mfma_f32_16x16x32_bf16 v[192:195], a[0:3], a[128:131], v[252:255]
    v_mfma_f32_16x16x32_bf16 v[192:195], a[4:7], a[132:135], v[192:195]
    v_mfma_f32_16x16x32_bf16 v[192:195], a[8:11], a[136:139], v[192:195]
    v_mfma_f32_16x16x32_bf16 v[192:195], a[12:15], a[140:143], v[192:195]
    v_mfma_f32_16x16x32_bf16 v[196:199], a[16:19], a[128:131], v[252:255]
    v_mfma_f32_16x16x32_bf16 v[196:199], a[20:23], a[132:135], v[196:199]
    v_mfma_f32_16x16x32_bf16 v[196:199], a[24:27], a[136:139], v[196:199]
    v_mfma_f32_16x16x32_bf16 v[196:199], a[28:31], a[140:143], v[196:199]
    s_nop 7
    s_nop 3
    v_max_f32 v200, v200, v192
    v_max_f32 v200, v200, v193
    v_max_f32 v200, v200, v194
    v_max_f32 v200, v200, v195
    v_max_f32 v200, v200, v196
    v_max_f32 v200, v200, v197
    v_max_f32 v200, v200, v198
    v_max_f32 v200, v200, v199
    s_nop 3
    v_mfma_f32_16x16x32_bf16 v[192:195], a[0:3], a[144:147], v[252:255]
    v_mfma_f32_16x16x32_bf16 v[192:195], a[4:7], a[148:151], v[192:195]
    v_mfma_f32_16x16x32_bf16 v[192:195], a[8:11], a[152:155], v[192:195]
    v_mfma_f32_16x16x32_bf16 v[192:195], a[12:15], a[156:159], v[192:195]
    v_mfma_f32_16x16x32_bf16 v[196:199], a[16:19], a[144:147], v[252:255]
    v_mfma_f32_16x16x32_bf16 v[196:199], a[20:23], a[148:151], v[196:199]
    v_mfma_f32_16x16x32_bf16 v[196:199], a[24:27], a[152:155], v[196:199]
    v_mfma_f32_16x16x32_bf16 v[196:199], a[28:31], a[156:159], v[196:199]
    s_nop 7
    s_nop 3
    v_max_f32 v201, v201, v192
    v_max_f32 v201, v201, v193
    v_max_f32 v201, v201, v194
    v_max_f32 v201, v201, v195
    v_max_f32 v201, v201, v196
    v_max_f32 v201, v201, v197
    v_max_f32 v201, v201, v198
    v_max_f32 v201, v201, v199
    s_nop 3
    v_mfma_f32_16x16x32_bf16 v[192:195], a[0:3], a[160:163], v[252:255]
    v_mfma_f32_16x16x32_bf16 v[192:195], a[4:7], a[164:167], v[192:195]
    v_mfma_f32_16x16x32_bf16 v[192:195], a[8:11], a[168:171], v[192:195]
    v_mfma_f32_16x16x32_bf16 v[192:195], a[12:15], a[172:175], v[192:195]
    v_mfma_f32_16x16x32_bf16 v[196:199], a[16:19], a[160:163], v[252:255]
    v_mfma_f32_16x16x32_bf16 v[196:199], a[20:23], a[164:167], v[196:199]
    v_mfma_f32_16x16x32_bf16 v[196:199], a[24:27], a[168:171], v[196:199]
    v_mfma_f32_16x16x32_bf16 v[196:199], a[28:31], a[172:175], v[196:199]
    s_nop 7
    s_nop 3
    v_max_f32 v202, v202, v192
    v_max_f32 v202, v202, v193
    v_max_f32 v202, v202, v194
    v_max_f32 v202, v202, v195
    v_max_f32 v202, v202, v196
    v_max_f32 v202, v202, v197
    v_max_f32 v202, v202, v198
    v_max_f32 v202, v202, v199
    s_nop 3
    v_mfma_f32_16x16x32_bf16 v[192:195], a[0:3], a[176:179], v[252:255]
    v_mfma_f32_16x16x32_bf16 v[192:195], a[4:7], a[180:183], v[192:195]
    v_mfma_f32_16x16x32_bf16 v[192:195], a[8:11], a[184:187], v[192:195]
    v_mfma_f32_16x16x32_bf16 v[192:195], a[12:15], a[188:191], v[192:195]
    v_mfma_f32_16x16x32_bf16 v[196:199], a[16:19], a[176:179], v[252:255]
    v_mfma_f32_16x16x32_bf16 v[196:199], a[20:23], a[180:183], v[196:199]
    v_mfma_f32_16x16x32_bf16 v[196:199], a[24:27], a[184:187], v[196:199]
    v_mfma_f32_16x16x32_bf16 v[196:199], a[28:31], a[188:191], v[196:199]
    s_nop 7
    s_nop 3
    v_max_f32 v203, v203, v192
    v_max_f32 v203, v203, v193
    v_max_f32 v203, v203, v194
    v_max_f32 v203, v203, v195
    v_max_f32 v203, v203, v196
    v_max_f32 v203, v203, v197
    v_max_f32 v203, v203, v198
    v_max_f32 v203, v203, v199
    s_nop 3
    v_mfma_f32_16x16x32_bf16 v[192:195], a[0:3], a[192:195], v[252:255]
    v_mfma_f32_16x16x32_bf16 v[192:195], a[4:7], a[196:199], v[192:195]
    v_mfma_f32_16x16x32_bf16 v[192:195], a[8:11], a[200:203], v[192:195]
    v_mfma_f32_16x16x32_bf16 v[192:195], a[12:15], a[204:207], v[192:195]
    v_mfma_f32_16x16x32_bf16 v[196:199], a[16:19], a[192:195], v[252:255]
    v_mfma_f32_16x16x32_bf16 v[196:199], a[20:23], a[196:199], v[196:199]
    v_mfma_f32_16x16x32_bf16 v[196:199], a[24:27], a[200:203], v[196:199]
    v_mfma_f32_16x16x32_bf16 v[196:199], a[28:31], a[204:207], v[196:199]
    s_nop 7
    s_nop 3
    v_max_f32 v204, v204, v192
    v_max_f32 v204, v204, v193
    v_max_f32 v204, v204, v194
    v_max_f32 v204, v204, v195
    v_max_f32 v204, v204, v196
    v_max_f32 v204, v204, v197
    v_max_f32 v204, v204, v198
    v_max_f32 v204, v204, v199
    s_nop 3
    v_mfma_f32_16x16x32_bf16 v[192:195], a[0:3], a[208:211], v[252:255]
    v_mfma_f32_16x16x32_bf16 v[192:195], a[4:7], a[212:215], v[192:195]
    v_mfma_f32_16x16x32_bf16 v[192:195], a[8:11], a[216:219], v[192:195]
    v_mfma_f32_16x16x32_bf16 v[192:195], a[12:15], a[220:223], v[192:195]
    v_mfma_f32_16x16x32_bf16 v[196:199], a[16:19], a[208:211], v[252:255]
    v_mfma_f32_16x16x32_bf16 v[196:199], a[20:23], a[212:215], v[196:199]
    v_mfma_f32_16x16x32_bf16 v[196:199], a[24:27], a[216:219], v[196:199]
    v_mfma_f32_16x16x32_bf16 v[196:199], a[28:31], a[220:223], v[196:199]
    s_nop 7
    s_nop 3
    v_max_f32 v205, v205, v192
    v_max_f32 v205, v205, v193
    v_max_f32 v205, v205, v194
    v_max_f32 v205, v205, v195
    v_max_f32 v205, v205, v196
    v_max_f32 v205, v205, v197
    v_max_f32 v205, v205, v198
    v_max_f32 v205, v205, v199
    s_nop 3
    ds_read_b128 a[0:3], v229 offset:0
    ds_read_b128 a[4:7], v229 offset:512
    ds_read_b128 a[8:11], v229 offset:2048
    ds_read_b128 a[12:15], v229 offset:2560
    ds_read_b128 a[16:19], v229 offset:4096
    ds_read_b128 a[20:23], v229 offset:4608
    ds_read_b128 a[24:27], v229 offset:6144
    ds_read_b128 a[28:31], v229 offset:6656
    s_waitcnt lgkmcnt(0)
    v_mfma_f32_16x16x32_bf16 v[192:195], a[0:3], a[128:131], v[252:255]
    v_mfma_f32_16x16x32_bf16 v[192:195], a[4:7], a[132:135], v[192:195]
    v_mfma_f32_16x16x32_bf16 v[192:195], a[8:11], a[136:139], v[192:195]
    v_mfma_f32_16x16x32_bf16 v[192:195], a[12:15], a[140:143], v[192:195]
    v_mfma_f32_16x16x32_bf16 v[196:199], a[16:19], a[128:131], v[252:255]
    v_mfma_f32_16x16x32_bf16 v[196:199], a[20:23], a[132:135], v[196:199]
    v_mfma_f32_16x16x32_bf16 v[196:199], a[24:27], a[136:139], v[196:199]
    v_mfma_f32_16x16x32_bf16 v[196:199], a[28:31], a[140:143], v[196:199]
    s_nop 7
    s_nop 3
    v_max_f32 v200, v200, v192
    v_max_f32 v200, v200, v193
    v_max_f32 v200, v200, v194
    v_max_f32 v200, v200, v195
    v_max_f32 v200, v200, v196
    v_max_f32 v200, v200, v197
    v_max_f32 v200, v200, v198
    v_max_f32 v200, v200, v199
    s_nop 3
    v_mfma_f32_16x16x32_bf16 v[192:195], a[0:3], a[144:147], v[252:255]
    v_mfma_f32_16x16x32_bf16 v[192:195], a[4:7], a[148:151], v[192:195]
    v_mfma_f32_16x16x32_bf16 v[192:195], a[8:11], a[152:155], v[192:195]
    v_mfma_f32_16x16x32_bf16 v[192:195], a[12:15], a[156:159], v[192:195]
    v_mfma_f32_16x16x32_bf16 v[196:199], a[16:19], a[144:147], v[252:255]
    v_mfma_f32_16x16x32_bf16 v[196:199], a[20:23], a[148:151], v[196:199]
    v_mfma_f32_16x16x32_bf16 v[196:199], a[24:27], a[152:155], v[196:199]
    v_mfma_f32_16x16x32_bf16 v[196:199], a[28:31], a[156:159], v[196:199]
    s_nop 7
    s_nop 3
    v_max_f32 v201, v201, v192
    v_max_f32 v201, v201, v193
    v_max_f32 v201, v201, v194
    v_max_f32 v201, v201, v195
    v_max_f32 v201, v201, v196
    v_max_f32 v201, v201, v197
    v_max_f32 v201, v201, v198
    v_max_f32 v201, v201, v199
    s_nop 3
    v_mfma_f32_16x16x32_bf16 v[192:195], a[0:3], a[160:163], v[252:255]
    v_mfma_f32_16x16x32_bf16 v[192:195], a[4:7], a[164:167], v[192:195]
    v_mfma_f32_16x16x32_bf16 v[192:195], a[8:11], a[168:171], v[192:195]
    v_mfma_f32_16x16x32_bf16 v[192:195], a[12:15], a[172:175], v[192:195]
    v_mfma_f32_16x16x32_bf16 v[196:199], a[16:19], a[160:163], v[252:255]
    v_mfma_f32_16x16x32_bf16 v[196:199], a[20:23], a[164:167], v[196:199]
    v_mfma_f32_16x16x32_bf16 v[196:199], a[24:27], a[168:171], v[196:199]
    v_mfma_f32_16x16x32_bf16 v[196:199], a[28:31], a[172:175], v[196:199]
    s_nop 7
    s_nop 3
    v_max_f32 v202, v202, v192
    v_max_f32 v202, v202, v193
    v_max_f32 v202, v202, v194
    v_max_f32 v202, v202, v195
    v_max_f32 v202, v202, v196
    v_max_f32 v202, v202, v197
    v_max_f32 v202, v202, v198
    v_max_f32 v202, v202, v199
    s_nop 3
    v_mfma_f32_16x16x32_bf16 v[192:195], a[0:3], a[176:179], v[252:255]
    v_mfma_f32_16x16x32_bf16 v[192:195], a[4:7], a[180:183], v[192:195]
    v_mfma_f32_16x16x32_bf16 v[192:195], a[8:11], a[184:187], v[192:195]
    v_mfma_f32_16x16x32_bf16 v[192:195], a[12:15], a[188:191], v[192:195]
    v_mfma_f32_16x16x32_bf16 v[196:199], a[16:19], a[176:179], v[252:255]
    v_mfma_f32_16x16x32_bf16 v[196:199], a[20:23], a[180:183], v[196:199]
    v_mfma_f32_16x16x32_bf16 v[196:199], a[24:27], a[184:187], v[196:199]
    v_mfma_f32_16x16x32_bf16 v[196:199], a[28:31], a[188:191], v[196:199]
    s_nop 7
    s_nop 3
    v_max_f32 v203, v203, v192
    v_max_f32 v203, v203, v193
    v_max_f32 v203, v203, v194
    v_max_f32 v203, v203, v195
    v_max_f32 v203, v203, v196
    v_max_f32 v203, v203, v197
    v_max_f32 v203, v203, v198
    v_max_f32 v203, v203, v199
    s_nop 3
    v_mfma_f32_16x16x32_bf16 v[192:195], a[0:3], a[192:195], v[252:255]
    v_mfma_f32_16x16x32_bf16 v[192:195], a[4:7], a[196:199], v[192:195]
    v_mfma_f32_16x16x32_bf16 v[192:195], a[8:11], a[200:203], v[192:195]
    v_mfma_f32_16x16x32_bf16 v[192:195], a[12:15], a[204:207], v[192:195]
    v_mfma_f32_16x16x32_bf16 v[196:199], a[16:19], a[192:195], v[252:255]
    v_mfma_f32_16x16x32_bf16 v[196:199], a[20:23], a[196:199], v[196:199]
    v_mfma_f32_16x16x32_bf16 v[196:199], a[24:27], a[200:203], v[196:199]
    v_mfma_f32_16x16x32_bf16 v[196:199], a[28:31], a[204:207], v[196:199]
    s_nop 7
    s_nop 3
    v_max_f32 v204, v204, v192
    v_max_f32 v204, v204, v193
    v_max_f32 v204, v204, v194
    v_max_f32 v204, v204, v195
    v_max_f32 v204, v204, v196
    v_max_f32 v204, v204, v197
    v_max_f32 v204, v204, v198
    v_max_f32 v204, v204, v199
    s_nop 3
    v_mfma_f32_16x16x32_bf16 v[192:195], a[0:3], a[208:211], v[252:255]
    v_mfma_f32_16x16x32_bf16 v[192:195], a[4:7], a[212:215], v[192:195]
    v_mfma_f32_16x16x32_bf16 v[192:195], a[8:11], a[216:219], v[192:195]
    v_mfma_f32_16x16x32_bf16 v[192:195], a[12:15], a[220:223], v[192:195]
    v_mfma_f32_16x16x32_bf16 v[196:199], a[16:19], a[208:211], v[252:255]
    v_mfma_f32_16x16x32_bf16 v[196:199], a[20:23], a[212:215], v[196:199]
    v_mfma_f32_16x16x32_bf16 v[196:199], a[24:27], a[216:219], v[196:199]
    v_mfma_f32_16x16x32_bf16 v[196:199], a[28:31], a[220:223], v[196:199]
    s_nop 7
    s_nop 3
    v_max_f32 v205, v205, v192
    v_max_f32 v205, v205, v193
    v_max_f32 v205, v205, v194
    v_max_f32 v205, v205, v195
    v_max_f32 v205, v205, v196
    v_max_f32 v205, v205, v197
    v_max_f32 v205, v205, v198
    v_max_f32 v205, v205, v199
    s_nop 3
    s_waitcnt lgkmcnt(0)
    s_sub_u32 s29, s29, 1
    s_cmp_lg_u32 s29, 0
    s_cbranch_scc1 L_fb0
    v_mov_b32 v243, v200
    s_nop 1
    v_permlane16_swap_b32 v200, v243
    s_nop 1
    v_max_f32 v200, v200, v243
    v_mov_b32 v243, v200
    s_nop 1
    v_permlane32_swap_b32 v200, v243
    s_nop 1
    v_max_f32 v200, v200, v243
    v_mov_b32 v243, v201
    s_nop 1
    v_permlane16_swap_b32 v201, v243
    s_nop 1
    v_max_f32 v201, v201, v243
    v_mov_b32 v243, v201
    s_nop 1
    v_permlane32_swap_b32 v201, v243
    s_nop 1
    v_max_f32 v201, v201, v243
    v_mov_b32 v243, v202
    s_nop 1
    v_permlane16_swap_b32 v202, v243
    s_nop 1
    v_max_f32 v202, v202, v243
    v_mov_b32 v243, v202
    s_nop 1
    v_permlane32_swap_b32 v202, v243
    s_nop 1
    v_max_f32 v202, v202, v243
    v_mov_b32 v243, v203
    s_nop 1
    v_permlane16_swap_b32 v203, v243
    s_nop 1
    v_max_f32 v203, v203, v243
    v_mov_b32 v243, v203
    s_nop 1
    v_permlane32_swap_b32 v203, v243
    s_nop 1
    v_max_f32 v203, v203, v243
    v_mov_b32 v243, v204
    s_nop 1
    v_permlane16_swap_b32 v204, v243
    s_nop 1
    v_max_f32 v204, v204, v243
    v_mov_b32 v243, v204
    s_nop 1
    v_permlane32_swap_b32 v204, v243
    s_nop 1
    v_max_f32 v204, v204, v243
    v_mov_b32 v243, v205
    s_nop 1
    v_permlane16_swap_b32 v205, v243
    s_nop 1
    v_max_f32 v205, v205, v243
    v_mov_b32 v243, v205
    s_nop 1
    v_permlane32_swap_b32 v205, v243
    s_nop 1
    v_max_f32 v205, v205, v243
    s_lshl_b32 s31, s28, 10
    s_mov_b32 s30, 0
    s_mov_b32 s29, 32
L_fb1:
    s_barrier
    s_add_u32 m0, s31, 0
    s_add_u32 s48, s30, 0
    buffer_load_dwordx4 v234, s[12:15], s48 offen nt lds
    s_add_u32 m0, s31, 4096
    s_add_u32 s48, s30, 4096
    buffer_load_dwordx4 v234, s[12:15], s48 offen nt lds
    s_add_u32 m0, s31, 8192
    s_add_u32 s48, s30, 8192
    buffer_load_dwordx4 v234, s[12:15], s48 offen nt lds
    s_add_u32 m0, s31, 12288
    s_add_u32 s48, s30, 12288
    buffer_load_dwordx4 v234, s[12:15], s48 offen nt lds
    s_add_u32 m0, s31, 65536
    s_add_u32 s48, s30, 0
    buffer_load_dwordx4 v235, s[16:19], s48 offen nt lds
    s_add_u32 m0, s31, 69632
    s_add_u32 s48, s30, 4096
    buffer_load_dwordx4 v235, s[16:19], s48 offen nt lds
    s_add_u32 m0, s31, 73728
    s_add_u32 s48, s30, 8192
    buffer_load_dwordx4 v235, s[16:19], s48 offen nt lds
    s_add_u32 m0, s31, 77824
    s_add_u32 s48, s30, 12288
    buffer_load_dwordx4 v235, s[16:19], s48 offen nt lds
    s_add_u32 s30, s30, 16384
    s_waitcnt vmcnt(0)
    s_barrier
    ds_read_b128 a[0:3], v228 offset:0
    ds_read_b128 a[4:7], v228 offset:512
    ds_read_b128 a[8:11], v228 offset:2048
    ds_read_b128 a[12:15], v228 offset:2560
    ds_read_b128 a[16:19], v228 offset:4096
    ds_read_b128 a[20:23], v228 offset:4608
    ds_read_b128 a[24:27], v228 offset:6144
    ds_read_b128 a[28:31], v228 offset:6656
    ds_read_b64_tr_b16 a[64:65], v230 offset:0
    ds_read_b64_tr_b16 a[66:67], v230 offset:4096
    ds_read_b64_tr_b16 a[68:69], v231 offset:0
    ds_read_b64_tr_b16 a[70:71], v231 offset:4096
    ds_read_b64_tr_b16 a[72:73], v230 offset:512
    ds_read_b64_tr_b16 a[74:75], v230 offset:4608
    ds_read_b64_tr_b16 a[76:77], v231 offset:512
    ds_read_b64_tr_b16 a[78:79], v231 offset:4608
    ds_read_b64_tr_b16 a[80:81], v230 offset:1024
    ds_read_b64_tr_b16 a[82:83], v230 offset:5120
    ds_read_b64_tr_b16 a[84:85], v231 offset:1024
    ds_read_b64_tr_b16 a[86:87], v231 offset:5120
    ds_read_b64_tr_b16 a[88:89], v230 offset:1536
    ds_read_b64_tr_b16 a[90:91], v230 offset:5632
    ds_read_b64_tr_b16 a[92:93], v231 offset:1536
    ds_read_b64_tr_b16 a[94:95], v231 offset:5632
    s_waitcnt lgkmcnt(0)
    v_mfma_f32_16x16x32_bf16 v[192:195], a[0:3], a[128:131], v[252:255]
    v_mfma_f32_16x16x32_bf16 v[192:195], a[4:7], a[132:135], v[192:195]
    v_mfma_f32_16x16x32_bf16 v[192:195], a[8:11], a[136:139], v[192:195]
    v_mfma_f32_16x16x32_bf16 v[192:195], a[12:15], a[140:143], v[192:195]
    v_mfma_f32_16x16x32_bf16 v[196:199], a[16:19], a[128:131], v[252:255]
    v_mfma_f32_16x16x32_bf16 v[196:199], a[20:23], a[132:135], v[196:199]
    v_mfma_f32_16x16x32_bf16 v[196:199], a[24:27], a[136:139], v[196:199]
    v_mfma_f32_16x16x32_bf16 v[196:199], a[28:31], a[140:143], v[196:199]
    s_nop 7
    s_nop 3
    v_sub_f32 v192, v192, v200
    v_sub_f32 v193, v193, v200
    v_sub_f32 v194, v194, v200
    v_sub_f32 v195, v195, v200
    v_sub_f32 v196, v196, v200
    v_sub_f32 v197, v197, v200
    v_sub_f32 v198, v198, v200
    v_sub_f32 v199, v199, v200
    v_exp_f32 v192, v192
    v_exp_f32 v193, v193
    v_exp_f32 v194, v194
    v_exp_f32 v195, v195
    v_exp_f32 v196, v196
    v_exp_f32 v197, v197
    v_exp_f32 v198, v198
    v_exp_f32 v199, v199
    s_nop 0
    v_add_f32 v236, v236, v192
    v_add_f32 v236, v236, v193
    v_add_f32 v236, v236, v194
    v_add_f32 v236, v236, v195
    v_add_f32 v236, v236, v196
    v_add_f32 v236, v236, v197
    v_add_f32 v236, v236, v198
    v_add_f32 v236, v236, v199
    v_cvt_pk_bf16_f32 v216, v192, v193
    v_cvt_pk_bf16_f32 v217, v194, v195
    v_cvt_pk_bf16_f32 v218, v196, v197
    v_cvt_pk_bf16_f32 v219, v198, v199
    s_nop 1
    v_mfma_f32_16x16x32_bf16 v[0:3], a[64:67], v[216:219], v[0:3]
    v_mfma_f32_16x16x32_bf16 v[4:7], a[68:71], v[216:219], v[4:7]
    v_mfma_f32_16x16x32_bf16 v[8:11], a[72:75], v[216:219], v[8:11]
    v_mfma_f32_16x16x32_bf16 v[12:15], a[76:79], v[216:219], v[12:15]
    v_mfma_f32_16x16x32_bf16 v[16:19], a[80:83], v[216:219], v[16:19]
    v_mfma_f32_16x16x32_bf16 v[20:23], a[84:87], v[216:219], v[20:23]
    v_mfma_f32_16x16x32_bf16 v[24:27], a[88:91], v[216:219], v[24:27]
    v_mfma_f32_16x16x32_bf16 v[28:31], a[92:95], v[216:219], v[28:31]
    s_nop 3
    v_mfma_f32_16x16x32_bf16 v[192:195], a[0:3], a[144:147], v[252:255]
    v_mfma_f32_16x16x32_bf16 v[192:195], a[4:7], a[148:151], v[192:195]
    v_mfma_f32_16x16x32_bf16 v[192:195], a[8:11], a[152:155], v[192:195]
    v_mfma_f32_16x16x32_bf16 v[192:195], a[12:15], a[156:159], v[192:195]
    v_mfma_f32_16x16x32_bf16 v[196:199], a[16:19], a[144:147], v[252:255]
    v_mfma_f32_16x16x32_bf16 v[196:199], a[20:23], a[148:151], v[196:199]
    v_mfma_f32_16x16x32_bf16 v[196:199], a[24:27], a[152:155], v[196:199]
    v_mfma_f32_16x16x32_bf16 v[196:199], a[28:31], a[156:159], v[196:199]
    s_nop 7
    s_nop 3
    v_sub_f32 v192, v192, v201
    v_sub_f32 v193, v193, v201
    v_sub_f32 v194, v194, v201
    v_sub_f32 v195, v195, v201
    v_sub_f32 v196, v196, v201
    v_sub_f32 v197, v197, v201
    v_sub_f32 v198, v198, v201
    v_sub_f32 v199, v199, v201
    v_exp_f32 v192, v192
    v_exp_f32 v193, v193
    v_exp_f32 v194, v194
    v_exp_f32 v195, v195
    v_exp_f32 v196, v196
    v_exp_f32 v197, v197
    v_exp_f32 v198, v198
    v_exp_f32 v199, v199
    s_nop 0
    v_add_f32 v237, v237, v192
    v_add_f32 v237, v237, v193
    v_add_f32 v237, v237, v194
    v_add_f32 v237, v237, v195
    v_add_f32 v237, v237, v196
    v_add_f32 v237, v237, v197
    v_add_f32 v237, v237, v198
    v_add_f32 v237, v237, v199
    v_cvt_pk_bf16_f32 v216, v192, v193
    v_cvt_pk_bf16_f32 v217, v194, v195
    v_cvt_pk_bf16_f32 v218, v196, v197
    v_cvt_pk_bf16_f32 v219, v198, v199
    s_nop 1
    v_mfma_f32_16x16x32_bf16 v[32:35], a[64:67], v[216:219], v[32:35]
    v_mfma_f32_16x16x32_bf16 v[36:39], a[68:71], v[216:219], v[36:39]
    v_mfma_f32_16x16x32_bf16 v[40:43], a[72:75], v[216:219], v[40:43]
    v_mfma_f32_16x16x32_bf16 v[44:47], a[76:79], v[216:219], v[44:47]
    v_mfma_f32_16x16x32_bf16 v[48:51], a[80:83], v[216:219], v[48:51]
    v_mfma_f32_16x16x32_bf16 v[52:55], a[84:87], v[216:219], v[52:55]
    v_mfma_f32_16x16x32_bf16 v[56:59], a[88:91], v[216:219], v[56:59]
    v_mfma_f32_16x16x32_bf16 v[60:63], a[92:95], v[216:219], v[60:63]
    s_nop 3
    v_mfma_f32_16x16x32_bf16 v[192:195], a[0:3], a[160:163], v[252:255]
    v_mfma_f32_16x16x32_bf16 v[192:195], a[4:7], a[164:167], v[192:195]
    v_mfma_f32_16x16x32_bf16 v[192:195], a[8:11], a[168:171], v[192:195]
    v_mfma_f32_16x16x32_bf16 v[192:195], a[12:15], a[172:175], v[192:195]
    v_mfma_f32_16x16x32_bf16 v[196:199], a[16:19], a[160:163], v[252:255]
    v_mfma_f32_16x16x32_bf16 v[196:199], a[20:23], a[164:167], v[196:199]
    v_mfma_f32_16x16x32_bf16 v[196:199], a[24:27], a[168:171], v[196:199]
    v_mfma_f32_16x16x32_bf16 v[196:199], a[28:31], a[172:175], v[196:199]
    s_nop 7
    s_nop 3
    v_sub_f32 v192, v192, v202
    v_sub_f32 v193, v193, v202
    v_sub_f32 v194, v194, v202
    v_sub_f32 v195, v195, v202
    v_sub_f32 v196, v196, v202
    v_sub_f32 v197, v197, v202
    v_sub_f32 v198, v198, v202
    v_sub_f32 v199, v199, v202
    v_exp_f32 v192, v192
    v_exp_f32 v193, v193
    v_exp_f32 v194, v194
    v_exp_f32 v195, v195
    v_exp_f32 v196, v196
    v_exp_f32 v197, v197
    v_exp_f32 v198, v198
    v_exp_f32 v199, v199
    s_nop 0
    v_add_f32 v238, v238, v192
    v_add_f32 v238, v238, v193
    v_add_f32 v238, v238, v194
    v_add_f32 v238, v238, v195
    v_add_f32 v238, v238, v196
    v_add_f32 v238, v238, v197
    v_add_f32 v238, v238, v198
    v_add_f32 v238, v238, v199
    v_cvt_pk_bf16_f32 v216, v192, v193
    v_cvt_pk_bf16_f32 v217, v194, v195
    v_cvt_pk_bf16_f32 v218, v196, v197
    v_cvt_pk_bf16_f32 v219, v198, v199
    s_nop 1
    v_mfma_f32_16x16x32_bf16 v[64:67], a[64:67], v[216:219], v[64:67]
    v_mfma_f32_16x16x32_bf16 v[68:71], a[68:71], v[216:219], v[68:71]
    v_mfma_f32_16x16x32_bf16 v[72:75], a[72:75], v[216:219], v[72:75]
    v_mfma_f32_16x16x32_bf16 v[76:79], a[76:79], v[216:219], v[76:79]
    v_mfma_f32_16x16x32_bf16 v[80:83], a[80:83], v[216:219], v[80:83]
    v_mfma_f32_16x16x32_bf16 v[84:87], a[84:87], v[216:219], v[84:87]
    v_mfma_f32_16x16x32_bf16 v[88:91], a[88:91], v[216:219], v[88:91]
    v_mfma_f32_16x16x32_bf16 v[92:95], a[92:95], v[216:219], v[92:95]
    s_nop 3
    v_mfma_f32_16x16x32_bf16 v[192:195], a[0:3], a[176:179], v[252:255]
    v_mfma_f32_16x16x32_bf16 v[192:195], a[4:7], a[180:183], v[192:195]
    v_mfma_f32_16x16x32_bf16 v[192:195], a[8:11], a[184:187], v[192:195]
    v_mfma_f32_16x16x32_bf16 v[192:195], a[12:15], a[188:191], v[192:195]
    v_mfma_f32_16x16x32_bf16 v[196:199], a[16:19], a[176:179], v[252:255]
    v_mfma_f32_16x16x32_bf16 v[196:199], a[20:23], a[180:183], v[196:199]
    v_mfma_f32_16x16x32_bf16 v[196:199], a[24:27], a[184:187], v[196:199]
    v_mfma_f32_16x16x32_bf16 v[196:199], a[28:31], a[188:191], v[196:199]
    s_nop 7
    s_nop 3
    v_sub_f32 v192, v192, v203
    v_sub_f32 v193, v193, v203
    v_sub_f32 v194, v194, v203
    v_sub_f32 v195, v195, v203
    v_sub_f32 v196, v196, v203
    v_sub_f32 v197, v197, v203
    v_sub_f32 v198, v198, v203
    v_sub_f32 v199, v199, v203
    v_exp_f32 v192, v192
    v_exp_f32 v193, v193
    v_exp_f32 v194, v194
    v_exp_f32 v195, v195
    v_exp_f32 v196, v196
    v_exp_f32 v197, v197
    v_exp_f32 v198, v198
    v_exp_f32 v199, v199
    s_nop 0
    v_add_f32 v239, v239, v192
    v_add_f32 v239, v239, v193
    v_add_f32 v239, v239, v194
    v_add_f32 v239, v239, v195
    v_add_f32 v239, v239, v196
    v_add_f32 v239, v239, v197
    v_add_f32 v239, v239, v198
    v_add_f32 v239, v239, v199
    v_cvt_pk_bf16_f32 v216, v192, v193
    v_cvt_pk_bf16_f32 v217, v194, v195
    v_cvt_pk_bf16_f32 v218, v196, v197
    v_cvt_pk_bf16_f32 v219, v198, v199
    s_nop 1
    v_mfma_f32_16x16x32_bf16 v[96:99], a[64:67], v[216:219], v[96:99]
    v_mfma_f32_16x16x32_bf16 v[100:103], a[68:71], v[216:219], v[100:103]
    v_mfma_f32_16x16x32_bf16 v[104:107], a[72:75], v[216:219], v[104:107]
    v_mfma_f32_16x16x32_bf16 v[108:111], a[76:79], v[216:219], v[108:111]
    v_mfma_f32_16x16x32_bf16 v[112:115], a[80:83], v[216:219], v[112:115]
    v_mfma_f32_16x16x32_bf16 v[116:119], a[84:87], v[216:219], v[116:119]
    v_mfma_f32_16x16x32_bf16 v[120:123], a[88:91], v[216:219], v[120:123]
    v_mfma_f32_16x16x32_bf16 v[124:127], a[92:95], v[216:219], v[124:127]
    s_nop 3
    v_mfma_f32_16x16x32_bf16 v[192:195], a[0:3], a[192:195], v[252:255]
    v_mfma_f32_16x16x32_bf16 v[192:195], a[4:7], a[196:199], v[192:195]
    v_mfma_f32_16x16x32_bf16 v[192:195], a[8:11], a[200:203], v[192:195]
    v_mfma_f32_16x16x32_bf16 v[192:195], a[12:15], a[204:207], v[192:195]
    v_mfma_f32_16x16x32_bf16 v[196:199], a[16:19], a[192:195], v[252:255]
    v_mfma_f32_16x16x32_bf16 v[196:199], a[20:23], a[196:199], v[196:199]
    v_mfma_f32_16x16x32_bf16 v[196:199], a[24:27], a[200:203], v[196:199]
    v_mfma_f32_16x16x32_bf16 v[196:199], a[28:31], a[204:207], v[196:199]
    s_nop 7
    s_nop 3
    v_sub_f32 v192, v192, v204
    v_sub_f32 v193, v193, v204
    v_sub_f32 v194, v194, v204
    v_sub_f32 v195, v195, v204
    v_sub_f32 v196, v196, v204
    v_sub_f32 v197, v197, v204
    v_sub_f32 v198, v198, v204
    v_sub_f32 v199, v199, v204
    v_exp_f32 v192, v192
    v_exp_f32 v193, v193
    v_exp_f32 v194, v194
    v_exp_f32 v195, v195
    v_exp_f32 v196, v196
    v_exp_f32 v197, v197
    v_exp_f32 v198, v198
    v_exp_f32 v199, v199
    s_nop 0
    v_add_f32 v240, v240, v192
    v_add_f32 v240, v240, v193
    v_add_f32 v240, v240, v194
    v_add_f32 v240, v240, v195
    v_add_f32 v240, v240, v196
    v_add_f32 v240, v240, v197
    v_add_f32 v240, v240, v198
    v_add_f32 v240, v240, v199
    v_cvt_pk_bf16_f32 v216, v192, v193
    v_cvt_pk_bf16_f32 v217, v194, v195
    v_cvt_pk_bf16_f32 v218, v196, v197
    v_cvt_pk_bf16_f32 v219, v198, v199
    s_nop 1
    v_mfma_f32_16x16x32_bf16 v[128:131], a[64:67], v[216:219], v[128:131]
    v_mfma_f32_16x16x32_bf16 v[132:135], a[68:71], v[216:219], v[132:135]
    v_mfma_f32_16x16x32_bf16 v[136:139], a[72:75], v[216:219], v[136:139]
    v_mfma_f32_16x16x32_bf16 v[140:143], a[76:79], v[216:219], v[140:143]
    v_mfma_f32_16x16x32_bf16 v[144:147], a[80:83], v[216:219], v[144:147]
    v_mfma_f32_16x16x32_bf16 v[148:151], a[84:87], v[216:219], v[148:151]
    v_mfma_f32_16x16x32_bf16 v[152:155], a[88:91], v[216:219], v[152:155]
    v_mfma_f32_16x16x32_bf16 v[156:159], a[92:95], v[216:219], v[156:159]
    s_nop 3
    v_mfma_f32_16x16x32_bf16 v[192:195], a[0:3], a[208:211], v[252:255]
    v_mfma_f32_16x16x32_bf16 v[192:195], a[4:7], a[212:215], v[192:195]
    v_mfma_f32_16x16x32_bf16 v[192:195], a[8:11], a[216:219], v[192:195]
    v_mfma_f32_16x16x32_bf16 v[192:195], a[12:15], a[220:223], v[192:195]
    v_mfma_f32_16x16x32_bf16 v[196:199], a[16:19], a[208:211], v[252:255]
    v_mfma_f32_16x16x32_bf16 v[196:199], a[20:23], a[212:215], v[196:199]
    v_mfma_f32_16x16x32_bf16 v[196:199], a[24:27], a[216:219], v[196:199]
    v_mfma_f32_16x16x32_bf16 v[196:199], a[28:31], a[220:223], v[196:199]
    s_nop 7
    s_nop 3
    v_sub_f32 v192, v192, v205
    v_sub_f32 v193, v193, v205
    v_sub_f32 v194, v194, v205
    v_sub_f32 v195, v195, v205
    v_sub_f32 v196, v196, v205
    v_sub_f32 v197, v197, v205
    v_sub_f32 v198, v198, v205
    v_sub_f32 v199, v199, v205
    v_exp_f32 v192, v192
    v_exp_f32 v193, v193
    v_exp_f32 v194, v194
    v_exp_f32 v195, v195
    v_exp_f32 v196, v196
    v_exp_f32 v197, v197
    v_exp_f32 v198, v198
    v_exp_f32 v199, v199
    s_nop 0
    v_add_f32 v241, v241, v192
    v_add_f32 v241, v241, v193
    v_add_f32 v241, v241, v194
    v_add_f32 v241, v241, v195
    v_add_f32 v241, v241, v196
    v_add_f32 v241, v241, v197
    v_add_f32 v241, v241, v198
    v_add_f32 v241, v241, v199
    v_cvt_pk_bf16_f32 v216, v192, v193
    v_cvt_pk_bf16_f32 v217, v194, v195
    v_cvt_pk_bf16_f32 v218, v196, v197
    v_cvt_pk_bf16_f32 v219, v198, v199
    s_nop 1
    v_mfma_f32_16x16x32_bf16 v[160:163], a[64:67], v[216:219], v[160:163]
    v_mfma_f32_16x16x32_bf16 v[164:167], a[68:71], v[216:219], v[164:167]
    v_mfma_f32_16x16x32_bf16 v[168:171], a[72:75], v[216:219], v[168:171]
    v_mfma_f32_16x16x32_bf16 v[172:175], a[76:79], v[216:219], v[172:175]
    v_mfma_f32_16x16x32_bf16 v[176:179], a[80:83], v[216:219], v[176:179]
    v_mfma_f32_16x16x32_bf16 v[180:183], a[84:87], v[216:219], v[180:183]
    v_mfma_f32_16x16x32_bf16 v[184:187], a[88:91], v[216:219], v[184:187]
    v_mfma_f32_16x16x32_bf16 v[188:191], a[92:95], v[216:219], v[188:191]
    s_nop 3
    ds_read_b128 a[0:3], v229 offset:0
    ds_read_b128 a[4:7], v229 offset:512
    ds_read_b128 a[8:11], v229 offset:2048
    ds_read_b128 a[12:15], v229 offset:2560
    ds_read_b128 a[16:19], v229 offset:4096
    ds_read_b128 a[20:23], v229 offset:4608
    ds_read_b128 a[24:27], v229 offset:6144
    ds_read_b128 a[28:31], v229 offset:6656
    ds_read_b64_tr_b16 a[64:65], v232 offset:0
    ds_read_b64_tr_b16 a[66:67], v232 offset:4096
    ds_read_b64_tr_b16 a[68:69], v233 offset:0
    ds_read_b64_tr_b16 a[70:71], v233 offset:4096
    ds_read_b64_tr_b16 a[72:73], v232 offset:512
    ds_read_b64_tr_b16 a[74:75], v232 offset:4608
    ds_read_b64_tr_b16 a[76:77], v233 offset:512
    ds_read_b64_tr_b16 a[78:79], v233 offset:4608
    ds_read_b64_tr_b16 a[80:81], v232 offset:1024
    ds_read_b64_tr_b16 a[82:83], v232 offset:5120
    ds_read_b64_tr_b16 a[84:85], v233 offset:1024
    ds_read_b64_tr_b16 a[86:87], v233 offset:5120
    ds_read_b64_tr_b16 a[88:89], v232 offset:1536
    ds_read_b64_tr_b16 a[90:91], v232 offset:5632
    ds_read_b64_tr_b16 a[92:93], v233 offset:1536
    ds_read_b64_tr_b16 a[94:95], v233 offset:5632
    s_waitcnt lgkmcnt(0)
    v_mfma_f32_16x16x32_bf16 v[192:195], a[0:3], a[128:131], v[252:255]
    v_mfma_f32_16x16x32_bf16 v[192:195], a[4:7], a[132:135], v[192:195]
    v_mfma_f32_16x16x32_bf16 v[192:195], a[8:11], a[136:139], v[192:195]
    v_mfma_f32_16x16x32_bf16 v[192:195], a[12:15], a[140:143], v[192:195]
    v_mfma_f32_16x16x32_bf16 v[196:199], a[16:19], a[128:131], v[252:255]
    v_mfma_f32_16x16x32_bf16 v[196:199], a[20:23], a[132:135], v[196:199]
    v_mfma_f32_16x16x32_bf16 v[196:199], a[24:27], a[136:139], v[196:199]
    v_mfma_f32_16x16x32_bf16 v[196:199], a[28:31], a[140:143], v[196:199]
    s_nop 7
    s_nop 3
    v_sub_f32 v192, v192, v200
    v_sub_f32 v193, v193, v200
    v_sub_f32 v194, v194, v200
    v_sub_f32 v195, v195, v200
    v_sub_f32 v196, v196, v200
    v_sub_f32 v197, v197, v200
    v_sub_f32 v198, v198, v200
    v_sub_f32 v199, v199, v200
    v_exp_f32 v192, v192
    v_exp_f32 v193, v193
    v_exp_f32 v194, v194
    v_exp_f32 v195, v195
    v_exp_f32 v196, v196
    v_exp_f32 v197, v197
    v_exp_f32 v198, v198
    v_exp_f32 v199, v199
    s_nop 0
    v_add_f32 v236, v236, v192
    v_add_f32 v236, v236, v193
    v_add_f32 v236, v236, v194
    v_add_f32 v236, v236, v195
    v_add_f32 v236, v236, v196
    v_add_f32 v236, v236, v197
    v_add_f32 v236, v236, v198
    v_add_f32 v236, v236, v199
    v_cvt_pk_bf16_f32 v216, v192, v193
    v_cvt_pk_bf16_f32 v217, v194, v195
    v_cvt_pk_bf16_f32 v218, v196, v197
    v_cvt_pk_bf16_f32 v219, v198, v199
    s_nop 1
    v_mfma_f32_16x16x32_bf16 v[0:3], a[64:67], v[216:219], v[0:3]
    v_mfma_f32_16x16x32_bf16 v[4:7], a[68:71], v[216:219], v[4:7]
    v_mfma_f32_16x16x32_bf16 v[8:11], a[72:75], v[216:219], v[8:11]
    v_mfma_f32_16x16x32_bf16 v[12:15], a[76:79], v[216:219], v[12:15]
    v_mfma_f32_16x16x32_bf16 v[16:19], a[80:83], v[216:219], v[16:19]
    v_mfma_f32_16x16x32_bf16 v[20:23], a[84:87], v[216:219], v[20:23]
    v_mfma_f32_16x16x32_bf16 v[24:27], a[88:91], v[216:219], v[24:27]
    v_mfma_f32_16x16x32_bf16 v[28:31], a[92:95], v[216:219], v[28:31]
    s_nop 3
    v_mfma_f32_16x16x32_bf16 v[192:195], a[0:3], a[144:147], v[252:255]
    v_mfma_f32_16x16x32_bf16 v[192:195], a[4:7], a[148:151], v[192:195]
    v_mfma_f32_16x16x32_bf16 v[192:195], a[8:11], a[152:155], v[192:195]
    v_mfma_f32_16x16x32_bf16 v[192:195], a[12:15], a[156:159], v[192:195]
    v_mfma_f32_16x16x32_bf16 v[196:199], a[16:19], a[144:147], v[252:255]
    v_mfma_f32_16x16x32_bf16 v[196:199], a[20:23], a[148:151], v[196:199]
    v_mfma_f32_16x16x32_bf16 v[196:199], a[24:27], a[152:155], v[196:199]
    v_mfma_f32_16x16x32_bf16 v[196:199], a[28:31], a[156:159], v[196:199]
    s_nop 7
    s_nop 3
    v_sub_f32 v192, v192, v201
    v_sub_f32 v193, v193, v201
    v_sub_f32 v194, v194, v201
    v_sub_f32 v195, v195, v201
    v_sub_f32 v196, v196, v201
    v_sub_f32 v197, v197, v201
    v_sub_f32 v198, v198, v201
    v_sub_f32 v199, v199, v201
    v_exp_f32 v192, v192
    v_exp_f32 v193, v193
    v_exp_f32 v194, v194
    v_exp_f32 v195, v195
    v_exp_f32 v196, v196
    v_exp_f32 v197, v197
    v_exp_f32 v198, v198
    v_exp_f32 v199, v199
    s_nop 0
    v_add_f32 v237, v237, v192
    v_add_f32 v237, v237, v193
    v_add_f32 v237, v237, v194
    v_add_f32 v237, v237, v195
    v_add_f32 v237, v237, v196
    v_add_f32 v237, v237, v197
    v_add_f32 v237, v237, v198
    v_add_f32 v237, v237, v199
    v_cvt_pk_bf16_f32 v216, v192, v193
    v_cvt_pk_bf16_f32 v217, v194, v195
    v_cvt_pk_bf16_f32 v218, v196, v197
    v_cvt_pk_bf16_f32 v219, v198, v199
    s_nop 1
    v_mfma_f32_16x16x32_bf16 v[32:35], a[64:67], v[216:219], v[32:35]
    v_mfma_f32_16x16x32_bf16 v[36:39], a[68:71], v[216:219], v[36:39]
    v_mfma_f32_16x16x32_bf16 v[40:43], a[72:75], v[216:219], v[40:43]
    v_mfma_f32_16x16x32_bf16 v[44:47], a[76:79], v[216:219], v[44:47]
    v_mfma_f32_16x16x32_bf16 v[48:51], a[80:83], v[216:219], v[48:51]
    v_mfma_f32_16x16x32_bf16 v[52:55], a[84:87], v[216:219], v[52:55]
    v_mfma_f32_16x16x32_bf16 v[56:59], a[88:91], v[216:219], v[56:59]
    v_mfma_f32_16x16x32_bf16 v[60:63], a[92:95], v[216:219], v[60:63]
    s_nop 3
    v_mfma_f32_16x16x32_bf16 v[192:195], a[0:3], a[160:163], v[252:255]
    v_mfma_f32_16x16x32_bf16 v[192:195], a[4:7], a[164:167], v[192:195]
    v_mfma_f32_16x16x32_bf16 v[192:195], a[8:11], a[168:171], v[192:195]
    v_mfma_f32_16x16x32_bf16 v[192:195], a[12:15], a[172:175], v[192:195]
    v_mfma_f32_16x16x32_bf16 v[196:199], a[16:19], a[160:163], v[252:255]
    v_mfma_f32_16x16x32_bf16 v[196:199], a[20:23], a[164:167], v[196:199]
    v_mfma_f32_16x16x32_bf16 v[196:199], a[24:27], a[168:171], v[196:199]
    v_mfma_f32_16x16x32_bf16 v[196:199], a[28:31], a[172:175], v[196:199]
    s_nop 7
    s_nop 3
    v_sub_f32 v192, v192, v202
    v_sub_f32 v193, v193, v202
    v_sub_f32 v194, v194, v202
    v_sub_f32 v195, v195, v202
    v_sub_f32 v196, v196, v202
    v_sub_f32 v197, v197, v202
    v_sub_f32 v198, v198, v202
    v_sub_f32 v199, v199, v202
    v_exp_f32 v192, v192
    v_exp_f32 v193, v193
    v_exp_f32 v194, v194
    v_exp_f32 v195, v195
    v_exp_f32 v196, v196
    v_exp_f32 v197, v197
    v_exp_f32 v198, v198
    v_exp_f32 v199, v199
    s_nop 0
    v_add_f32 v238, v238, v192
    v_add_f32 v238, v238, v193
    v_add_f32 v238, v238, v194
    v_add_f32 v238, v238, v195
    v_add_f32 v238, v238, v196
    v_add_f32 v238, v238, v197
    v_add_f32 v238, v238, v198
    v_add_f32 v238, v238, v199
    v_cvt_pk_bf16_f32 v216, v192, v193
    v_cvt_pk_bf16_f32 v217, v194, v195
    v_cvt_pk_bf16_f32 v218, v196, v197
    v_cvt_pk_bf16_f32 v219, v198, v199
    s_nop 1
    v_mfma_f32_16x16x32_bf16 v[64:67], a[64:67], v[216:219], v[64:67]
    v_mfma_f32_16x16x32_bf16 v[68:71], a[68:71], v[216:219], v[68:71]
    v_mfma_f32_16x16x32_bf16 v[72:75], a[72:75], v[216:219], v[72:75]
    v_mfma_f32_16x16x32_bf16 v[76:79], a[76:79], v[216:219], v[76:79]
    v_mfma_f32_16x16x32_bf16 v[80:83], a[80:83], v[216:219], v[80:83]
    v_mfma_f32_16x16x32_bf16 v[84:87], a[84:87], v[216:219], v[84:87]
    v_mfma_f32_16x16x32_bf16 v[88:91], a[88:91], v[216:219], v[88:91]
    v_mfma_f32_16x16x32_bf16 v[92:95], a[92:95], v[216:219], v[92:95]
    s_nop 3
    v_mfma_f32_16x16x32_bf16 v[192:195], a[0:3], a[176:179], v[252:255]
    v_mfma_f32_16x16x32_bf16 v[192:195], a[4:7], a[180:183], v[192:195]
    v_mfma_f32_16x16x32_bf16 v[192:195], a[8:11], a[184:187], v[192:195]
    v_mfma_f32_16x16x32_bf16 v[192:195], a[12:15], a[188:191], v[192:195]
    v_mfma_f32_16x16x32_bf16 v[196:199], a[16:19], a[176:179], v[252:255]
    v_mfma_f32_16x16x32_bf16 v[196:199], a[20:23], a[180:183], v[196:199]
    v_mfma_f32_16x16x32_bf16 v[196:199], a[24:27], a[184:187], v[196:199]
    v_mfma_f32_16x16x32_bf16 v[196:199], a[28:31], a[188:191], v[196:199]
    s_nop 7
    s_nop 3
    v_sub_f32 v192, v192, v203
    v_sub_f32 v193, v193, v203
    v_sub_f32 v194, v194, v203
    v_sub_f32 v195, v195, v203
    v_sub_f32 v196, v196, v203
    v_sub_f32 v197, v197, v203
    v_sub_f32 v198, v198, v203
    v_sub_f32 v199, v199, v203
    v_exp_f32 v192, v192
    v_exp_f32 v193, v193
    v_exp_f32 v194, v194
    v_exp_f32 v195, v195
    v_exp_f32 v196, v196
    v_exp_f32 v197, v197
    v_exp_f32 v198, v198
    v_exp_f32 v199, v199
    s_nop 0
    v_add_f32 v239, v239, v192
    v_add_f32 v239, v239, v193
    v_add_f32 v239, v239, v194
    v_add_f32 v239, v239, v195
    v_add_f32 v239, v239, v196
    v_add_f32 v239, v239, v197
    v_add_f32 v239, v239, v198
    v_add_f32 v239, v239, v199
    v_cvt_pk_bf16_f32 v216, v192, v193
    v_cvt_pk_bf16_f32 v217, v194, v195
    v_cvt_pk_bf16_f32 v218, v196, v197
    v_cvt_pk_bf16_f32 v219, v198, v199
    s_nop 1
    v_mfma_f32_16x16x32_bf16 v[96:99], a[64:67], v[216:219], v[96:99]
    v_mfma_f32_16x16x32_bf16 v[100:103], a[68:71], v[216:219], v[100:103]
    v_mfma_f32_16x16x32_bf16 v[104:107], a[72:75], v[216:219], v[104:107]
    v_mfma_f32_16x16x32_bf16 v[108:111], a[76:79], v[216:219], v[108:111]
    v_mfma_f32_16x16x32_bf16 v[112:115], a[80:83], v[216:219], v[112:115]
    v_mfma_f32_16x16x32_bf16 v[116:119], a[84:87], v[216:219], v[116:119]
    v_mfma_f32_16x16x32_bf16 v[120:123], a[88:91], v[216:219], v[120:123]
    v_mfma_f32_16x16x32_bf16 v[124:127], a[92:95], v[216:219], v[124:127]
    s_nop 3
    v_mfma_f32_16x16x32_bf16 v[192:195], a[0:3], a[192:195], v[252:255]
    v_mfma_f32_16x16x32_bf16 v[192:195], a[4:7], a[196:199], v[192:195]
    v_mfma_f32_16x16x32_bf16 v[192:195], a[8:11], a[200:203], v[192:195]
    v_mfma_f32_16x16x32_bf16 v[192:195], a[12:15], a[204:207], v[192:195]
    v_mfma_f32_16x16x32_bf16 v[196:199], a[16:19], a[192:195], v[252:255]
    v_mfma_f32_16x16x32_bf16 v[196:199], a[20:23], a[196:199], v[196:199]
    v_mfma_f32_16x16x32_bf16 v[196:199], a[24:27], a[200:203], v[196:199]
    v_mfma_f32_16x16x32_bf16 v[196:199], a[28:31], a[204:207], v[196:199]
    s_nop 7
    s_nop 3
    v_sub_f32 v192, v192, v204
    v_sub_f32 v193, v193, v204
    v_sub_f32 v194, v194, v204
    v_sub_f32 v195, v195, v204
    v_sub_f32 v196, v196, v204
    v_sub_f32 v197, v197, v204
    v_sub_f32 v198, v198, v204
    v_sub_f32 v199, v199, v204
    v_exp_f32 v192, v192
    v_exp_f32 v193, v193
    v_exp_f32 v194, v194
    v_exp_f32 v195, v195
    v_exp_f32 v196, v196
    v_exp_f32 v197, v197
    v_exp_f32 v198, v198
    v_exp_f32 v199, v199
    s_nop 0
    v_add_f32 v240, v240, v192
    v_add_f32 v240, v240, v193
    v_add_f32 v240, v240, v194
    v_add_f32 v240, v240, v195
    v_add_f32 v240, v240, v196
    v_add_f32 v240, v240, v197
    v_add_f32 v240, v240, v198
    v_add_f32 v240, v240, v199
    v_cvt_pk_bf16_f32 v216, v192, v193
    v_cvt_pk_bf16_f32 v217, v194, v195
    v_cvt_pk_bf16_f32 v218, v196, v197
    v_cvt_pk_bf16_f32 v219, v198, v199
    s_nop 1
    v_mfma_f32_16x16x32_bf16 v[128:131], a[64:67], v[216:219], v[128:131]
    v_mfma_f32_16x16x32_bf16 v[132:135], a[68:71], v[216:219], v[132:135]
    v_mfma_f32_16x16x32_bf16 v[136:139], a[72:75], v[216:219], v[136:139]
    v_mfma_f32_16x16x32_bf16 v[140:143], a[76:79], v[216:219], v[140:143]
    v_mfma_f32_16x16x32_bf16 v[144:147], a[80:83], v[216:219], v[144:147]
    v_mfma_f32_16x16x32_bf16 v[148:151], a[84:87], v[216:219], v[148:151]
    v_mfma_f32_16x16x32_bf16 v[152:155], a[88:91], v[216:219], v[152:155]
    v_mfma_f32_16x16x32_bf16 v[156:159], a[92:95], v[216:219], v[156:159]
    s_nop 3
    v_mfma_f32_16x16x32_bf16 v[192:195], a[0:3], a[208:211], v[252:255]
    v_mfma_f32_16x16x32_bf16 v[192:195], a[4:7], a[212:215], v[192:195]
    v_mfma_f32_16x16x32_bf16 v[192:195], a[8:11], a[216:219], v[192:195]
    v_mfma_f32_16x16x32_bf16 v[192:195], a[12:15], a[220:223], v[192:195]
    v_mfma_f32_16x16x32_bf16 v[196:199], a[16:19], a[208:211], v[252:255]
    v_mfma_f32_16x16x32_bf16 v[196:199], a[20:23], a[212:215], v[196:199]
    v_mfma_f32_16x16x32_bf16 v[196:199], a[24:27], a[216:219], v[196:199]
    v_mfma_f32_16x16x32_bf16 v[196:199], a[28:31], a[220:223], v[196:199]
    s_nop 7
    s_nop 3
    v_sub_f32 v192, v192, v205
    v_sub_f32 v193, v193, v205
    v_sub_f32 v194, v194, v205
    v_sub_f32 v195, v195, v205
    v_sub_f32 v196, v196, v205
    v_sub_f32 v197, v197, v205
    v_sub_f32 v198, v198, v205
    v_sub_f32 v199, v199, v205
    v_exp_f32 v192, v192
    v_exp_f32 v193, v193
    v_exp_f32 v194, v194
    v_exp_f32 v195, v195
    v_exp_f32 v196, v196
    v_exp_f32 v197, v197
    v_exp_f32 v198, v198
    v_exp_f32 v199, v199
    s_nop 0
    v_add_f32 v241, v241, v192
    v_add_f32 v241, v241, v193
    v_add_f32 v241, v241, v194
    v_add_f32 v241, v241, v195
    v_add_f32 v241, v241, v196
    v_add_f32 v241, v241, v197
    v_add_f32 v241, v241, v198
    v_add_f32 v241, v241, v199
    v_cvt_pk_bf16_f32 v216, v192, v193
    v_cvt_pk_bf16_f32 v217, v194, v195
    v_cvt_pk_bf16_f32 v218, v196, v197
    v_cvt_pk_bf16_f32 v219, v198, v199
    s_nop 1
    v_mfma_f32_16x16x32_bf16 v[160:163], a[64:67], v[216:219], v[160:163]
    v_mfma_f32_16x16x32_bf16 v[164:167], a[68:71], v[216:219], v[164:167]
    v_mfma_f32_16x16x32_bf16 v[168:171], a[72:75], v[216:219], v[168:171]
    v_mfma_f32_16x16x32_bf16 v[172:175], a[76:79], v[216:219], v[172:175]
    v_mfma_f32_16x16x32_bf16 v[176:179], a[80:83], v[216:219], v[176:179]
    v_mfma_f32_16x16x32_bf16 v[180:183], a[84:87], v[216:219], v[180:183]
    v_mfma_f32_16x16x32_bf16 v[184:187], a[88:91], v[216:219], v[184:187]
    v_mfma_f32_16x16x32_bf16 v[188:191], a[92:95], v[216:219], v[188:191]
    s_nop 3
    s_waitcnt lgkmcnt(0)
    s_sub_u32 s29, s29, 1
    s_cmp_lg_u32 s29, 0
    s_cbranch_scc1 L_fb1
    s_nop 7
    s_nop 7
    s_barrier
    v_mov_b32 v243, v236
    s_nop 1
    v_permlane16_swap_b32 v236, v243
    s_nop 1
    v_add_f32 v236, v236, v243
    v_mov_b32 v243, v236
    s_nop 1
    v_permlane32_swap_b32 v236, v243
    s_nop 1
    v_add_f32 v236, v236, v243
    v_mov_b32 v243, v237
    s_nop 1
    v_permlane16_swap_b32 v237, v243
    s_nop 1
    v_add_f32 v237, v237, v243
    v_mov_b32 v243, v237
    s_nop 1
    v_permlane32_swap_b32 v237, v243
    s_nop 1
    v_add_f32 v237, v237, v243
    v_mov_b32 v243, v238
    s_nop 1
    v_permlane16_swap_b32 v238, v243
    s_nop 1
    v_add_f32 v238, v238, v243
    v_mov_b32 v243, v238
    s_nop 1
    v_permlane32_swap_b32 v238, v243
    s_nop 1
    v_add_f32 v238, v238, v243
    v_mov_b32 v243, v239
    s_nop 1
    v_permlane16_swap_b32 v239, v243
    s_nop 1
    v_add_f32 v239, v239, v243
    v_mov_b32 v243, v239
    s_nop 1
    v_permlane32_swap_b32 v239, v243
    s_nop 1
    v_add_f32 v239, v239, v243
    v_mov_b32 v243, v240
    s_nop 1
    v_permlane16_swap_b32 v240, v243
    s_nop 1
    v_add_f32 v240, v240, v243
    v_mov_b32 v243, v240
    s_nop 1
    v_permlane32_swap_b32 v240, v243
    s_nop 1
    v_add_f32 v240, v240, v243
    v_mov_b32 v243, v241
    s_nop 1
    v_permlane16_swap_b32 v241, v243
    s_nop 1
    v_add_f32 v241, v241, v243
    v_mov_b32 v243, v241
    s_nop 1
    v_permlane32_swap_b32 v241, v243
    s_nop 1
    v_add_f32 v241, v241, v243
    v_accvgpr_read_b32 v228, a248
    v_accvgpr_read_b32 v230, a249
    v_accvgpr_read_b32 v231, a250
    v_accvgpr_read_b32 v242, a251
    s_lshl_b32 s33, s28, 10
    v_add_u32 v229, s33, v242
    v_add_u32 v245, 131072, v229
    s_mov_b32 s41, 81920
    v_rcp_f32 v236, v236
    s_nop 0
    v_pk_mul_f32 v[0:1], v[0:1], v[236:237] op_sel:[0,0] op_sel_hi:[1,0]
    v_pk_mul_f32 v[2:3], v[2:3], v[236:237] op_sel:[0,0] op_sel_hi:[1,0]
    v_pk_mul_f32 v[4:5], v[4:5], v[236:237] op_sel:[0,0] op_sel_hi:[1,0]
    v_pk_mul_f32 v[6:7], v[6:7], v[236:237] op_sel:[0,0] op_sel_hi:[1,0]
    v_cvt_pk_bf16_f32 v0, v0, v1
    v_cvt_pk_bf16_f32 v1, v2, v3
    v_cvt_pk_bf16_f32 v4, v4, v5
    v_cvt_pk_bf16_f32 v5, v6, v7
    ds_write2_b64 v228, v[0:1], v[4:5] offset0:0 offset1:4
    v_pk_mul_f32 v[8:9], v[8:9], v[236:237] op_sel:[0,0] op_sel_hi:[1,0]
    v_pk_mul_f32 v[10:11], v[10:11], v[236:237] op_sel:[0,0] op_sel_hi:[1,0]
    v_pk_mul_f32 v[12:13], v[12:13], v[236:237] op_sel:[0,0] op_sel_hi:[1,0]
    v_pk_mul_f32 v[14:15], v[14:15], v[236:237] op_sel:[0,0] op_sel_hi:[1,0]
    v_cvt_pk_bf16_f32 v8, v8, v9
    v_cvt_pk_bf16_f32 v9, v10, v11
    v_cvt_pk_bf16_f32 v12, v12, v13
    v_cvt_pk_bf16_f32 v13, v14, v15
    ds_write2_b64 v228, v[8:9], v[12:13] offset0:8 offset1:12
    ds_read_b128 v[0:3], v230 offset:0
    ds_read_b128 v[4:7], v230 offset:2176
    s_waitcnt lgkmcnt(1)
    buffer_store_dwordx4 v[0:3], v231, s[20:23], s36 offen offset:0 nt
    s_waitcnt lgkmcnt(0)
    buffer_store_dwordx4 v[4:7], v231, s[20:23], s36 offen offset:2048 nt
    v_pk_mul_f32 v[16:17], v[16:17], v[236:237] op_sel:[0,0] op_sel_hi:[1,0]
    v_pk_mul_f32 v[18:19], v[18:19], v[236:237] op_sel:[0,0] op_sel_hi:[1,0]
    v_pk_mul_f32 v[20:21], v[20:21], v[236:237] op_sel:[0,0] op_sel_hi:[1,0]
    v_pk_mul_f32 v[22:23], v[22:23], v[236:237] op_sel:[0,0] op_sel_hi:[1,0]
    v_cvt_pk_bf16_f32 v16, v16, v17
    v_cvt_pk_bf16_f32 v17, v18, v19
    v_cvt_pk_bf16_f32 v20, v20, v21
    v_cvt_pk_bf16_f32 v21, v22, v23
    ds_write2_b64 v228, v[16:17], v[20:21] offset0:16 offset1:20
    v_pk_mul_f32 v[24:25], v[24:25], v[236:237] op_sel:[0,0] op_sel_hi:[1,0]
    v_pk_mul_f32 v[26:27], v[26:27], v[236:237] op_sel:[0,0] op_sel_hi:[1,0]
    v_pk_mul_f32 v[28:29], v[28:29], v[236:237] op_sel:[0,0] op_sel_hi:[1,0]
    v_pk_mul_f32 v[30:31], v[30:31], v[236:237] op_sel:[0,0] op_sel_hi:[1,0]
    v_cvt_pk_bf16_f32 v24, v24, v25
    v_cvt_pk_bf16_f32 v25, v26, v27
    v_cvt_pk_bf16_f32 v28, v28, v29
    v_cvt_pk_bf16_f32 v29, v30, v31
    ds_write2_b64 v228, v[24:25], v[28:29] offset0:24 offset1:28
    ds_read_b128 v[16:19], v230 offset:128
    ds_read_b128 v[20:23], v230 offset:2304
    s_waitcnt lgkmcnt(1)
    buffer_store_dwordx4 v[16:19], v231, s[20:23], s36 offen offset:128 nt
    s_waitcnt lgkmcnt(0)
    buffer_store_dwordx4 v[20:23], v231, s[20:23], s36 offen offset:2176 nt
    v_rcp_f32 v237, v237
    s_nop 0
    v_pk_mul_f32 v[32:33], v[32:33], v[236:237] op_sel:[0,1] op_sel_hi:[1,1]
    v_pk_mul_f32 v[34:35], v[34:35], v[236:237] op_sel:[0,1] op_sel_hi:[1,1]
    v_pk_mul_f32 v[36:37], v[36:37], v[236:237] op_sel:[0,1] op_sel_hi:[1,1]
    v_pk_mul_f32 v[38:39], v[38:39], v[236:237] op_sel:[0,1] op_sel_hi:[1,1]
    v_cvt_pk_bf16_f32 v32, v32, v33
    v_cvt_pk_bf16_f32 v33, v34, v35
    v_cvt_pk_bf16_f32 v36, v36, v37
    v_cvt_pk_bf16_f32 v37, v38, v39
    ds_write2_b64 v228, v[32:33], v[36:37] offset0:0 offset1:4
    v_pk_mul_f32 v[40:41], v[40:41], v[236:237] op_sel:[0,1] op_sel_hi:[1,1]
    v_pk_mul_f32 v[42:43], v[42:43], v[236:237] op_sel:[0,1] op_sel_hi:[1,1]
    v_pk_mul_f32 v[44:45], v[44:45], v[236:237] op_sel:[0,1] op_sel_hi:[1,1]
    v_pk_mul_f32 v[46:47], v[46:47], v[236:237] op_sel:[0,1] op_sel_hi:[1,1]
    v_cvt_pk_bf16_f32 v40, v40, v41
    v_cvt_pk_bf16_f32 v41, v42, v43
    v_cvt_pk_bf16_f32 v44, v44, v45
    v_cvt_pk_bf16_f32 v45, v46, v47
    ds_write2_b64 v228, v[40:41], v[44:45] offset0:8 offset1:12
    ds_read_b128 v[32:35], v230 offset:0
    ds_read_b128 v[36:39], v230 offset:2176
    s_waitcnt lgkmcnt(1)
    buffer_store_dwordx4 v[32:35], v231, s[20:23], s37 offen offset:0 nt
    s_waitcnt lgkmcnt(0)
    buffer_store_dwordx4 v[36:39], v231, s[20:23], s37 offen offset:2048 nt
    v_pk_mul_f32 v[48:49], v[48:49], v[236:237] op_sel:[0,1] op_sel_hi:[1,1]
    v_pk_mul_f32 v[50:51], v[50:51], v[236:237] op_sel:[0,1] op_sel_hi:[1,1]
    v_pk_mul_f32 v[52:53], v[52:53], v[236:237] op_sel:[0,1] op_sel_hi:[1,1]
    v_pk_mul_f32 v[54:55], v[54:55], v[236:237] op_sel:[0,1] op_sel_hi:[1,1]
    v_cvt_pk_bf16_f32 v48, v48, v49
    v_cvt_pk_bf16_f32 v49, v50, v51
    v_cvt_pk_bf16_f32 v52, v52, v53
    v_cvt_pk_bf16_f32 v53, v54, v55
    ds_write2_b64 v228, v[48:49], v[52:53] offset0:16 offset1:20
    v_pk_mul_f32 v[56:57], v[56:57], v[236:237] op_sel:[0,1] op_sel_hi:[1,1]
    v_pk_mul_f32 v[58:59], v[58:59], v[236:237] op_sel:[0,1] op_sel_hi:[1,1]
    v_pk_mul_f32 v[60:61], v[60:61], v[236:237] op_sel:[0,1] op_sel_hi:[1,1]
    v_pk_mul_f32 v[62:63], v[62:63], v[236:237] op_sel:[0,1] op_sel_hi:[1,1]
    v_cvt_pk_bf16_f32 v56, v56, v57
    v_cvt_pk_bf16_f32 v57, v58, v59
    v_cvt_pk_bf16_f32 v60, v60, v61
    v_cvt_pk_bf16_f32 v61, v62, v63
    ds_write2_b64 v228, v[56:57], v[60:61] offset0:24 offset1:28
    ds_read_b128 v[48:51], v230 offset:128
    ds_read_b128 v[52:55], v230 offset:2304
    s_waitcnt lgkmcnt(1)
    buffer_store_dwordx4 v[48:51], v231, s[20:23], s37 offen offset:128 nt
    s_waitcnt lgkmcnt(0)
    buffer_store_dwordx4 v[52:55], v231, s[20:23], s37 offen offset:2176 nt
    v_rcp_f32 v238, v238
    s_nop 0
    v_pk_mul_f32 v[64:65], v[64:65], v[238:239] op_sel:[0,0] op_sel_hi:[1,0]
    v_pk_mul_f32 v[66:67], v[66:67], v[238:239] op_sel:[0,0] op_sel_hi:[1,0]
    v_pk_mul_f32 v[68:69], v[68:69], v[238:239] op_sel:[0,0] op_sel_hi:[1,0]
    v_pk_mul_f32 v[70:71], v[70:71], v[238:239] op_sel:[0,0] op_sel_hi:[1,0]
    v_cvt_pk_bf16_f32 v64, v64, v65
    v_cvt_pk_bf16_f32 v65, v66, v67
    v_cvt_pk_bf16_f32 v68, v68, v69
    v_cvt_pk_bf16_f32 v69, v70, v71
    ds_write2_b64 v228, v[64:65], v[68:69] offset0:0 offset1:4
    v_pk_mul_f32 v[72:73], v[72:73], v[238:239] op_sel:[0,0] op_sel_hi:[1,0]
    v_pk_mul_f32 v[74:75], v[74:75], v[238:239] op_sel:[0,0] op_sel_hi:[1,0]
    v_pk_mul_f32 v[76:77], v[76:77], v[238:239] op_sel:[0,0] op_sel_hi:[1,0]
    v_pk_mul_f32 v[78:79], v[78:79], v[238:239] op_sel:[0,0] op_sel_hi:[1,0]
    v_cvt_pk_bf16_f32 v72, v72, v73
    v_cvt_pk_bf16_f32 v73, v74, v75
    v_cvt_pk_bf16_f32 v76, v76, v77
    v_cvt_pk_bf16_f32 v77, v78, v79
    ds_write2_b64 v228, v[72:73], v[76:77] offset0:8 offset1:12
    ds_read_b128 v[64:67], v230 offset:0
    ds_read_b128 v[68:71], v230 offset:2176
    s_waitcnt lgkmcnt(1)
    buffer_store_dwordx4 v[64:67], v231, s[20:23], s38 offen offset:0 nt
    s_waitcnt lgkmcnt(0)
    buffer_store_dwordx4 v[68:71], v231, s[20:23], s38 offen offset:2048 nt
    v_pk_mul_f32 v[80:81], v[80:81], v[238:239] op_sel:[0,0] op_sel_hi:[1,0]
    v_pk_mul_f32 v[82:83], v[82:83], v[238:239] op_sel:[0,0] op_sel_hi:[1,0]
    v_pk_mul_f32 v[84:85], v[84:85], v[238:239] op_sel:[0,0] op_sel_hi:[1,0]
    v_pk_mul_f32 v[86:87], v[86:87], v[238:239] op_sel:[0,0] op_sel_hi:[1,0]
    v_cvt_pk_bf16_f32 v80, v80, v81
    v_cvt_pk_bf16_f32 v81, v82, v83
    v_cvt_pk_bf16_f32 v84, v84, v85
    v_cvt_pk_bf16_f32 v85, v86, v87
    ds_write2_b64 v228, v[80:81], v[84:85] offset0:16 offset1:20
    v_pk_mul_f32 v[88:89], v[88:89], v[238:239] op_sel:[0,0] op_sel_hi:[1,0]
    v_pk_mul_f32 v[90:91], v[90:91], v[238:239] op_sel:[0,0] op_sel_hi:[1,0]
    v_pk_mul_f32 v[92:93], v[92:93], v[238:239] op_sel:[0,0] op_sel_hi:[1,0]
    v_pk_mul_f32 v[94:95], v[94:95], v[238:239] op_sel:[0,0] op_sel_hi:[1,0]
    v_cvt_pk_bf16_f32 v88, v88, v89
    v_cvt_pk_bf16_f32 v89, v90, v91
    v_cvt_pk_bf16_f32 v92, v92, v93
    v_cvt_pk_bf16_f32 v93, v94, v95
    ds_write2_b64 v228, v[88:89], v[92:93] offset0:24 offset1:28
    ds_read_b128 v[80:83], v230 offset:128
    ds_read_b128 v[84:87], v230 offset:2304
    s_waitcnt lgkmcnt(1)
    buffer_store_dwordx4 v[80:83], v231, s[20:23], s38 offen offset:128 nt
    s_waitcnt lgkmcnt(0)
    buffer_store_dwordx4 v[84:87], v231, s[20:23], s38 offen offset:2176 nt
    v_rcp_f32 v239, v239
    s_nop 0
    v_pk_mul_f32 v[96:97], v[96:97], v[238:239] op_sel:[0,1] op_sel_hi:[1,1]
    v_pk_mul_f32 v[98:99], v[98:99], v[238:239] op_sel:[0,1] op_sel_hi:[1,1]
    v_pk_mul_f32 v[100:101], v[100:101], v[238:239] op_sel:[0,1] op_sel_hi:[1,1]
    v_pk_mul_f32 v[102:103], v[102:103], v[238:239] op_sel:[0,1] op_sel_hi:[1,1]
    v_cvt_pk_bf16_f32 v96, v96, v97
    v_cvt_pk_bf16_f32 v97, v98, v99
    v_cvt_pk_bf16_f32 v100, v100, v101
    v_cvt_pk_bf16_f32 v101, v102, v103
    ds_write2_b64 v228, v[96:97], v[100:101] offset0:0 offset1:4
    v_pk_mul_f32 v[104:105], v[104:105], v[238:239] op_sel:[0,1] op_sel_hi:[1,1]
    v_pk_mul_f32 v[106:107], v[106:107], v[238:239] op_sel:[0,1] op_sel_hi:[1,1]
    v_pk_mul_f32 v[108:109], v[108:109], v[238:239] op_sel:[0,1] op_sel_hi:[1,1]
    v_pk_mul_f32 v[110:111], v[110:111], v[238:239] op_sel:[0,1] op_sel_hi:[1,1]
    v_cvt_pk_bf16_f32 v104, v104, v105
    v_cvt_pk_bf16_f32 v105, v106, v107
    v_cvt_pk_bf16_f32 v108, v108, v109
    v_cvt_pk_bf16_f32 v109, v110, v111
    ds_write2_b64 v228, v[104:105], v[108:109] offset0:8 offset1:12
    ds_read_b128 v[96:99], v230 offset:0
    ds_read_b128 v[100:103], v230 offset:2176
    s_waitcnt lgkmcnt(1)
    buffer_store_dwordx4 v[96:99], v231, s[20:23], s39 offen offset:0 nt
    s_waitcnt lgkmcnt(0)
    buffer_store_dwordx4 v[100:103], v231, s[20:23], s39 offen offset:2048 nt
    v_pk_mul_f32 v[112:113], v[112:113], v[238:239] op_sel:[0,1] op_sel_hi:[1,1]
    v_pk_mul_f32 v[114:115], v[114:115], v[238:239] op_sel:[0,1] op_sel_hi:[1,1]
    v_pk_mul_f32 v[116:117], v[116:117], v[238:239] op_sel:[0,1] op_sel_hi:[1,1]
    v_pk_mul_f32 v[118:119], v[118:119], v[238:239] op_sel:[0,1] op_sel_hi:[1,1]
    v_cvt_pk_bf16_f32 v112, v112, v113
    v_cvt_pk_bf16_f32 v113, v114, v115
    v_cvt_pk_bf16_f32 v116, v116, v117
    v_cvt_pk_bf16_f32 v117, v118, v119
    ds_write2_b64 v228, v[112:113], v[116:117] offset0:16 offset1:20
    v_pk_mul_f32 v[120:121], v[120:121], v[238:239] op_sel:[0,1] op_sel_hi:[1,1]
    v_pk_mul_f32 v[122:123], v[122:123], v[238:239] op_sel:[0,1] op_sel_hi:[1,1]
    v_pk_mul_f32 v[124:125], v[124:125], v[238:239] op_sel:[0,1] op_sel_hi:[1,1]
    v_pk_mul_f32 v[126:127], v[126:127], v[238:239] op_sel:[0,1] op_sel_hi:[1,1]
    v_cvt_pk_bf16_f32 v120, v120, v121
    v_cvt_pk_bf16_f32 v121, v122, v123
    v_cvt_pk_bf16_f32 v124, v124, v125
    v_cvt_pk_bf16_f32 v125, v126, v127
    ds_write2_b64 v228, v[120:121], v[124:125] offset0:24 offset1:28
    ds_read_b128 v[112:115], v230 offset:128
    ds_read_b128 v[116:119], v230 offset:2304
    s_waitcnt lgkmcnt(1)
    buffer_store_dwordx4 v[112:115], v231, s[20:23], s39 offen offset:128 nt
    s_waitcnt lgkmcnt(0)
    buffer_store_dwordx4 v[116:119], v231, s[20:23], s39 offen offset:2176 nt
    v_rcp_f32 v240, v240
    s_nop 0
    v_pk_mul_f32 v[128:129], v[128:129], v[240:241] op_sel:[0,0] op_sel_hi:[1,0]
    v_pk_mul_f32 v[130:131], v[130:131], v[240:241] op_sel:[0,0] op_sel_hi:[1,0]
    v_pk_mul_f32 v[132:133], v[132:133], v[240:241] op_sel:[0,0] op_sel_hi:[1,0]
    v_pk_mul_f32 v[134:135], v[134:135], v[240:241] op_sel:[0,0] op_sel_hi:[1,0]
    v_cvt_pk_bf16_f32 v128, v128, v129
    v_cvt_pk_bf16_f32 v129, v130, v131
    v_cvt_pk_bf16_f32 v132, v132, v133
    v_cvt_pk_bf16_f32 v133, v134, v135
    ds_write2_b64 v228, v[128:129], v[132:133] offset0:0 offset1:4
    v_pk_mul_f32 v[136:137], v[136:137], v[240:241] op_sel:[0,0] op_sel_hi:[1,0]
    v_pk_mul_f32 v[138:139], v[138:139], v[240:241] op_sel:[0,0] op_sel_hi:[1,0]
    v_pk_mul_f32 v[140:141], v[140:141], v[240:241] op_sel:[0,0] op_sel_hi:[1,0]
    v_pk_mul_f32 v[142:143], v[142:143], v[240:241] op_sel:[0,0] op_sel_hi:[1,0]
    v_cvt_pk_bf16_f32 v136, v136, v137
    v_cvt_pk_bf16_f32 v137, v138, v139
    v_cvt_pk_bf16_f32 v140, v140, v141
    v_cvt_pk_bf16_f32 v141, v142, v143
    ds_write2_b64 v228, v[136:137], v[140:141] offset0:8 offset1:12
    ds_read_b128 v[128:131], v230 offset:0
    ds_read_b128 v[132:135], v230 offset:2176
    s_waitcnt lgkmcnt(1)
    buffer_store_dwordx4 v[128:131], v231, s[20:23], s40 offen offset:0 nt
    s_waitcnt lgkmcnt(0)
    buffer_store_dwordx4 v[132:135], v231, s[20:23], s40 offen offset:2048 nt
    v_pk_mul_f32 v[144:145], v[144:145], v[240:241] op_sel:[0,0] op_sel_hi:[1,0]
    v_pk_mul_f32 v[146:147], v[146:147], v[240:241] op_sel:[0,0] op_sel_hi:[1,0]
    v_pk_mul_f32 v[148:149], v[148:149], v[240:241] op_sel:[0,0] op_sel_hi:[1,0]
    v_pk_mul_f32 v[150:151], v[150:151], v[240:241] op_sel:[0,0] op_sel_hi:[1,0]
    v_cvt_pk_bf16_f32 v144, v144, v145
    v_cvt_pk_bf16_f32 v145, v146, v147
    v_cvt_pk_bf16_f32 v148, v148, v149
    v_cvt_pk_bf16_f32 v149, v150, v151
    ds_write2_b64 v228, v[144:145], v[148:149] offset0:16 offset1:20
    v_pk_mul_f32 v[152:153], v[152:153], v[240:241] op_sel:[0,0] op_sel_hi:[1,0]
    v_pk_mul_f32 v[154:155], v[154:155], v[240:241] op_sel:[0,0] op_sel_hi:[1,0]
    v_pk_mul_f32 v[156:157], v[156:157], v[240:241] op_sel:[0,0] op_sel_hi:[1,0]
    v_pk_mul_f32 v[158:159], v[158:159], v[240:241] op_sel:[0,0] op_sel_hi:[1,0]
    v_cvt_pk_bf16_f32 v152, v152, v153
    v_cvt_pk_bf16_f32 v153, v154, v155
    v_cvt_pk_bf16_f32 v156, v156, v157
    v_cvt_pk_bf16_f32 v157, v158, v159
    ds_write2_b64 v228, v[152:153], v[156:157] offset0:24 offset1:28
    ds_read_b128 v[144:147], v230 offset:128
    ds_read_b128 v[148:151], v230 offset:2304
    s_waitcnt lgkmcnt(1)
    buffer_store_dwordx4 v[144:147], v231, s[20:23], s40 offen offset:128 nt
    s_waitcnt lgkmcnt(0)
    buffer_store_dwordx4 v[148:151], v231, s[20:23], s40 offen offset:2176 nt
    s_cmp_lg_u32 s28, 0
    s_cbranch_scc1 L_fb_done
    v_rcp_f32 v241, v241
    s_nop 0
    v_pk_mul_f32 v[160:161], v[160:161], v[240:241] op_sel:[0,1] op_sel_hi:[1,1]
    v_pk_mul_f32 v[162:163], v[162:163], v[240:241] op_sel:[0,1] op_sel_hi:[1,1]
    v_pk_mul_f32 v[164:165], v[164:165], v[240:241] op_sel:[0,1] op_sel_hi:[1,1]
    v_pk_mul_f32 v[166:167], v[166:167], v[240:241] op_sel:[0,1] op_sel_hi:[1,1]
    v_cvt_pk_bf16_f32 v160, v160, v161
    v_cvt_pk_bf16_f32 v161, v162, v163
    v_cvt_pk_bf16_f32 v164, v164, v165
    v_cvt_pk_bf16_f32 v165, v166, v167
    ds_write2_b64 v228, v[160:161], v[164:165] offset0:0 offset1:4
    v_pk_mul_f32 v[168:169], v[168:169], v[240:241] op_sel:[0,1] op_sel_hi:[1,1]
    v_pk_mul_f32 v[170:171], v[170:171], v[240:241] op_sel:[0,1] op_sel_hi:[1,1]
    v_pk_mul_f32 v[172:173], v[172:173], v[240:241] op_sel:[0,1] op_sel_hi:[1,1]
    v_pk_mul_f32 v[174:175], v[174:175], v[240:241] op_sel:[0,1] op_sel_hi:[1,1]
    v_cvt_pk_bf16_f32 v168, v168, v169
    v_cvt_pk_bf16_f32 v169, v170, v171
    v_cvt_pk_bf16_f32 v172, v172, v173
    v_cvt_pk_bf16_f32 v173, v174, v175
    ds_write2_b64 v228, v[168:169], v[172:173] offset0:8 offset1:12
    ds_read_b128 v[160:163], v230 offset:0
    ds_read_b128 v[164:167], v230 offset:2176
    s_waitcnt lgkmcnt(1)
    buffer_store_dwordx4 v[160:163], v231, s[20:23], s41 offen offset:0 nt
    s_waitcnt lgkmcnt(0)
    buffer_store_dwordx4 v[164:167], v231, s[20:23], s41 offen offset:2048 nt
    v_pk_mul_f32 v[176:177], v[176:177], v[240:241] op_sel:[0,1] op_sel_hi:[1,1]
    v_pk_mul_f32 v[178:179], v[178:179], v[240:241] op_sel:[0,1] op_sel_hi:[1,1]
    v_pk_mul_f32 v[180:181], v[180:181], v[240:241] op_sel:[0,1] op_sel_hi:[1,1]
    v_pk_mul_f32 v[182:183], v[182:183], v[240:241] op_sel:[0,1] op_sel_hi:[1,1]
    v_cvt_pk_bf16_f32 v176, v176, v177
    v_cvt_pk_bf16_f32 v177, v178, v179
    v_cvt_pk_bf16_f32 v180, v180, v181
    v_cvt_pk_bf16_f32 v181, v182, v183
    ds_write2_b64 v228, v[176:177], v[180:181] offset0:16 offset1:20
    v_pk_mul_f32 v[184:185], v[184:185], v[240:241] op_sel:[0,1] op_sel_hi:[1,1]
    v_pk_mul_f32 v[186:187], v[186:187], v[240:241] op_sel:[0,1] op_sel_hi:[1,1]
    v_pk_mul_f32 v[188:189], v[188:189], v[240:241] op_sel:[0,1] op_sel_hi:[1,1]
    v_pk_mul_f32 v[190:191], v[190:191], v[240:241] op_sel:[0,1] op_sel_hi:[1,1]
    v_cvt_pk_bf16_f32 v184, v184, v185
    v_cvt_pk_bf16_f32 v185, v186, v187
    v_cvt_pk_bf16_f32 v188, v188, v189
    v_cvt_pk_bf16_f32 v189, v190, v191
    ds_write2_b64 v228, v[184:185], v[188:189] offset0:24 offset1:28
    ds_read_b128 v[176:179], v230 offset:128
    ds_read_b128 v[180:183], v230 offset:2304
    s_waitcnt lgkmcnt(1)
    buffer_store_dwordx4 v[176:179], v231, s[20:23], s41 offen offset:128 nt
    s_waitcnt lgkmcnt(0)
    buffer_store_dwordx4 v[180:183], v231, s[20:23], s41 offen offset:2176 nt
L_fb_done:
    s_endpgm
L_end:
    s_endpgm
.section .rodata,"a"
.p2align 6
.amdhsa_kernel standalone__gqa_softmax__near_ridge_kernel
  .amdhsa_next_free_vgpr 512
  .amdhsa_next_free_sgpr 102
  .amdhsa_accum_offset 256
  .amdhsa_group_segment_fixed_size 0
  .amdhsa_kernarg_size 48
  .amdhsa_user_sgpr_count 2
  .amdhsa_user_sgpr_kernarg_segment_ptr 1
  .amdhsa_system_sgpr_workgroup_id_x 1
.end_amdhsa_kernel
```
